```python
import torch

def _softmax(x, axis=-1):
    return torch.softmax(x, dim=axis)
def _gelu(x):
    return torch.nn.functional.gelu(x, approximate="tanh")
def _silu(x):
    return torch.nn.functional.silu(x)
def _sigmoid(x):
    return torch.sigmoid(x)
def _layernorm(x, axis=-1, eps=1e-5):
    m = x.mean(dim=axis, keepdim=True)
    v = x.var(dim=axis, keepdim=True, unbiased=False)
    return (x - m) / torch.sqrt(v + eps)
def _scatter_add(tgt, idx, src, axis=0):
    return tgt.clone().index_add_(axis, idx, src)
def _segment_sum(src, seg, n):
    out = torch.zeros((n,) + src.shape[1:], dtype=src.dtype)
    return out.index_add_(0, seg, src)
def _pad(x, pw):
    flat = tuple(v for pair in reversed(pw) for v in pair)
    return torch.nn.functional.pad(x, flat)

kernel_name = 'gated_mix__linear_attn_block__mha_block__prompt'

def setup_inputs():

    _w = (lambda a: (lambda t: t.to(torch.bfloat16) if t.is_floating_point() else t)(torch.as_tensor(a)))
    def _A_setup():
        B, S, D = 1, 2048, 448
        return {
            "x": _w((lambda *s: torch.randn(*s, dtype=torch.bfloat16) * 0.05)(B, S, D)),
            "wqkv": _w((lambda *s: torch.randn(*s, dtype=torch.bfloat16) * 3.2)(D, 3 * D)),
            "wo": _w((lambda *s: torch.randn(*s, dtype=torch.bfloat16) * 0.4)(D, D)),
        }
    _A_in = _A_setup()

    def _B_setup():
        B, S, D, H = 1, 2048, 448, 16
        return {
            "x": _w((lambda *s: torch.randn(*s, dtype=torch.bfloat16) * 0.05)(B, S, D)),
            "wqkv": _w((lambda *s: torch.randn(*s, dtype=torch.bfloat16) * 1.6)(D, 3 * D)),
            "wo": _w((lambda *s: torch.randn(*s, dtype=torch.bfloat16) * 0.05)(D, D)),
        }
    _B_in = _B_setup()

    return {
        "A_x": _A_in["x"],
        "A_wqkv": _A_in["wqkv"],
        "A_wo": _A_in["wo"],
        "B_x": _B_in["x"],
        "B_wqkv": _B_in["wqkv"],
        "B_wo": _B_in["wo"],
        "gate_w": _w((lambda *s: torch.randn(*s, dtype=torch.bfloat16) * 0.05)(448) * 16.0),
    }

def reference(A_x, A_wqkv, A_wo, B_x, B_wqkv, B_wo, gate_w):
    def _A_ref(x, wqkv, wo):
        B, S, D = x.shape
        H = 16; Dh = D // H
        qkv = (lambda x, *d: x.permute(*d))((x @ wqkv).reshape(B, S, 3, H, Dh), 2, 0, 3, 1, 4)
        q, k, v = qkv[0], qkv[1], qkv[2]
        phi = lambda t: torch.where(t > 0, t + 1, torch.exp(t)) + 1e-6
        pq, pk = phi(q), phi(k)
        kv = torch.einsum("bhsd,bhse->bhde", pk, v)
        z = torch.einsum("bhsd->bhd", pk)
        num = torch.einsum("bhqd,bhde->bhqe", pq, kv)
        den = torch.einsum("bhqd,bhd->bhq", pq, z)[..., None] + 1e-6
        o = num / den
        return (lambda x, *d: x.permute(*d))(o, 0, 2, 1, 3).reshape(B, S, D) @ wo

    def _B_ref(x, wqkv, wo):
        B, S, D = x.shape
        H = 16
        Dh = D // H
        qkv = (lambda x, *d: x.permute(*d))((x @ wqkv).reshape(B, S, 3, H, Dh), 2, 0, 3, 1, 4)
        q, k, v = qkv[0], qkv[1], qkv[2]
        scores = torch.einsum("bhqd,bhkd->bhqk", q, k) * (Dh ** -0.5)
        p = _softmax(scores, axis=-1)
        o = torch.einsum("bhqk,bhkd->bhqd", p, v)
        return (lambda x, *d: x.permute(*d))(o, 0, 2, 1, 3).reshape(B, S, D) @ wo

    x = A_x
    g = _sigmoid((x * gate_w).sum(-1, keepdims=True))
    a = _A_ref(x, A_wqkv, A_wo)
    b = _B_ref(x, B_wqkv, B_wo)
    return g * a + (1 - g) * b
```

```asm
; @launch grid=(256,1,1) block=(256,1,1) lds=163840
.amdgcn_target "amdgcn-amd-amdhsa--gfx950"
.text
.globl gated_mix__linear_attn_block__mha_block__prompt_kernel
.p2align 8
.type gated_mix__linear_attn_block__mha_block__prompt_kernel,@function
gated_mix__linear_attn_block__mha_block__prompt_kernel:
  s_cmp_ge_u32 s2, 256
  s_cbranch_scc1 L_end
  s_load_dwordx2 s[4:5], s[0:1], 0
  s_load_dwordx16 s[72:87], s[0:1], 0
  s_load_dwordx2 s[16:17], s[0:1], 72
  v_lshrrev_b32 v1, 6, v0
  v_and_b32 v0, 63, v0
  v_readfirstlane_b32 s38, v1
  s_mov_b32 s6, 1835008
  s_mov_b32 s7, 0x00020000
  s_bfe_u32 s37, s2, 0x10002
  s_lshr_b32 s53, s2, 5
  s_lshl3_add_u32 s37, s37, s53
  s_mul_i32 s39, s38, 28672
  s_mul_i32 s3, s37, 114688
  s_add_u32 s40, s3, s39
  v_lshrrev_b32 v8, 3, v0
  v_mul_u32_u24 v2, 896, v8
  v_and_b32 v5, 7, v0
  v_lshrrev_b32 v6, 4, v0
  v_xor_b32 v7, v5, v6
  v_lshl_add_u32 v2, v7, 4, v2
  v_xor_b32 v3, 64, v2
  s_bfe_u32 s54, s2, 0x20003
  s_lshl1_add_u32 s53, s54, s53
  s_sub_u32 s54, s53, 7
  s_min_u32 s53, s53, s54
  s_lshl_b32 s96, s53, 7
  s_getpc_b64 s[56:57]
L_pc:
  s_lshr_b32 s55, s2, 3
  s_lshl_b32 s55, s55, 2
  s_add_u32 s55, s55, s38
  s_lshl_b32 s55, s55, 9
  v_and_b32 v251, 3, v0
  v_lshl_add_u32 v250, v251, 7, s55
  v_min_u32 v250, L_hotend-L_pc-4, v250
  v_mov_b32 v253, s57
  v_add_co_u32 v252, vcc, s56, v250
  s_nop 1
  v_addc_co_u32 v253, vcc, 0, v253, vcc
  global_load_dword v249, v[252:253], off
  s_waitcnt lgkmcnt(0)
  s_add_u32 m0, s39, 0
  s_add_u32 s53, s40, s96
  buffer_load_dwordx4 v2, s[4:7], s53 offen lds
  s_add_u32 s41, s40, 7168
  s_add_u32 m0, s39, 1024
  s_add_u32 s54, s41, s96
  buffer_load_dwordx4 v3, s[4:7], s54 offen lds
  s_add_u32 s42, s40, 14336
  s_add_u32 m0, s39, 2048
  s_add_u32 s53, s42, s96
  buffer_load_dwordx4 v2, s[4:7], s53 offen lds
  s_add_u32 s43, s40, 21504
  s_add_u32 m0, s39, 3072
  s_add_u32 s54, s43, s96
  buffer_load_dwordx4 v3, s[4:7], s54 offen lds
  s_and_b32 s59, s2, 3
  s_bfe_u32 s3, s2, 0x10003
  s_lshl1_add_u32 s59, s59, s3
  s_bfe_u32 s60, s2, 0x10004
  s_xor_b32 s60, s60, 1
  s_mov_b64 s[12:13], s[80:81]
  s_mov_b32 s91, s96
  s_mul_i32 s44, s38, 43008
  s_mul_i32 s3, s59, 112
  s_add_u32 s44, s44, s3
  s_lshl_b32 s69, s38, 11
  s_add_u32 s45, s69, 114688
  v_mul_u32_u24 v4, 2688, v8
  v_and_b32 v6, 1, v6
  v_lshlrev_b32 v6, 2, v6
  v_xor_b32 v7, v5, v6
  s_cmp_eq_u32 s59, 7
  s_cselect_b32 s3, 6, 7
  v_min_u32 v7, s3, v7
  v_lshl_add_u32 v4, v7, 4, v4
  s_mul_i32 s3, s60, 896
  s_add_u32 s3, s3, 896
  s_add_u32 s98, s44, s3
  s_add_u32 s98, s98, s12
  s_addc_u32 s99, s13, 0
  s_mul_i32 s97, s96, 1344
  v_add_u32 v160, s97, v4
  v_add_u32 v161, 21504, v160
  s_add_u32 m0, s45, 0
  s_nop 0
  global_load_lds_dwordx4 v160, s[98:99]
  s_add_u32 m0, s45, 1024
  s_nop 0
  global_load_lds_dwordx4 v161, s[98:99]
  s_mov_b64 s[8:9], s[74:75]
  s_mov_b64 s[20:21], s[76:77]
  s_mov_b64 s[24:25], s[82:83]
  s_mov_b64 s[32:33], s[84:85]
  s_mov_b64 s[28:29], s[86:87]
  s_mov_b32 s10, 1204224
  s_mov_b32 s11, 0x00020000
  s_mov_b32 s14, 1204224
  s_mov_b32 s15, 0x00020000
  s_mov_b32 s18, 0x10000000
  s_mov_b32 s19, 0x00020000
  s_mov_b32 s22, 401408
  s_mov_b32 s23, 0x00020000
  s_mov_b32 s26, 401408
  s_mov_b32 s27, 0x00020000
  s_mov_b32 s30, 1835008
  s_mov_b32 s31, 0x00020000
  s_mov_b32 s34, 896
  s_mov_b32 s35, 0x00020000
  s_lshl_b32 s36, s59, 1
  s_add_u32 s36, s36, s60
  s_lshl_b32 s61, s59, 4
  s_add_u32 s61, s61, s37
  v_lshlrev_b32 v1, 4, v0
  s_mov_b32 s3, s96
  s_add_u32 s3, s3, 128
  s_cmp_eq_u32 s3, 896
  s_cselect_b32 s3, 0, s3
  s_mul_i32 s97, s3, 1344
  v_add_u32 v162, s97, v4
  v_add_u32 v163, 21504, v162
  s_add_u32 s3, s3, 128
  s_cmp_eq_u32 s3, 896
  s_cselect_b32 s3, 0, s3
  s_mul_i32 s97, s3, 1344
  v_add_u32 v164, s97, v4
  v_add_u32 v165, 21504, v164
  s_add_u32 s3, s3, 128
  s_cmp_eq_u32 s3, 896
  s_cselect_b32 s3, 0, s3
  s_mul_i32 s97, s3, 1344
  v_add_u32 v166, s97, v4
  v_add_u32 v167, 21504, v166
  s_add_u32 s3, s3, 128
  s_cmp_eq_u32 s3, 896
  s_cselect_b32 s3, 0, s3
  s_mul_i32 s97, s3, 1344
  v_add_u32 v168, s97, v4
  v_add_u32 v169, 21504, v168
  s_add_u32 s3, s3, 128
  s_cmp_eq_u32 s3, 896
  s_cselect_b32 s3, 0, s3
  s_mul_i32 s97, s3, 1344
  v_add_u32 v170, s97, v4
  v_add_u32 v171, 21504, v170
  s_add_u32 s3, s3, 128
  s_cmp_eq_u32 s3, 896
  s_cselect_b32 s3, 0, s3
  s_mul_i32 s97, s3, 1344
  v_add_u32 v172, s97, v4
  v_add_u32 v173, 21504, v172
  v_mov_b32 v5, 0
  buffer_load_dword v15, v5, s[16:19], 0 offen sc1
  v_and_b32 v9, 31, v0
  v_lshlrev_b32 v9, 7, v9
  v_add_u32 v9, s39, v9
  v_lshrrev_b32 v10, 5, v0
  v_bfe_u32 v11, v0, 1, 3
  v_add_u32 v12, 0, v10
  v_xor_b32 v12, v12, v11
  v_lshl_add_u32 v5, v12, 4, v9
  v_add_u32 v12, 2, v10
  v_xor_b32 v12, v12, v11
  v_lshl_add_u32 v6, v12, 4, v9
  v_add_u32 v12, 4, v10
  v_xor_b32 v12, v12, v11
  v_lshl_add_u32 v7, v12, 4, v9
  v_add_u32 v12, 6, v10
  v_xor_b32 v12, v12, v11
  v_lshl_add_u32 v8, v12, 4, v9
  v_lshlrev_b32 v11, 10, v10
  v_bfe_u32 v12, v0, 2, 2
  v_lshl_add_u32 v11, v12, 7, v11
  v_add_u32 v11, 114688, v11
  v_bfe_u32 v12, v0, 4, 1
  v_lshlrev_b32 v12, 5, v12
  v_and_b32 v13, 3, v0
  v_lshl_add_u32 v12, v13, 3, v12
  v_bfe_u32 v13, v0, 3, 1
  v_lshlrev_b32 v13, 6, v13
  v_xor_b32 v14, v12, v13
  v_add_u32 v9, v11, v14
  v_add_u32 v12, 56, v12
  v_xor_b32 v14, v12, v13
  v_add_u32 v10, v11, v14
  v_subrev_u32 v200, 114688, v9
  v_subrev_u32 v201, 114688, v10
  v_add_u32 v174, 0x10000, v200
  v_add_u32 v175, 0x10000, v201
  s_mov_b32 s46, 0
  s_mov_b32 s47, -1
  s_mov_b32 s48, 0xF0000000
  s_mov_b32 s49, 0xF0000000
  s_mov_b32 s50, 1049335798
  s_mov_b32 s51, 1069066811
  s_mov_b32 s52, 897988541
  v_and_b32 v12, 31, v0
  v_cmp_eq_u32 s[56:57], 28, v12
  v_mov_b32 v13, 0x3F803F80
  v_mov_b32 v224, 1069066811
  v_mov_b32 v206, 1049335798
  v_min_u32 v14, 1, v0
  v_cndmask_b32 v12, 0, v13, s[56:57]
  v_lshlrev_b32 v14, 30, v14
  s_lshl_b32 s55, s59, 2
  s_add_u32 s55, s55, s38
  s_lshl_b32 s86, s55, 12
  s_add_u32 s86, s86, 65536
  v_and_b32 v16, 31, v0
  v_lshl_add_u32 v236, v16, 7, s86
  s_lshl_b32 s63, s36, 18
  s_lshl_b32 s56, s38, 16
  s_add_u32 s63, s63, s56
  s_add_u32 s63, s63, 1048576
  s_lshl_b32 s55, s55, 11
  s_add_u32 s55, s55, 327680
  s_lshl_b32 s56, s61, 9
  s_add_u32 s56, s56, 262144
  v_and_b32 v17, 15, v0
  v_lshl_add_u32 v18, v17, 7, s55
  v_and_b32 v19, 3, v0
  v_lshl_add_u32 v20, v19, 7, s56
  s_lshl_b32 s55, s59, 14
  s_lshl_b32 s56, s37, 7
  s_add_u32 s55, s55, s56
  s_add_u32 s55, s55, 67584
  v_lshl_add_u32 v19, v19, 12, s55
  v_cmp_gt_u32 s[56:57], 16, v0
  v_cmp_gt_u32 s[54:55], 20, v0
  v_lshlrev_b32 v237, 7, v17
  s_lshl_b32 s64, s36, 16
  v_cndmask_b32 v19, v19, v20, s[54:55]
  v_cndmask_b32 v235, v19, v18, s[56:57]
  s_lshl_b32 s53, s38, 14
  s_add_u32 s64, s64, s53
  s_add_u32 s64, s64, 5242880
  s_lshl_b32 s53, s38, 9
  s_add_u32 s53, s53, 122880
  v_lshl_add_u32 v226, v0, 3, s53
  v_lshlrev_b32 v227, 3, v0
  v_add_u32 v227, 122880, v227
  s_lshl_b32 s53, s38, 13
  s_add_u32 s53, s53, 131072
  v_add_u32 v230, s53, v1
  s_lshl_b32 s53, s38, 11
  s_add_u32 s53, s53, 131072
  v_add_u32 v231, s53, v1
  s_lshr_b32 s53, s38, 1
  s_lshl_b32 s53, s53, 12
  s_add_u32 s53, s53, 134656
  v_lshl_add_u32 v232, v16, 4, s53
  v_xor_b32 v233, 4096, v232
  v_lshlrev_b32 v228, 2, v16
  v_mov_b32 v229, 1602224128
  s_and_b32 s53, s38, 1
  s_lshl_b32 s65, s37, 18
  s_lshl_b32 s54, s36, 11
  s_add_u32 s65, s65, s54
  s_add_u32 s65, s65, 6291456
  s_lshr_b32 s54, s2, 3
  s_min_u32 s54, s54, 27
  s_mul_i32 s55, s54, 37
  s_lshr_b32 s55, s55, 8
  s_mul_i32 s57, s55, 7
  s_sub_u32 s57, s54, s57
  s_lshl_b32 s57, s57, 7
  s_and_b32 s68, s2, 7
  s_lshl_b32 s68, s68, 2
  s_add_u32 s68, s68, s55
  s_mul_i32 s66, s38, 100352
  s_add_u32 s66, s66, s57
  s_mul_i32 s67, s38, 30720
  v_lshrrev_b32 v18, 3, v0
  v_mul_u32_u24 v234, 896, v18
  v_and_b32 v18, 7, v0
  v_bfe_u32 v19, v0, 4, 1
  v_lshlrev_b32 v20, 2, v19
  v_xor_b32 v18, v18, v20
  v_lshl_add_u32 v234, v18, 4, v234
  s_lshr_b32 s56, s68, 1
  s_lshl_b32 s88, s56, 13
  s_lshl_b32 s54, s38, 11
  s_add_u32 s88, s88, s54
  s_add_u32 s88, s88, 393216
  s_and_b32 s53, s68, 1
  s_lshl_b32 s87, s56, 18
  s_lshl_b32 s54, s53, 16
  s_add_u32 s87, s87, s54
  s_lshl_b32 s54, s38, 13
  s_add_u32 s87, s87, s54
  s_add_u32 s87, s87, 6291456
  v_lshrrev_b32 v21, 5, v0
  v_lshlrev_b32 v18, 9, v21
  v_bfe_u32 v20, v0, 2, 2
  v_lshl_add_u32 v18, v20, 7, v18
  v_add_u32 v18, s67, v18
  v_lshlrev_b32 v19, 5, v19
  v_and_b32 v20, 3, v0
  v_lshl_add_u32 v19, v20, 3, v19
  v_bfe_u32 v20, v0, 3, 1
  v_lshlrev_b32 v20, 6, v20
  v_xor_b32 v22, v19, v20
  v_add_u32 v240, v18, v22
  v_xor_b32 v241, 64, v240
  v_lshlrev_b32 v18, 9, v21
  v_bfe_u32 v22, v0, 2, 1
  v_lshl_add_u32 v18, v22, 7, v18
  v_bfe_u32 v22, v0, 3, 1
  v_lshl_add_u32 v18, v22, 11, v18
  v_add3_u32 v18, v18, v19, s67
  v_add_u32 v238, 1024, v18
  v_xor_b32 v225, 64, v238
  v_lshlrev_b32 v242, 5, v16
  v_lshl_add_u32 v242, v21, 4, v242
  v_add_u32 v246, 7168, v234
  v_add_u32 v247, 14336, v234
  v_add_u32 v248, 21504, v234
  v_add_u32 v250, 28672, v234
  v_add_u32 v251, 35840, v234
  v_add_u32 v252, 43008, v234
  s_and_b32 s3, s38, 1
  s_mul_i32 s3, s3, 2040
  s_sub_u32 s3, 1024, s3
  v_add_u32 v253, s3, v231
  v_mul_u32_u24 v245, 0x9E37, v0
  s_lshl_b32 s56, s56, 2
  s_add_u32 s56, s56, s53
  s_mul_i32 s89, s56, 28672
  s_add_u32 s89, s89, s57
  s_and_b32 s53, s38, 1
  s_lshl_b32 s54, s53, 6
  s_add_u32 s89, s89, s54
  s_lshr_b32 s54, s38, 1
  s_lshl_b32 s55, s54, 5
  s_add_u32 s89, s89, s55
  v_mul_u32_u24 v244, 896, v16
  v_lshl_add_u32 v244, v21, 4, v244
  s_lshl_b32 s53, s53, 12
  s_lshl_b32 s54, s54, 11
  s_add_u32 s53, s53, s54
  s_add_u32 s53, s53, 131072
  v_add_u32 v243, s53, v1
  s_lshr_b32 s53, s2, 3
  s_lshl_b32 s53, s53, 2
  s_add_u32 s53, s53, s38
  s_mul_i32 s90, s53, 3200
  v_cmp_gt_u32 s[56:57], 25, v0
  v_lshlrev_b32 v18, 7, v0
  v_mov_b32 v19, 0x40000000
  v_cndmask_b32 v239, v19, v18, s[56:57]
  s_add_u32 s96, s96, 128
  s_cmp_eq_u32 s96, 896
  s_cselect_b32 s96, 0, s96
  s_add_u32 m0, s39, 4096
  s_add_u32 s53, s40, s96
  buffer_load_dwordx4 v2, s[4:7], s53 offen lds
  s_add_u32 m0, s39, 5120
  s_add_u32 s54, s41, s96
  buffer_load_dwordx4 v3, s[4:7], s54 offen lds
  s_add_u32 m0, s39, 6144
  s_add_u32 s53, s42, s96
  buffer_load_dwordx4 v2, s[4:7], s53 offen lds
  s_add_u32 m0, s39, 7168
  s_add_u32 s54, s43, s96
  buffer_load_dwordx4 v3, s[4:7], s54 offen lds
  s_add_u32 m0, s45, 8192
  s_nop 0
  global_load_lds_dwordx4 v162, s[98:99]
  s_add_u32 m0, s45, 9216
  s_nop 0
  global_load_lds_dwordx4 v163, s[98:99]
  s_cmp_eq_u32 s60, 0
  s_cbranch_scc0 L_roleVA
  s_waitcnt vmcnt(7)
  s_barrier
  ds_read_b128 a[0:3], v5 offset:0
  ds_read_b128 a[4:7], v6 offset:0
  s_add_u32 s96, s96, 128
  s_cmp_eq_u32 s96, 896
  s_cselect_b32 s96, 0, s96
  s_add_u32 m0, s39, 8192
  s_add_u32 s53, s40, s96
  buffer_load_dwordx4 v2, s[4:7], s53 offen lds
  ds_read_b128 a[8:11], v7 offset:0
  ds_read_b128 a[12:15], v8 offset:0
  ds_read_b64_tr_b16 a[112:113], v9 offset:0
  s_add_u32 m0, s39, 9216
  s_add_u32 s54, s41, s96
  buffer_load_dwordx4 v3, s[4:7], s54 offen lds
  ds_read_b64_tr_b16 a[114:115], v9 offset:512
  ds_read_b64_tr_b16 a[116:117], v10 offset:0
  ds_read_b64_tr_b16 a[118:119], v10 offset:512
  s_add_u32 m0, s39, 10240
  s_add_u32 s53, s42, s96
  buffer_load_dwordx4 v2, s[4:7], s53 offen lds
  ds_read_b64_tr_b16 a[120:121], v9 offset:2048
  ds_read_b64_tr_b16 a[122:123], v9 offset:2560
  ds_read_b64_tr_b16 a[124:125], v10 offset:2048
  s_add_u32 m0, s39, 11264
  s_add_u32 s54, s43, s96
  buffer_load_dwordx4 v3, s[4:7], s54 offen lds
  s_add_u32 m0, s45, 16384
  ds_read_b64_tr_b16 a[126:127], v10 offset:2560
  ds_read_b64_tr_b16 a[128:129], v9 offset:4096
  ds_read_b64_tr_b16 a[130:131], v9 offset:4608
  ds_read_b64_tr_b16 a[132:133], v10 offset:4096
  ds_read_b64_tr_b16 a[134:135], v10 offset:4608
  ds_read_b64_tr_b16 a[136:137], v9 offset:6144
  global_load_lds_dwordx4 v164, s[98:99]
  s_add_u32 m0, s45, 17408
  ds_read_b64_tr_b16 a[138:139], v9 offset:6656
  ds_read_b64_tr_b16 a[140:141], v10 offset:6144
  ds_read_b64_tr_b16 a[142:143], v10 offset:6656
  global_load_lds_dwordx4 v165, s[98:99]
  s_waitcnt lgkmcnt(14)
  v_mfma_f32_32x32x16_bf16 v[16:31], a[112:115], a[0:3], 0
  s_waitcnt lgkmcnt(6)
  s_waitcnt vmcnt(6)
  s_barrier
  v_mfma_f32_32x32x16_bf16 v[32:47], a[116:119], a[0:3], 0
  ds_read_b128 a[16:19], v5 offset:4096
  ds_read_b128 a[20:23], v6 offset:4096
  s_add_u32 s96, s96, 128
  s_cmp_eq_u32 s96, 896
  s_cselect_b32 s96, 0, s96
  s_add_u32 m0, s39, 12288
  s_add_u32 s53, s40, s96
  buffer_load_dwordx4 v2, s[4:7], s53 offen lds
  v_mfma_f32_32x32x16_bf16 v[16:31], a[120:123], a[4:7], v[16:31]
  ds_read_b128 a[24:27], v7 offset:4096
  ds_read_b128 a[28:31], v8 offset:4096
  ds_read_b64_tr_b16 a[144:145], v9 offset:8192
  s_add_u32 m0, s39, 13312
  s_add_u32 s54, s41, s96
  buffer_load_dwordx4 v3, s[4:7], s54 offen lds
  v_mfma_f32_32x32x16_bf16 v[32:47], a[124:127], a[4:7], v[32:47]
  ds_read_b64_tr_b16 a[146:147], v9 offset:8704
  ds_read_b64_tr_b16 a[148:149], v10 offset:8192
  ds_read_b64_tr_b16 a[150:151], v10 offset:8704
  s_add_u32 m0, s39, 14336
  s_add_u32 s53, s42, s96
  buffer_load_dwordx4 v2, s[4:7], s53 offen lds
  v_mfma_f32_32x32x16_bf16 v[16:31], a[128:131], a[8:11], v[16:31]
  s_waitcnt lgkmcnt(2)
  ds_read_b64_tr_b16 a[152:153], v9 offset:10240
  ds_read_b64_tr_b16 a[154:155], v9 offset:10752
  ds_read_b64_tr_b16 a[156:157], v10 offset:10240
  s_add_u32 m0, s39, 15360
  s_add_u32 s54, s43, s96
  buffer_load_dwordx4 v3, s[4:7], s54 offen lds
  v_mfma_f32_32x32x16_bf16 v[32:47], a[132:135], a[8:11], v[32:47]
  s_add_u32 m0, s45, 24576
  ds_read_b64_tr_b16 a[158:159], v10 offset:10752
  ds_read_b64_tr_b16 a[160:161], v9 offset:12288
  ds_read_b64_tr_b16 a[162:163], v9 offset:12800
  v_mfma_f32_32x32x16_bf16 v[16:31], a[136:139], a[12:15], v[16:31]
  ds_read_b64_tr_b16 a[164:165], v10 offset:12288
  ds_read_b64_tr_b16 a[166:167], v10 offset:12800
  ds_read_b64_tr_b16 a[168:169], v9 offset:14336
  global_load_lds_dwordx4 v166, s[98:99]
  v_mfma_f32_32x32x16_bf16 v[32:47], a[140:143], a[12:15], v[32:47]
  s_add_u32 m0, s45, 25600
  ds_read_b64_tr_b16 a[170:171], v9 offset:14848
  ds_read_b64_tr_b16 a[172:173], v10 offset:14336
  ds_read_b64_tr_b16 a[174:175], v10 offset:14848
  global_load_lds_dwordx4 v167, s[98:99]
  v_mfma_f32_32x32x16_bf16 v[16:31], a[144:147], a[16:19], v[16:31]
  s_waitcnt lgkmcnt(6)
  s_waitcnt vmcnt(6)
  s_barrier
  v_mfma_f32_32x32x16_bf16 v[32:47], a[148:151], a[16:19], v[32:47]
  ds_read_b128 a[32:35], v5 offset:8192
  ds_read_b128 a[36:39], v6 offset:8192
  s_add_u32 s96, s96, 128
  s_cmp_eq_u32 s96, 896
  s_cselect_b32 s96, 0, s96
  s_add_u32 m0, s39, 16384
  s_add_u32 s53, s40, s96
  buffer_load_dwordx4 v2, s[4:7], s53 offen lds
  v_mfma_f32_32x32x16_bf16 v[16:31], a[152:155], a[20:23], v[16:31]
  ds_read_b128 a[40:43], v7 offset:8192
  ds_read_b128 a[44:47], v8 offset:8192
  ds_read_b64_tr_b16 a[112:113], v9 offset:16384
  s_add_u32 m0, s39, 17408
  s_add_u32 s54, s41, s96
  buffer_load_dwordx4 v3, s[4:7], s54 offen lds
  v_mfma_f32_32x32x16_bf16 v[32:47], a[156:159], a[20:23], v[32:47]
  ds_read_b64_tr_b16 a[114:115], v9 offset:16896
  ds_read_b64_tr_b16 a[116:117], v10 offset:16384
  ds_read_b64_tr_b16 a[118:119], v10 offset:16896
  s_add_u32 m0, s39, 18432
  s_add_u32 s53, s42, s96
  buffer_load_dwordx4 v2, s[4:7], s53 offen lds
  v_mfma_f32_32x32x16_bf16 v[16:31], a[160:163], a[24:27], v[16:31]
  s_waitcnt lgkmcnt(2)
  ds_read_b64_tr_b16 a[120:121], v9 offset:18432
  ds_read_b64_tr_b16 a[122:123], v9 offset:18944
  ds_read_b64_tr_b16 a[124:125], v10 offset:18432
  s_add_u32 m0, s39, 19456
  s_add_u32 s54, s43, s96
  buffer_load_dwordx4 v3, s[4:7], s54 offen lds
  v_mfma_f32_32x32x16_bf16 v[32:47], a[164:167], a[24:27], v[32:47]
  s_add_u32 m0, s45, 32768
  ds_read_b64_tr_b16 a[126:127], v10 offset:18944
  ds_read_b64_tr_b16 a[128:129], v9 offset:20480
  ds_read_b64_tr_b16 a[130:131], v9 offset:20992
  v_mfma_f32_32x32x16_bf16 v[16:31], a[168:171], a[28:31], v[16:31]
  ds_read_b64_tr_b16 a[132:133], v10 offset:20480
  ds_read_b64_tr_b16 a[134:135], v10 offset:20992
  ds_read_b64_tr_b16 a[136:137], v9 offset:22528
  global_load_lds_dwordx4 v168, s[98:99]
  v_mfma_f32_32x32x16_bf16 v[32:47], a[172:175], a[28:31], v[32:47]
  s_add_u32 m0, s45, 33792
  ds_read_b64_tr_b16 a[138:139], v9 offset:23040
  ds_read_b64_tr_b16 a[140:141], v10 offset:22528
  ds_read_b64_tr_b16 a[142:143], v10 offset:23040
  global_load_lds_dwordx4 v169, s[98:99]
  v_mfma_f32_32x32x16_bf16 v[16:31], a[112:115], a[32:35], v[16:31]
  s_waitcnt lgkmcnt(6)
  s_waitcnt vmcnt(6)
  s_barrier
  v_mfma_f32_32x32x16_bf16 v[32:47], a[116:119], a[32:35], v[32:47]
  ds_read_b128 a[48:51], v5 offset:12288
  ds_read_b128 a[52:55], v6 offset:12288
  s_add_u32 s96, s96, 128
  s_cmp_eq_u32 s96, 896
  s_cselect_b32 s96, 0, s96
  s_add_u32 m0, s39, 20480
  s_add_u32 s53, s40, s96
  buffer_load_dwordx4 v2, s[4:7], s53 offen lds
  v_mfma_f32_32x32x16_bf16 v[16:31], a[120:123], a[36:39], v[16:31]
  ds_read_b128 a[56:59], v7 offset:12288
  ds_read_b128 a[60:63], v8 offset:12288
  ds_read_b64_tr_b16 a[144:145], v9 offset:24576
  s_add_u32 m0, s39, 21504
  s_add_u32 s54, s41, s96
  buffer_load_dwordx4 v3, s[4:7], s54 offen lds
  v_mfma_f32_32x32x16_bf16 v[32:47], a[124:127], a[36:39], v[32:47]
  ds_read_b64_tr_b16 a[146:147], v9 offset:25088
  ds_read_b64_tr_b16 a[148:149], v10 offset:24576
  ds_read_b64_tr_b16 a[150:151], v10 offset:25088
  s_add_u32 m0, s39, 22528
  s_add_u32 s53, s42, s96
  buffer_load_dwordx4 v2, s[4:7], s53 offen lds
  v_mfma_f32_32x32x16_bf16 v[16:31], a[128:131], a[40:43], v[16:31]
  s_waitcnt lgkmcnt(2)
  ds_read_b64_tr_b16 a[152:153], v9 offset:26624
  ds_read_b64_tr_b16 a[154:155], v9 offset:27136
  ds_read_b64_tr_b16 a[156:157], v10 offset:26624
  s_add_u32 m0, s39, 23552
  s_add_u32 s54, s43, s96
  buffer_load_dwordx4 v3, s[4:7], s54 offen lds
  v_mfma_f32_32x32x16_bf16 v[32:47], a[132:135], a[40:43], v[32:47]
  s_add_u32 m0, s45, 40960
  ds_read_b64_tr_b16 a[158:159], v10 offset:27136
  ds_read_b64_tr_b16 a[160:161], v9 offset:28672
  ds_read_b64_tr_b16 a[162:163], v9 offset:29184
  v_mfma_f32_32x32x16_bf16 v[16:31], a[136:139], a[44:47], v[16:31]
  ds_read_b64_tr_b16 a[164:165], v10 offset:28672
  ds_read_b64_tr_b16 a[166:167], v10 offset:29184
  ds_read_b64_tr_b16 a[168:169], v9 offset:30720
  global_load_lds_dwordx4 v170, s[98:99]
  v_mfma_f32_32x32x16_bf16 v[32:47], a[140:143], a[44:47], v[32:47]
  s_add_u32 m0, s45, 41984
  ds_read_b64_tr_b16 a[170:171], v9 offset:31232
  ds_read_b64_tr_b16 a[172:173], v10 offset:30720
  ds_read_b64_tr_b16 a[174:175], v10 offset:31232
  global_load_lds_dwordx4 v171, s[98:99]
  v_mfma_f32_32x32x16_bf16 v[16:31], a[144:147], a[48:51], v[16:31]
  s_waitcnt lgkmcnt(6)
  s_waitcnt vmcnt(6)
  s_barrier
  v_mfma_f32_32x32x16_bf16 v[32:47], a[148:151], a[48:51], v[32:47]
  ds_read_b128 a[64:67], v5 offset:16384
  ds_read_b128 a[68:71], v6 offset:16384
  s_add_u32 s96, s96, 128
  s_cmp_eq_u32 s96, 896
  s_cselect_b32 s96, 0, s96
  s_add_u32 m0, s39, 24576
  s_add_u32 s53, s40, s96
  buffer_load_dwordx4 v2, s[4:7], s53 offen lds
  v_mfma_f32_32x32x16_bf16 v[16:31], a[152:155], a[52:55], v[16:31]
  ds_read_b128 a[72:75], v7 offset:16384
  ds_read_b128 a[76:79], v8 offset:16384
  ds_read_b64_tr_b16 a[112:113], v9 offset:32768
  s_add_u32 m0, s39, 25600
  s_add_u32 s54, s41, s96
  buffer_load_dwordx4 v3, s[4:7], s54 offen lds
  s_add_u32 m0, s39, 26624
  s_add_u32 s53, s42, s96
  buffer_load_dwordx4 v2, s[4:7], s53 offen lds
  v_mfma_f32_32x32x16_bf16 v[32:47], a[156:159], a[52:55], v[32:47]
  ds_read_b64_tr_b16 a[114:115], v9 offset:33280
  ds_read_b64_tr_b16 a[116:117], v10 offset:32768
  ds_read_b64_tr_b16 a[118:119], v10 offset:33280
  s_add_u32 m0, s39, 27648
  s_add_u32 s54, s43, s96
  buffer_load_dwordx4 v3, s[4:7], s54 offen lds
  s_add_u32 m0, s45, 0
  v_mfma_f32_32x32x16_bf16 v[16:31], a[160:163], a[56:59], v[16:31]
  s_waitcnt lgkmcnt(2)
  ds_read_b64_tr_b16 a[120:121], v9 offset:34816
  ds_read_b64_tr_b16 a[122:123], v9 offset:35328
  ds_read_b64_tr_b16 a[124:125], v10 offset:34816
  global_load_lds_dwordx4 v172, s[98:99]
  s_add_u32 m0, s45, 1024
  v_mfma_f32_32x32x16_bf16 v[32:47], a[164:167], a[56:59], v[32:47]
  ds_read_b64_tr_b16 a[126:127], v10 offset:35328
  ds_read_b64_tr_b16 a[128:129], v9 offset:36864
  ds_read_b64_tr_b16 a[130:131], v9 offset:37376
  global_load_lds_dwordx4 v173, s[98:99]
  s_add_u32 s98, s44, 0
  s_add_u32 s98, s98, s12
  s_addc_u32 s99, s13, 0
  v_mfma_f32_32x32x16_bf16 v[16:31], a[168:171], a[60:63], v[16:31]
  s_add_u32 m0, s45, 8192
  ds_read_b64_tr_b16 a[132:133], v10 offset:36864
  ds_read_b64_tr_b16 a[134:135], v10 offset:37376
  ds_read_b64_tr_b16 a[136:137], v9 offset:38912
  global_load_lds_dwordx4 v160, s[98:99]
  v_mfma_f32_32x32x16_bf16 v[32:47], a[172:175], a[60:63], v[32:47]
  s_add_u32 m0, s45, 9216
  ds_read_b64_tr_b16 a[138:139], v9 offset:39424
  ds_read_b64_tr_b16 a[140:141], v10 offset:38912
  ds_read_b64_tr_b16 a[142:143], v10 offset:39424
  global_load_lds_dwordx4 v161, s[98:99]
  v_mfma_f32_32x32x16_bf16 v[16:31], a[112:115], a[64:67], v[16:31]
  s_waitcnt lgkmcnt(6)
  s_waitcnt vmcnt(8)
  s_barrier
  v_mfma_f32_32x32x16_bf16 v[32:47], a[116:119], a[64:67], v[32:47]
  s_add_u32 m0, s45, 16384
  ds_read_b128 a[80:83], v5 offset:20480
  ds_read_b128 a[84:87], v6 offset:20480
  v_mfma_f32_32x32x16_bf16 v[16:31], a[120:123], a[68:71], v[16:31]
  ds_read_b128 a[88:91], v7 offset:20480
  ds_read_b128 a[92:95], v8 offset:20480
  ds_read_b64_tr_b16 a[144:145], v9 offset:40960
  global_load_lds_dwordx4 v162, s[98:99]
  v_mfma_f32_32x32x16_bf16 v[32:47], a[124:127], a[68:71], v[32:47]
  s_add_u32 m0, s45, 17408
  ds_read_b64_tr_b16 a[146:147], v9 offset:41472
  ds_read_b64_tr_b16 a[148:149], v10 offset:40960
  ds_read_b64_tr_b16 a[150:151], v10 offset:41472
  v_mfma_f32_32x32x16_bf16 v[16:31], a[128:131], a[72:75], v[16:31]
  s_waitcnt lgkmcnt(2)
  ds_read_b64_tr_b16 a[152:153], v9 offset:43008
  ds_read_b64_tr_b16 a[154:155], v9 offset:43520
  ds_read_b64_tr_b16 a[156:157], v10 offset:43008
  global_load_lds_dwordx4 v163, s[98:99]
  v_mfma_f32_32x32x16_bf16 v[32:47], a[132:135], a[72:75], v[32:47]
  s_add_u32 m0, s45, 24576
  ds_read_b64_tr_b16 a[158:159], v10 offset:43520
  ds_read_b64_tr_b16 a[160:161], v9 offset:45056
  ds_read_b64_tr_b16 a[162:163], v9 offset:45568
  v_mfma_f32_32x32x16_bf16 v[16:31], a[136:139], a[76:79], v[16:31]
  ds_read_b64_tr_b16 a[164:165], v10 offset:45056
  ds_read_b64_tr_b16 a[166:167], v10 offset:45568
  ds_read_b64_tr_b16 a[168:169], v9 offset:47104
  global_load_lds_dwordx4 v164, s[98:99]
  v_mfma_f32_32x32x16_bf16 v[32:47], a[140:143], a[76:79], v[32:47]
  s_add_u32 m0, s45, 25600
  ds_read_b64_tr_b16 a[170:171], v9 offset:47616
  ds_read_b64_tr_b16 a[172:173], v10 offset:47104
  ds_read_b64_tr_b16 a[174:175], v10 offset:47616
  global_load_lds_dwordx4 v165, s[98:99]
  v_mfma_f32_32x32x16_bf16 v[16:31], a[144:147], a[80:83], v[16:31]
  s_waitcnt lgkmcnt(6)
  s_waitcnt vmcnt(6)
  s_barrier
  v_mfma_f32_32x32x16_bf16 v[32:47], a[148:151], a[80:83], v[32:47]
  ds_read_b128 a[96:99], v5 offset:24576
  ds_read_b128 a[100:103], v6 offset:24576
  v_mfma_f32_32x32x16_bf16 v[16:31], a[152:155], a[84:87], v[16:31]
  s_add_u32 m0, s45, 32768
  ds_read_b128 a[104:107], v7 offset:24576
  ds_read_b128 a[108:111], v8 offset:24576
  ds_read_b64_tr_b16 a[112:113], v9 offset:0
  v_mfma_f32_32x32x16_bf16 v[32:47], a[156:159], a[84:87], v[32:47]
  ds_read_b64_tr_b16 a[114:115], v9 offset:512
  ds_read_b64_tr_b16 a[116:117], v10 offset:0
  ds_read_b64_tr_b16 a[118:119], v10 offset:512
  v_mfma_f32_32x32x16_bf16 v[16:31], a[160:163], a[88:91], v[16:31]
  s_waitcnt lgkmcnt(2)
  ds_read_b64_tr_b16 a[120:121], v9 offset:2048
  ds_read_b64_tr_b16 a[122:123], v9 offset:2560
  ds_read_b64_tr_b16 a[124:125], v10 offset:2048
  global_load_lds_dwordx4 v166, s[98:99]
  v_mfma_f32_32x32x16_bf16 v[32:47], a[164:167], a[88:91], v[32:47]
  ds_read_b64_tr_b16 a[126:127], v10 offset:2560
  ds_read_b64_tr_b16 a[128:129], v9 offset:4096
  ds_read_b64_tr_b16 a[130:131], v9 offset:4608
  v_mfma_f32_32x32x16_bf16 v[16:31], a[168:171], a[92:95], v[16:31]
  s_add_u32 m0, s45, 33792
  ds_read_b64_tr_b16 a[132:133], v10 offset:4096
  ds_read_b64_tr_b16 a[134:135], v10 offset:4608
  ds_read_b64_tr_b16 a[136:137], v9 offset:6144
  v_mfma_f32_32x32x16_bf16 v[32:47], a[172:175], a[92:95], v[32:47]
  ds_read_b64_tr_b16 a[138:139], v9 offset:6656
  ds_read_b64_tr_b16 a[140:141], v10 offset:6144
  ds_read_b64_tr_b16 a[142:143], v10 offset:6656
  global_load_lds_dwordx4 v167, s[98:99]
  v_mfma_f32_32x32x16_bf16 v[16:31], a[112:115], a[96:99], v[16:31]
  s_waitcnt lgkmcnt(6)
  s_waitcnt vmcnt(6)
  s_barrier
  v_mfma_f32_32x32x16_bf16 v[32:47], a[116:119], a[96:99], v[32:47]
  ds_read_b64_tr_b16 a[144:145], v9 offset:8192
  ds_read_b64_tr_b16 a[146:147], v9 offset:8704
  v_mfma_f32_32x32x16_bf16 v[16:31], a[120:123], a[100:103], v[16:31]
  s_add_u32 m0, s45, 40960
  ds_read_b64_tr_b16 a[148:149], v10 offset:8192
  ds_read_b64_tr_b16 a[150:151], v10 offset:8704
  v_mfma_f32_32x32x16_bf16 v[32:47], a[124:127], a[100:103], v[32:47]
  ds_read_b64_tr_b16 a[152:153], v9 offset:10240
  ds_read_b64_tr_b16 a[154:155], v9 offset:10752
  v_mfma_f32_32x32x16_bf16 v[16:31], a[128:131], a[104:107], v[16:31]
  s_waitcnt lgkmcnt(4)
  ds_read_b64_tr_b16 a[156:157], v10 offset:10240
  ds_read_b64_tr_b16 a[158:159], v10 offset:10752
  ds_read_b64_tr_b16 a[160:161], v9 offset:12288
  global_load_lds_dwordx4 v168, s[98:99]
  v_mfma_f32_32x32x16_bf16 v[32:47], a[132:135], a[104:107], v[32:47]
  ds_read_b64_tr_b16 a[162:163], v9 offset:12800
  ds_read_b64_tr_b16 a[164:165], v10 offset:12288
  v_mfma_f32_32x32x16_bf16 v[16:31], a[136:139], a[108:111], v[16:31]
  s_add_u32 m0, s45, 41984
  ds_read_b64_tr_b16 a[166:167], v10 offset:12800
  ds_read_b64_tr_b16 a[168:169], v9 offset:14336
  v_mfma_f32_32x32x16_bf16 v[32:47], a[140:143], a[108:111], v[32:47]
  ds_read_b64_tr_b16 a[170:171], v9 offset:14848
  ds_read_b64_tr_b16 a[172:173], v10 offset:14336
  ds_read_b64_tr_b16 a[174:175], v10 offset:14848
  global_load_lds_dwordx4 v169, s[98:99]
  v_add_u32 v15, 2654435769, v15
  v_mfma_f32_32x32x16_bf16 v[48:63], a[144:147], a[0:3], 0
  s_waitcnt lgkmcnt(6)
  s_waitcnt vmcnt(6)
  s_barrier
  v_mfma_f32_32x32x16_bf16 v[64:79], a[148:151], a[0:3], 0
  ds_read_b64_tr_b16 a[112:113], v9 offset:16384
  ds_read_b64_tr_b16 a[114:115], v9 offset:16896
  v_mfma_f32_32x32x16_bf16 v[48:63], a[152:155], a[4:7], v[48:63]
  s_add_u32 m0, s69, 0
  ds_read_b64_tr_b16 a[116:117], v10 offset:16384
  ds_read_b64_tr_b16 a[118:119], v10 offset:16896
  s_lshl_b32 s56, s59, 19
  v_mfma_f32_32x32x16_bf16 v[64:79], a[156:159], a[4:7], v[64:79]
  ds_read_b64_tr_b16 a[120:121], v9 offset:18432
  ds_read_b64_tr_b16 a[122:123], v9 offset:18944
  s_lshl_b32 s57, s37, 12
  s_add_u32 s56, s56, s57
  v_mfma_f32_32x32x16_bf16 v[48:63], a[160:163], a[8:11], v[48:63]
  s_waitcnt lgkmcnt(4)
  ds_read_b64_tr_b16 a[124:125], v10 offset:18432
  ds_read_b64_tr_b16 a[126:127], v10 offset:18944
  ds_read_b64_tr_b16 a[128:129], v9 offset:20480
  global_load_lds_dwordx4 v170, s[98:99]
  s_lshl_b32 s57, s38, 16
  s_add_u32 s56, s56, s57
  v_mfma_f32_32x32x16_bf16 v[64:79], a[164:167], a[8:11], v[64:79]
  ds_read_b64_tr_b16 a[130:131], v9 offset:20992
  ds_read_b64_tr_b16 a[132:133], v10 offset:20480
  s_add_u32 s56, s56, 1048576
  s_add_u32 s57, s56, 0x40000
  v_cvt_pk_bf16_f32 v112, v16, v17
  v_mfma_f32_32x32x16_bf16 v[48:63], a[168:171], a[12:15], v[48:63]
  s_add_u32 m0, s69, 1024
  ds_read_b64_tr_b16 a[134:135], v10 offset:20992
  ds_read_b64_tr_b16 a[136:137], v9 offset:22528
  v_cvt_pk_bf16_f32 v113, v18, v19
  v_cvt_pk_bf16_f32 v114, v20, v21
  v_mfma_f32_32x32x16_bf16 v[64:79], a[172:175], a[12:15], v[64:79]
  ds_read_b64_tr_b16 a[138:139], v9 offset:23040
  ds_read_b64_tr_b16 a[140:141], v10 offset:22528
  ds_read_b64_tr_b16 a[142:143], v10 offset:23040
  global_load_lds_dwordx4 v171, s[98:99]
  v_cvt_pk_bf16_f32 v116, v22, v23
  v_cvt_pk_bf16_f32 v117, v24, v25
  v_cvt_pk_bf16_f32 v118, v26, v27
  v_mfma_f32_32x32x16_bf16 v[48:63], a[112:115], a[16:19], v[48:63]
  s_waitcnt lgkmcnt(6)
  s_waitcnt vmcnt(6)
  s_barrier
  v_cvt_pk_bf16_f32 v115, v28, v29
  v_cvt_pk_bf16_f32 v119, v30, v31
  v_mfma_f32_32x32x16_bf16 v[64:79], a[116:119], a[16:19], v[64:79]
  ds_read_b64_tr_b16 a[144:145], v9 offset:24576
  ds_read_b64_tr_b16 a[146:147], v9 offset:25088
  v_lshrrev_b32 v5, 16, v13
  v_cndmask_b32 v115, v115, v5, s[46:47]
  v_mfma_f32_32x32x16_bf16 v[48:63], a[120:123], a[20:23], v[48:63]
  s_add_u32 m0, s69, 8192
  ds_read_b64_tr_b16 a[148:149], v10 offset:24576
  ds_read_b64_tr_b16 a[150:151], v10 offset:25088
  v_cndmask_b32 v119, v119, v5, s[46:47]
  buffer_store_dwordx4 v[112:115], v1, s[16:19], s56 offen offset:0 sc1
  buffer_store_dwordx4 v[116:119], v1, s[16:19], s56 offen offset:1024 sc1
  v_mfma_f32_32x32x16_bf16 v[64:79], a[124:127], a[20:23], v[64:79]
  ds_read_b64_tr_b16 a[152:153], v9 offset:26624
  ds_read_b64_tr_b16 a[154:155], v9 offset:27136
  v_cvt_pk_bf16_f32 v120, v32, v33
  v_cvt_pk_bf16_f32 v121, v34, v35
  v_mfma_f32_32x32x16_bf16 v[48:63], a[128:131], a[24:27], v[48:63]
  s_waitcnt lgkmcnt(4)
  ds_read_b64_tr_b16 a[156:157], v10 offset:26624
  ds_read_b64_tr_b16 a[158:159], v10 offset:27136
  ds_read_b64_tr_b16 a[160:161], v9 offset:28672
  global_load_lds_dwordx4 v172, s[98:99]
  v_cvt_pk_bf16_f32 v122, v36, v37
  v_cvt_pk_bf16_f32 v124, v38, v39
  v_mfma_f32_32x32x16_bf16 v[64:79], a[132:135], a[24:27], v[64:79]
  ds_read_b64_tr_b16 a[162:163], v9 offset:29184
  ds_read_b64_tr_b16 a[164:165], v10 offset:28672
  v_cvt_pk_bf16_f32 v125, v40, v41
  v_cvt_pk_bf16_f32 v126, v42, v43
  v_cvt_pk_bf16_f32 v123, v44, v45
  v_mfma_f32_32x32x16_bf16 v[48:63], a[136:139], a[28:31], v[48:63]
  s_add_u32 m0, s69, 9216
  ds_read_b64_tr_b16 a[166:167], v10 offset:29184
  ds_read_b64_tr_b16 a[168:169], v9 offset:30720
  v_cvt_pk_bf16_f32 v127, v46, v47
  v_cndmask_b32 v123, v123, v5, s[46:47]
  v_mfma_f32_32x32x16_bf16 v[64:79], a[140:143], a[28:31], v[64:79]
  ds_read_b64_tr_b16 a[170:171], v9 offset:31232
  ds_read_b64_tr_b16 a[172:173], v10 offset:30720
  ds_read_b64_tr_b16 a[174:175], v10 offset:31232
  global_load_lds_dwordx4 v173, s[98:99]
  v_cndmask_b32 v127, v127, v5, s[46:47]
  buffer_store_dwordx4 v[120:123], v1, s[16:19], s57 offen offset:0 sc1
  buffer_store_dwordx4 v[124:127], v1, s[16:19], s57 offen offset:1024 sc1
  v_mfma_f32_32x32x16_bf16 v[48:63], a[144:147], a[32:35], v[48:63]
  s_waitcnt lgkmcnt(6)
  s_waitcnt vmcnt(10)
  s_barrier
  v_mfma_f32_32x32x16_bf16 v[64:79], a[148:151], a[32:35], v[64:79]
  ds_read_b64_tr_b16 a[112:113], v9 offset:32768
  ds_read_b64_tr_b16 a[114:115], v9 offset:33280
  v_mfma_f32_32x32x16_bf16 v[48:63], a[152:155], a[36:39], v[48:63]
  ds_read_b64_tr_b16 a[116:117], v10 offset:32768
  ds_read_b64_tr_b16 a[118:119], v10 offset:33280
  s_add_u32 s98, s44, 0
  s_add_u32 s98, s98, s8
  s_addc_u32 s99, s9, 0
  v_mfma_f32_32x32x16_bf16 v[64:79], a[156:159], a[36:39], v[64:79]
  s_add_u32 m0, s69, 16384
  ds_read_b64_tr_b16 a[120:121], v9 offset:34816
  ds_read_b64_tr_b16 a[122:123], v9 offset:35328
  v_mfma_f32_32x32x16_bf16 v[48:63], a[160:163], a[40:43], v[48:63]
  s_waitcnt lgkmcnt(4)
  ds_read_b64_tr_b16 a[124:125], v10 offset:34816
  ds_read_b64_tr_b16 a[126:127], v10 offset:35328
  ds_read_b64_tr_b16 a[128:129], v9 offset:36864
  v_mfma_f32_32x32x16_bf16 v[64:79], a[164:167], a[40:43], v[64:79]
  ds_read_b64_tr_b16 a[130:131], v9 offset:37376
  ds_read_b64_tr_b16 a[132:133], v10 offset:36864
  global_load_lds_dwordx4 v160, s[98:99]
  v_mfma_f32_32x32x16_bf16 v[48:63], a[168:171], a[44:47], v[48:63]
  s_add_u32 m0, s69, 17408
  ds_read_b64_tr_b16 a[134:135], v10 offset:37376
  ds_read_b64_tr_b16 a[136:137], v9 offset:38912
  v_mfma_f32_32x32x16_bf16 v[64:79], a[172:175], a[44:47], v[64:79]
  ds_read_b64_tr_b16 a[138:139], v9 offset:39424
  ds_read_b64_tr_b16 a[140:141], v10 offset:38912
  ds_read_b64_tr_b16 a[142:143], v10 offset:39424
  global_load_lds_dwordx4 v161, s[98:99]
  v_mfma_f32_32x32x16_bf16 v[48:63], a[112:115], a[48:51], v[48:63]
  s_waitcnt lgkmcnt(6)
  s_waitcnt vmcnt(10)
  s_barrier
  v_mfma_f32_32x32x16_bf16 v[64:79], a[116:119], a[48:51], v[64:79]
  ds_read_b64_tr_b16 a[144:145], v9 offset:40960
  ds_read_b64_tr_b16 a[146:147], v9 offset:41472
  s_add_u32 s4, s63, 4096
  v_mfma_f32_32x32x16_bf16 v[48:63], a[120:123], a[52:55], v[48:63]
  s_add_u32 m0, s69, 24576
  ds_read_b64_tr_b16 a[148:149], v10 offset:40960
  ds_read_b64_tr_b16 a[150:151], v10 offset:41472
  v_mfma_f32_32x32x16_bf16 v[64:79], a[124:127], a[52:55], v[64:79]
  ds_read_b64_tr_b16 a[152:153], v9 offset:43008
  ds_read_b64_tr_b16 a[154:155], v9 offset:43520
  s_add_u32 s4, s4, s16
  s_addc_u32 s5, s17, 0
  v_mfma_f32_32x32x16_bf16 v[48:63], a[128:131], a[56:59], v[48:63]
  s_waitcnt lgkmcnt(4)
  ds_read_b64_tr_b16 a[156:157], v10 offset:43008
  ds_read_b64_tr_b16 a[158:159], v10 offset:43520
  ds_read_b64_tr_b16 a[160:161], v9 offset:45056
  global_load_lds_dwordx4 v162, s[98:99]
  v_xor_b32 v245, v245, v15
  v_mfma_f32_32x32x16_bf16 v[64:79], a[132:135], a[56:59], v[64:79]
  ds_read_b64_tr_b16 a[162:163], v9 offset:45568
  ds_read_b64_tr_b16 a[164:165], v10 offset:45056
  v_mfma_f32_32x32x16_bf16 v[48:63], a[136:139], a[60:63], v[48:63]
  s_add_u32 m0, s69, 25600
  ds_read_b64_tr_b16 a[166:167], v10 offset:45568
  ds_read_b64_tr_b16 a[168:169], v9 offset:47104
  v_cndmask_b32 v245, 0, v245, s[46:47]
  v_mfma_f32_32x32x16_bf16 v[64:79], a[140:143], a[60:63], v[64:79]
  ds_read_b64_tr_b16 a[170:171], v9 offset:47616
  ds_read_b64_tr_b16 a[172:173], v10 offset:47104
  ds_read_b64_tr_b16 a[174:175], v10 offset:47616
  global_load_lds_dwordx4 v163, s[98:99]
  v_and_b32 v207, 0xFFFF0000, v245
  v_mfma_f32_32x32x16_bf16 v[48:63], a[144:147], a[64:67], v[48:63]
  s_waitcnt lgkmcnt(6)
  s_waitcnt vmcnt(10)
  s_barrier
  s_lshl_b32 s55, s59, 2
  v_mfma_f32_32x32x16_bf16 v[64:79], a[148:151], a[64:67], v[64:79]
  ds_read_b64_tr_b16 a[112:113], v200 offset:0
  ds_read_b64_tr_b16 a[114:115], v200 offset:512
  s_add_u32 s55, s55, s38
  v_mfma_f32_32x32x16_bf16 v[48:63], a[152:155], a[68:71], v[48:63]
  s_add_u32 m0, s69, 32768
  ds_read_b64_tr_b16 a[116:117], v201 offset:0
  ds_read_b64_tr_b16 a[118:119], v201 offset:512
  s_lshl_b32 s55, s55, 5
  v_mfma_f32_32x32x16_bf16 v[64:79], a[156:159], a[68:71], v[64:79]
  ds_read_b64_tr_b16 a[120:121], v200 offset:2048
  ds_read_b64_tr_b16 a[122:123], v200 offset:2560
  s_add_u32 s55, s55, s37
  v_mfma_f32_32x32x16_bf16 v[48:63], a[160:163], a[72:75], v[48:63]
  s_waitcnt lgkmcnt(4)
  ds_read_b64_tr_b16 a[124:125], v201 offset:2048
  ds_read_b64_tr_b16 a[126:127], v201 offset:2560
  ds_read_b64_tr_b16 a[128:129], v200 offset:4096
  global_load_lds_dwordx4 v164, s[98:99]
  s_add_u32 s55, s55, 0
  v_mfma_f32_32x32x16_bf16 v[64:79], a[164:167], a[72:75], v[64:79]
  ds_read_b64_tr_b16 a[130:131], v200 offset:4608
  ds_read_b64_tr_b16 a[132:133], v201 offset:4096
  s_lshl_b32 s55, s55, 7
  v_mfma_f32_32x32x16_bf16 v[48:63], a[168:171], a[76:79], v[48:63]
  s_add_u32 m0, s69, 33792
  ds_read_b64_tr_b16 a[134:135], v201 offset:4608
  ds_read_b64_tr_b16 a[136:137], v200 offset:6144
  s_add_u32 s55, s55, 65536
  v_mfma_f32_32x32x16_bf16 v[64:79], a[172:175], a[76:79], v[64:79]
  ds_read_b64_tr_b16 a[138:139], v200 offset:6656
  ds_read_b64_tr_b16 a[140:141], v201 offset:6144
  ds_read_b64_tr_b16 a[142:143], v201 offset:6656
  global_load_lds_dwordx4 v165, s[98:99]
  s_waitcnt vmcnt(6)
  buffer_store_dword v15, v14, s[16:19], s55 offen sc1
  v_mfma_f32_32x32x16_bf16 v[48:63], a[112:115], a[80:83], v[48:63]
  s_waitcnt lgkmcnt(6)
  s_barrier
  v_mfma_f32_32x32x16_bf16 v[64:79], a[116:119], a[80:83], v[64:79]
  ds_read_b64_tr_b16 a[144:145], v200 offset:8192
  ds_read_b64_tr_b16 a[146:147], v200 offset:8704
  s_lshl_b32 s94, s61, 14
  v_mfma_f32_32x32x16_bf16 v[48:63], a[120:123], a[84:87], v[48:63]
  s_add_u32 m0, s69, 40960
  ds_read_b64_tr_b16 a[148:149], v201 offset:8192
  ds_read_b64_tr_b16 a[150:151], v201 offset:8704
  v_mfma_f32_32x32x16_bf16 v[64:79], a[124:127], a[84:87], v[64:79]
  ds_read_b64_tr_b16 a[152:153], v200 offset:10240
  ds_read_b64_tr_b16 a[154:155], v200 offset:10752
  s_lshl_b32 s95, s38, 11
  v_mfma_f32_32x32x16_bf16 v[48:63], a[128:131], a[88:91], v[48:63]
  s_waitcnt lgkmcnt(4)
  ds_read_b64_tr_b16 a[156:157], v201 offset:10240
  ds_read_b64_tr_b16 a[158:159], v201 offset:10752
  ds_read_b64_tr_b16 a[160:161], v200 offset:12288
  global_load_lds_dwordx4 v166, s[98:99]
  s_add_u32 s94, s94, s95
  v_mfma_f32_32x32x16_bf16 v[64:79], a[132:135], a[88:91], v[64:79]
  ds_read_b64_tr_b16 a[162:163], v200 offset:12800
  ds_read_b64_tr_b16 a[164:165], v201 offset:12288
  v_mfma_f32_32x32x16_bf16 v[48:63], a[136:139], a[92:95], v[48:63]
  s_add_u32 m0, s69, 41984
  ds_read_b64_tr_b16 a[166:167], v201 offset:12800
  ds_read_b64_tr_b16 a[168:169], v200 offset:14336
  s_add_u32 s94, s94, 12582912
  v_mfma_f32_32x32x16_bf16 v[64:79], a[140:143], a[92:95], v[64:79]
  ds_read_b64_tr_b16 a[170:171], v200 offset:14848
  ds_read_b64_tr_b16 a[172:173], v201 offset:14336
  ds_read_b64_tr_b16 a[174:175], v201 offset:14848
  global_load_lds_dwordx4 v167, s[98:99]
  s_add_u32 s95, s94, 8192
  v_mfma_f32_32x32x16_bf16 v[48:63], a[144:147], a[96:99], v[48:63]
  s_waitcnt lgkmcnt(6)
  s_waitcnt vmcnt(7)
  s_barrier
  v_mfma_f32_32x32x16_bf16 v[64:79], a[148:151], a[96:99], v[64:79]
  ds_read_b64_tr_b16 a[112:113], v200 offset:16384
  ds_read_b64_tr_b16 a[114:115], v200 offset:16896
  s_lshl_b32 s62, s61, 2
  v_mfma_f32_32x32x16_bf16 v[48:63], a[152:155], a[100:103], v[48:63]
  s_add_u32 m0, s69, 49152
  ds_read_b64_tr_b16 a[116:117], v201 offset:16384
  ds_read_b64_tr_b16 a[118:119], v201 offset:16896
  v_mfma_f32_32x32x16_bf16 v[64:79], a[156:159], a[100:103], v[64:79]
  ds_read_b64_tr_b16 a[120:121], v200 offset:18432
  ds_read_b64_tr_b16 a[122:123], v200 offset:18944
  s_add_u32 s62, s62, s38
  v_mfma_f32_32x32x16_bf16 v[48:63], a[160:163], a[104:107], v[48:63]
  s_waitcnt lgkmcnt(4)
  ds_read_b64_tr_b16 a[124:125], v201 offset:18432
  ds_read_b64_tr_b16 a[126:127], v201 offset:18944
  ds_read_b64_tr_b16 a[128:129], v200 offset:20480
  global_load_lds_dwordx4 v168, s[98:99]
  s_lshl_b32 s62, s62, 7
  v_mfma_f32_32x32x16_bf16 v[64:79], a[164:167], a[104:107], v[64:79]
  ds_read_b64_tr_b16 a[130:131], v200 offset:20992
  ds_read_b64_tr_b16 a[132:133], v201 offset:20480
  v_mfma_f32_32x32x16_bf16 v[48:63], a[168:171], a[108:111], v[48:63]
  s_add_u32 m0, s69, 50176
  ds_read_b64_tr_b16 a[134:135], v201 offset:20992
  ds_read_b64_tr_b16 a[136:137], v200 offset:22528
  s_add_u32 s62, s62, 262144
  v_mfma_f32_32x32x16_bf16 v[64:79], a[172:175], a[108:111], v[64:79]
  ds_read_b64_tr_b16 a[138:139], v200 offset:23040
  ds_read_b64_tr_b16 a[140:141], v201 offset:22528
  ds_read_b64_tr_b16 a[142:143], v201 offset:23040
  global_load_lds_dwordx4 v169, s[98:99]
  v_add_u32 v8, 65536, v1
  v_mfma_f32_32x32x16_bf16 v[16:31], a[112:115], a[0:3], 0
  s_waitcnt lgkmcnt(6)
  s_waitcnt vmcnt(7)
  s_barrier
  s_lshl_b32 s56, s61, 14
  s_lshl_b32 s57, s38, 11
  s_add_u32 s56, s56, s57
  v_mfma_f32_32x32x16_bf16 v[32:47], a[116:119], a[0:3], 0
  ds_read_b64_tr_b16 a[144:145], v200 offset:24576
  ds_read_b64_tr_b16 a[146:147], v200 offset:25088
  s_add_u32 s56, s56, 10485760
  v_mfma_f32_32x32x16_bf16 v[16:31], a[120:123], a[4:7], v[16:31]
  s_add_u32 m0, s69, 57344
  ds_read_b64_tr_b16 a[148:149], v201 offset:24576
  ds_read_b64_tr_b16 a[150:151], v201 offset:25088
  v_pk_mul_f32 v[64:65], v[64:65], v[206:207] op_sel_hi:[1,0]
  v_pk_mul_f32 v[66:67], v[66:67], v[206:207] op_sel_hi:[1,0]
  v_pk_mul_f32 v[68:69], v[68:69], v[206:207] op_sel_hi:[1,0]
  v_pk_mul_f32 v[70:71], v[70:71], v[206:207] op_sel_hi:[1,0]
  v_mfma_f32_32x32x16_bf16 v[32:47], a[124:127], a[4:7], v[32:47]
  ds_read_b64_tr_b16 a[152:153], v200 offset:26624
  ds_read_b64_tr_b16 a[154:155], v200 offset:27136
  v_pk_mul_f32 v[72:73], v[72:73], v[206:207] op_sel_hi:[1,0]
  v_pk_mul_f32 v[74:75], v[74:75], v[206:207] op_sel_hi:[1,0]
  v_pk_mul_f32 v[76:77], v[76:77], v[206:207] op_sel_hi:[1,0]
  v_mfma_f32_32x32x16_bf16 v[16:31], a[128:131], a[8:11], v[16:31]
  s_waitcnt lgkmcnt(4)
  ds_read_b64_tr_b16 a[156:157], v201 offset:26624
  ds_read_b64_tr_b16 a[158:159], v201 offset:27136
  ds_read_b64_tr_b16 a[160:161], v200 offset:28672
  global_load_lds_dwordx4 v170, s[98:99]
  v_pk_mul_f32 v[78:79], v[78:79], v[206:207] op_sel_hi:[1,0]
  v_cvt_pk_bf16_f32 v136, v64, v65
  v_cvt_pk_bf16_f32 v137, v66, v67
  v_mfma_f32_32x32x16_bf16 v[32:47], a[132:135], a[8:11], v[32:47]
  ds_read_b64_tr_b16 a[162:163], v200 offset:29184
  ds_read_b64_tr_b16 a[164:165], v201 offset:28672
  v_cvt_pk_bf16_f32 v138, v68, v69
  v_cvt_pk_bf16_f32 v140, v70, v71
  v_cvt_pk_bf16_f32 v141, v72, v73
  v_cvt_pk_bf16_f32 v142, v74, v75
  v_mfma_f32_32x32x16_bf16 v[16:31], a[136:139], a[12:15], v[16:31]
  s_add_u32 m0, s69, 58368
  ds_read_b64_tr_b16 a[166:167], v201 offset:29184
  ds_read_b64_tr_b16 a[168:169], v200 offset:30720
  v_cvt_pk_bf16_f32 v139, v76, v77
  v_cvt_pk_bf16_f32 v143, v78, v79
  v_cndmask_b32 v139, v139, 0, s[46:47]
  v_mfma_f32_32x32x16_bf16 v[32:47], a[140:143], a[12:15], v[32:47]
  ds_read_b64_tr_b16 a[170:171], v200 offset:31232
  ds_read_b64_tr_b16 a[172:173], v201 offset:30720
  ds_read_b64_tr_b16 a[174:175], v201 offset:31232
  global_load_lds_dwordx4 v171, s[98:99]
  v_cndmask_b32 v143, v143, 0, s[46:47]
  s_nop 1
  v_mfma_f32_32x32x16_bf16 v[96:111], v[120:123], v[136:139], 0
  v_mfma_f32_32x32x16_bf16 v[96:111], v[124:127], v[140:143], v[96:111]
  v_mfma_f32_32x32x16_bf16 v[16:31], a[144:147], a[16:19], v[16:31]
  s_waitcnt lgkmcnt(6)
  s_waitcnt vmcnt(7)
  s_barrier
  v_mfma_f32_32x32x16_bf16 v[32:47], a[148:151], a[16:19], v[32:47]
  ds_read_b64_tr_b16 a[112:113], v200 offset:32768
  ds_read_b64_tr_b16 a[114:115], v200 offset:33280
  v_mfma_f32_32x32x16_bf16 v[16:31], a[152:155], a[20:23], v[16:31]
  s_add_u32 m0, s45, 16384
  ds_read_b64_tr_b16 a[116:117], v201 offset:32768
  ds_read_b64_tr_b16 a[118:119], v201 offset:33280
  s_nop 0
  v_max3_f32 v5, v96, v97, v98
  v_max3_f32 v5, v5, v99, v100
  v_max3_f32 v5, v5, v101, v102
  v_mfma_f32_32x32x16_bf16 v[32:47], a[156:159], a[20:23], v[32:47]
  ds_read_b64_tr_b16 a[120:121], v200 offset:34816
  ds_read_b64_tr_b16 a[122:123], v200 offset:35328
  v_max3_f32 v5, v5, v103, v104
  v_max3_f32 v5, v5, v105, v106
  v_max3_f32 v5, v5, v107, v108
  v_max3_f32 v5, v5, v109, v110
  v_mfma_f32_32x32x16_bf16 v[16:31], a[160:163], a[24:27], v[16:31]
  s_waitcnt lgkmcnt(4)
  ds_read_b64_tr_b16 a[124:125], v201 offset:34816
  ds_read_b64_tr_b16 a[126:127], v201 offset:35328
  ds_read_b64_tr_b16 a[128:129], v200 offset:36864
  global_load_lds_dwordx4 v172, s[98:99]
  v_max_f32 v5, v5, v111
  v_mov_b32 v6, v5
  s_nop 1
  v_permlane32_swap_b32 v6, v5
  v_mfma_f32_32x32x16_bf16 v[32:47], a[164:167], a[24:27], v[32:47]
  ds_read_b64_tr_b16 a[130:131], v200 offset:37376
  ds_read_b64_tr_b16 a[132:133], v201 offset:36864
  v_max_f32 v5, v5, v6
  v_sub_f32 v5, 0, v5
  v_and_b32 v6, 0xFFFF0000, v5
  v_sub_f32 v5, v5, v6
  v_mfma_f32_32x32x16_bf16 v[16:31], a[168:171], a[28:31], v[16:31]
  s_add_u32 m0, s45, 17408
  ds_read_b64_tr_b16 a[134:135], v201 offset:37376
  ds_read_b64_tr_b16 a[136:137], v200 offset:38912
  v_lshrrev_b32 v6, 16, v6
  v_lshrrev_b32 v5, 16, v5
  v_or_b32 v6, v6, v207
  v_or_b32 v5, v5, v207
  v_mfma_f32_32x32x16_bf16 v[32:47], a[172:175], a[28:31], v[32:47]
  ds_read_b64_tr_b16 a[138:139], v200 offset:39424
  ds_read_b64_tr_b16 a[140:141], v201 offset:38912
  ds_read_b64_tr_b16 a[142:143], v201 offset:39424
  global_load_lds_dwordx4 v173, s[98:99]
  v_cndmask_b32 v139, v139, v6, s[46:47]
  v_cndmask_b32 v143, v143, v5, s[46:47]
  buffer_store_dwordx4 v[136:139], v242, s[16:19], s56 offen offset:0 sc1
  buffer_store_dwordx4 v[140:143], v242, s[16:19], s56 offen offset:1024 sc1
  v_mfma_f32_32x32x16_bf16 v[16:31], a[112:115], a[32:35], v[16:31]
  s_waitcnt lgkmcnt(6)
  s_waitcnt vmcnt(8)
  s_barrier
  v_pk_mul_f32 v[48:49], v[48:49], v[206:207] op_sel_hi:[1,0]
  v_pk_mul_f32 v[50:51], v[50:51], v[206:207] op_sel_hi:[1,0]
  v_mfma_f32_32x32x16_bf16 v[32:47], a[116:119], a[32:35], v[32:47]
  ds_read_b64_tr_b16 a[144:145], v200 offset:40960
  ds_read_b64_tr_b16 a[146:147], v200 offset:41472
  v_pk_mul_f32 v[52:53], v[52:53], v[206:207] op_sel_hi:[1,0]
  v_pk_mul_f32 v[54:55], v[54:55], v[206:207] op_sel_hi:[1,0]
  v_pk_mul_f32 v[56:57], v[56:57], v[206:207] op_sel_hi:[1,0]
  v_mfma_f32_32x32x16_bf16 v[16:31], a[120:123], a[36:39], v[16:31]
  ds_read_b64_tr_b16 a[148:149], v201 offset:40960
  ds_read_b64_tr_b16 a[150:151], v201 offset:41472
  v_pk_mul_f32 v[58:59], v[58:59], v[206:207] op_sel_hi:[1,0]
  v_pk_mul_f32 v[60:61], v[60:61], v[206:207] op_sel_hi:[1,0]
  v_pk_mul_f32 v[62:63], v[62:63], v[206:207] op_sel_hi:[1,0]
  v_mfma_f32_32x32x16_bf16 v[32:47], a[124:127], a[36:39], v[32:47]
  ds_read_b64_tr_b16 a[152:153], v200 offset:43008
  ds_read_b64_tr_b16 a[154:155], v200 offset:43520
  v_cvt_pk_bf16_f32 v128, v48, v49
  v_cvt_pk_bf16_f32 v129, v50, v51
  v_cvt_pk_bf16_f32 v130, v52, v53
  v_mfma_f32_32x32x16_bf16 v[16:31], a[128:131], a[40:43], v[16:31]
  s_waitcnt lgkmcnt(4)
  ds_read_b64_tr_b16 a[156:157], v201 offset:43008
  ds_read_b64_tr_b16 a[158:159], v201 offset:43520
  ds_read_b64_tr_b16 a[160:161], v200 offset:45056
  buffer_load_dword v2, v236, s[16:19], 0 offen sc1
  v_cvt_pk_bf16_f32 v132, v54, v55
  v_mfma_f32_32x32x16_bf16 v[32:47], a[132:135], a[40:43], v[32:47]
  ds_read_b64_tr_b16 a[162:163], v200 offset:45568
  ds_read_b64_tr_b16 a[164:165], v201 offset:45056
  v_cvt_pk_bf16_f32 v133, v56, v57
  v_cvt_pk_bf16_f32 v134, v58, v59
  v_cvt_pk_bf16_f32 v131, v60, v61
  v_mfma_f32_32x32x16_bf16 v[16:31], a[136:139], a[44:47], v[16:31]
  ds_read_b64_tr_b16 a[166:167], v201 offset:45568
  ds_read_b64_tr_b16 a[168:169], v200 offset:47104
  v_cvt_pk_bf16_f32 v135, v62, v63
  v_cndmask_b32 v131, v131, 0, s[46:47]
  v_cndmask_b32 v135, v135, 0, s[46:47]
  v_mfma_f32_32x32x16_bf16 v[32:47], a[140:143], a[44:47], v[32:47]
  ds_read_b64_tr_b16 a[170:171], v200 offset:47616
  ds_read_b64_tr_b16 a[172:173], v201 offset:47104
  ds_read_b64_tr_b16 a[174:175], v201 offset:47616
  s_nop 1
  v_mfma_f32_32x32x16_bf16 v[80:95], v[112:115], v[128:131], 0
  v_mfma_f32_32x32x16_bf16 v[80:95], v[116:119], v[132:135], v[80:95]
  v_mfma_f32_32x32x16_bf16 v[16:31], a[144:147], a[48:51], v[16:31]
  s_waitcnt lgkmcnt(6)
  s_waitcnt vmcnt(7)
  s_barrier
  v_mfma_f32_32x32x16_bf16 v[32:47], a[148:151], a[48:51], v[32:47]
  ds_read_b64_tr_b16 a[112:113], v200 offset:49152
  ds_read_b64_tr_b16 a[114:115], v200 offset:49664
  v_mfma_f32_32x32x16_bf16 v[16:31], a[152:155], a[52:55], v[16:31]
  ds_read_b64_tr_b16 a[116:117], v201 offset:49152
  ds_read_b64_tr_b16 a[118:119], v201 offset:49664
  s_nop 1
  v_max3_f32 v5, v80, v81, v82
  v_max3_f32 v5, v5, v83, v84
  v_max3_f32 v5, v5, v85, v86
  v_mfma_f32_32x32x16_bf16 v[32:47], a[156:159], a[52:55], v[32:47]
  ds_read_b64_tr_b16 a[120:121], v200 offset:51200
  ds_read_b64_tr_b16 a[122:123], v200 offset:51712
  v_max3_f32 v5, v5, v87, v88
  v_max3_f32 v5, v5, v89, v90
  v_max3_f32 v5, v5, v91, v92
  v_max3_f32 v5, v5, v93, v94
  v_mfma_f32_32x32x16_bf16 v[16:31], a[160:163], a[56:59], v[16:31]
  s_waitcnt lgkmcnt(4)
  ds_read_b64_tr_b16 a[124:125], v201 offset:51200
  ds_read_b64_tr_b16 a[126:127], v201 offset:51712
  ds_read_b64_tr_b16 a[128:129], v200 offset:53248
  v_max_f32 v5, v5, v95
  v_mov_b32 v6, v5
  s_nop 1
  v_mfma_f32_32x32x16_bf16 v[32:47], a[164:167], a[56:59], v[32:47]
  ds_read_b64_tr_b16 a[130:131], v200 offset:53760
  ds_read_b64_tr_b16 a[132:133], v201 offset:53248
  v_permlane32_swap_b32 v6, v5
  v_max_f32 v5, v5, v6
  v_sub_f32 v5, 0, v5
  v_and_b32 v6, 0xFFFF0000, v5
  v_mfma_f32_32x32x16_bf16 v[16:31], a[168:171], a[60:63], v[16:31]
  ds_read_b64_tr_b16 a[134:135], v201 offset:53760
  ds_read_b64_tr_b16 a[136:137], v200 offset:55296
  v_sub_f32 v5, v5, v6
  v_lshrrev_b32 v6, 16, v6
  v_lshrrev_b32 v5, 16, v5
  v_cndmask_b32 v131, v131, v6, s[46:47]
  v_mfma_f32_32x32x16_bf16 v[32:47], a[172:175], a[60:63], v[32:47]
  ds_read_b64_tr_b16 a[138:139], v200 offset:55808
  ds_read_b64_tr_b16 a[140:141], v201 offset:55296
  ds_read_b64_tr_b16 a[142:143], v201 offset:55808
  v_cndmask_b32 v135, v135, v5, s[46:47]
  s_lshl_b32 s3, s38, 11
  s_add_u32 s3, s3, 65536
  v_add_u32 v6, s3, v1
  ds_write_b128 v6, v[128:131]
  ds_write_b128 v6, v[132:135] offset:1024
  v_mfma_f32_32x32x16_bf16 v[16:31], a[112:115], a[64:67], v[16:31]
  s_waitcnt lgkmcnt(8)
  s_waitcnt vmcnt(5)
  s_barrier
  v_mfma_f32_32x32x16_bf16 v[32:47], a[116:119], a[64:67], v[32:47]
  ds_read_b64_tr_b16 a[144:145], v200 offset:57344
  ds_read_b64_tr_b16 a[146:147], v200 offset:57856
  v_mfma_f32_32x32x16_bf16 v[16:31], a[120:123], a[68:71], v[16:31]
  ds_read_b64_tr_b16 a[148:149], v201 offset:57344
  ds_read_b64_tr_b16 a[150:151], v201 offset:57856
  v_mfma_f32_32x32x16_bf16 v[32:47], a[124:127], a[68:71], v[32:47]
  ds_read_b64_tr_b16 a[152:153], v200 offset:59392
  ds_read_b64_tr_b16 a[154:155], v200 offset:59904
  v_mfma_f32_32x32x16_bf16 v[16:31], a[128:131], a[72:75], v[16:31]
  s_waitcnt lgkmcnt(4)
  ds_read_b64_tr_b16 a[156:157], v201 offset:59392
  ds_read_b64_tr_b16 a[158:159], v201 offset:59904
  ds_read_b64_tr_b16 a[160:161], v200 offset:61440
  v_mfma_f32_32x32x16_bf16 v[32:47], a[132:135], a[72:75], v[32:47]
  ds_read_b64_tr_b16 a[162:163], v200 offset:61952
  ds_read_b64_tr_b16 a[164:165], v201 offset:61440
  v_mfma_f32_32x32x16_bf16 v[16:31], a[136:139], a[76:79], v[16:31]
  ds_read_b64_tr_b16 a[166:167], v201 offset:61952
  ds_read_b64_tr_b16 a[168:169], v200 offset:63488
  v_mfma_f32_32x32x16_bf16 v[32:47], a[140:143], a[76:79], v[32:47]
  ds_read_b64_tr_b16 a[170:171], v200 offset:64000
  ds_read_b64_tr_b16 a[172:173], v201 offset:63488
  ds_read_b64_tr_b16 a[174:175], v201 offset:64000
  v_mfma_f32_32x32x16_bf16 v[16:31], a[144:147], a[80:83], v[16:31]
  s_waitcnt lgkmcnt(6)
  s_waitcnt vmcnt(3)
  s_barrier
  v_mfma_f32_32x32x16_bf16 v[32:47], a[148:151], a[80:83], v[32:47]
  ds_read_b64_tr_b16 a[112:113], v9 offset:16384
  ds_read_b64_tr_b16 a[114:115], v9 offset:16896
  s_waitcnt vmcnt(0)
  v_cmp_ne_u32 vcc, v15, v2
  s_cbranch_vccnz L_oolK0
L_retK0:
  v_mfma_f32_32x32x16_bf16 v[16:31], a[152:155], a[84:87], v[16:31]
  ds_read_b64_tr_b16 a[116:117], v10 offset:16384
  ds_read_b64_tr_b16 a[118:119], v10 offset:16896
  global_load_dwordx4 a[176:179], v1, s[4:5] offset:-4096 sc1
  v_mfma_f32_32x32x16_bf16 v[32:47], a[156:159], a[84:87], v[32:47]
  ds_read_b64_tr_b16 a[120:121], v9 offset:18432
  ds_read_b64_tr_b16 a[122:123], v9 offset:18944
  global_load_dwordx4 a[180:183], v1, s[4:5] offset:-3072 sc1
  v_mfma_f32_32x32x16_bf16 v[16:31], a[160:163], a[88:91], v[16:31]
  s_waitcnt lgkmcnt(4)
  ds_read_b64_tr_b16 a[124:125], v10 offset:18432
  ds_read_b64_tr_b16 a[126:127], v10 offset:18944
  ds_read_b64_tr_b16 a[128:129], v9 offset:20480
  v_mfma_f32_32x32x16_bf16 v[32:47], a[164:167], a[88:91], v[32:47]
  ds_read_b64_tr_b16 a[130:131], v9 offset:20992
  ds_read_b64_tr_b16 a[132:133], v10 offset:20480
  global_load_dwordx4 a[184:187], v1, s[4:5] offset:-2048 sc1
  v_mfma_f32_32x32x16_bf16 v[16:31], a[168:171], a[92:95], v[16:31]
  ds_read_b64_tr_b16 a[134:135], v10 offset:20992
  ds_read_b64_tr_b16 a[136:137], v9 offset:22528
  global_load_dwordx4 a[188:191], v1, s[4:5] offset:-1024 sc1
  v_mfma_f32_32x32x16_bf16 v[32:47], a[172:175], a[92:95], v[32:47]
  ds_read_b64_tr_b16 a[138:139], v9 offset:23040
  ds_read_b64_tr_b16 a[140:141], v10 offset:22528
  ds_read_b64_tr_b16 a[142:143], v10 offset:23040
  global_load_dwordx4 a[192:195], v1, s[4:5] offset:0 sc1
  v_mfma_f32_32x32x16_bf16 v[16:31], a[112:115], a[96:99], v[16:31]
  s_waitcnt lgkmcnt(6)
  v_mfma_f32_32x32x16_bf16 v[32:47], a[116:119], a[96:99], v[32:47]
  v_mfma_f32_32x32x16_bf16 v[16:31], a[120:123], a[100:103], v[16:31]
  global_load_dwordx4 a[196:199], v1, s[4:5] offset:1024 sc1
  v_mfma_f32_32x32x16_bf16 v[32:47], a[124:127], a[100:103], v[32:47]
  v_mfma_f32_32x32x16_bf16 v[16:31], a[128:131], a[104:107], v[16:31]
  s_waitcnt lgkmcnt(0)
  v_mfma_f32_32x32x16_bf16 v[32:47], a[132:135], a[104:107], v[32:47]
  global_load_dwordx4 a[200:203], v1, s[4:5] offset:2048 sc1
  v_mfma_f32_32x32x16_bf16 v[16:31], a[136:139], a[108:111], v[16:31]
  v_mfma_f32_32x32x16_bf16 v[32:47], a[140:143], a[108:111], v[32:47]
  global_load_dwordx4 a[204:207], v1, s[4:5] offset:3072 sc1
  ds_read_b128 v[160:163], v8 offset:0
  ds_read_b128 v[164:167], v8 offset:1024
  ds_read_b128 v[168:171], v8 offset:2048
  ds_read_b128 v[172:175], v8 offset:3072
  ds_read_b128 v[176:179], v8 offset:4096
  ds_read_b128 v[180:183], v8 offset:5120
  ds_read_b128 v[184:187], v8 offset:6144
  ds_read_b128 v[188:191], v8 offset:7168
  s_nop 2
  v_pk_mul_f32 v[220:221], v[32:33], v[224:225] op_sel_hi:[1,0]
  v_pk_mul_f32 v[222:223], v[34:35], v[224:225] op_sel_hi:[1,0]
  v_exp_f32 v220, v220 clamp
  v_exp_f32 v221, v221 clamp
  v_exp_f32 v222, v222 clamp
  v_exp_f32 v223, v223 clamp
  v_max_f32 v32, s52, v32
  v_max_f32 v33, s52, v33
  v_max_f32 v34, s52, v34
  v_max_f32 v35, s52, v35
  v_pk_add_f32 v[32:33], v[32:33], v[220:221]
  v_pk_add_f32 v[34:35], v[34:35], v[222:223]
  v_cvt_pk_bf16_f32 v152, v32, v33
  v_cvt_pk_bf16_f32 v153, v34, v35
  v_pk_mul_f32 v[220:221], v[36:37], v[224:225] op_sel_hi:[1,0]
  v_pk_mul_f32 v[222:223], v[38:39], v[224:225] op_sel_hi:[1,0]
  v_exp_f32 v220, v220 clamp
  v_exp_f32 v221, v221 clamp
  v_exp_f32 v222, v222 clamp
  v_exp_f32 v223, v223 clamp
  v_max_f32 v36, s52, v36
  v_max_f32 v37, s52, v37
  v_max_f32 v38, s52, v38
  v_max_f32 v39, s52, v39
  v_pk_add_f32 v[36:37], v[36:37], v[220:221]
  v_pk_add_f32 v[38:39], v[38:39], v[222:223]
  v_cvt_pk_bf16_f32 v154, v36, v37
  v_cvt_pk_bf16_f32 v155, v38, v39
  v_pk_mul_f32 v[220:221], v[40:41], v[224:225] op_sel_hi:[1,0]
  v_pk_mul_f32 v[222:223], v[42:43], v[224:225] op_sel_hi:[1,0]
  v_exp_f32 v220, v220 clamp
  v_exp_f32 v221, v221 clamp
  v_exp_f32 v222, v222 clamp
  v_exp_f32 v223, v223 clamp
  v_max_f32 v40, s52, v40
  v_max_f32 v41, s52, v41
  v_max_f32 v42, s52, v42
  v_max_f32 v43, s52, v43
  v_pk_add_f32 v[40:41], v[40:41], v[220:221]
  v_pk_add_f32 v[42:43], v[42:43], v[222:223]
  v_cvt_pk_bf16_f32 v156, v40, v41
  v_cvt_pk_bf16_f32 v157, v42, v43
  v_pk_mul_f32 v[220:221], v[44:45], v[224:225] op_sel_hi:[1,0]
  v_pk_mul_f32 v[222:223], v[46:47], v[224:225] op_sel_hi:[1,0]
  v_exp_f32 v220, v220 clamp
  v_exp_f32 v221, v221 clamp
  v_exp_f32 v222, v222 clamp
  v_exp_f32 v223, v223 clamp
  v_max_f32 v44, s52, v44
  v_max_f32 v45, s52, v45
  v_max_f32 v46, s52, v46
  v_max_f32 v47, s52, v47
  v_pk_add_f32 v[44:45], v[44:45], v[220:221]
  v_pk_add_f32 v[46:47], v[46:47], v[222:223]
  v_cvt_pk_bf16_f32 v158, v44, v45
  v_cvt_pk_bf16_f32 v159, v46, v47
  v_cndmask_b32 v158, v158, 0, s[46:47]
  v_cndmask_b32 v159, v159, 0, s[46:47]
  v_pk_mul_f32 v[220:221], v[16:17], v[224:225] op_sel_hi:[1,0]
  v_pk_mul_f32 v[222:223], v[18:19], v[224:225] op_sel_hi:[1,0]
  v_exp_f32 v220, v220 clamp
  v_exp_f32 v221, v221 clamp
  v_exp_f32 v222, v222 clamp
  v_exp_f32 v223, v223 clamp
  v_max_f32 v16, s52, v16
  v_max_f32 v17, s52, v17
  v_max_f32 v18, s52, v18
  v_max_f32 v19, s52, v19
  v_pk_add_f32 v[16:17], v[16:17], v[220:221]
  v_pk_add_f32 v[18:19], v[18:19], v[222:223]
  v_cvt_pk_bf16_f32 v144, v16, v17
  v_cvt_pk_bf16_f32 v145, v18, v19
  v_pk_mul_f32 v[220:221], v[20:21], v[224:225] op_sel_hi:[1,0]
  v_pk_mul_f32 v[222:223], v[22:23], v[224:225] op_sel_hi:[1,0]
  v_exp_f32 v220, v220 clamp
  v_exp_f32 v221, v221 clamp
  v_exp_f32 v222, v222 clamp
  v_exp_f32 v223, v223 clamp
  v_max_f32 v20, s52, v20
  v_max_f32 v21, s52, v21
  v_max_f32 v22, s52, v22
  v_max_f32 v23, s52, v23
  v_pk_add_f32 v[20:21], v[20:21], v[220:221]
  v_pk_add_f32 v[22:23], v[22:23], v[222:223]
  v_cvt_pk_bf16_f32 v146, v20, v21
  v_cvt_pk_bf16_f32 v147, v22, v23
  v_pk_mul_f32 v[220:221], v[24:25], v[224:225] op_sel_hi:[1,0]
  v_pk_mul_f32 v[222:223], v[26:27], v[224:225] op_sel_hi:[1,0]
  v_exp_f32 v220, v220 clamp
  v_exp_f32 v221, v221 clamp
  v_exp_f32 v222, v222 clamp
  v_exp_f32 v223, v223 clamp
  v_max_f32 v24, s52, v24
  v_max_f32 v25, s52, v25
  v_max_f32 v26, s52, v26
  v_max_f32 v27, s52, v27
  v_pk_add_f32 v[24:25], v[24:25], v[220:221]
  v_pk_add_f32 v[26:27], v[26:27], v[222:223]
  v_cvt_pk_bf16_f32 v148, v24, v25
  v_cvt_pk_bf16_f32 v149, v26, v27
  v_pk_mul_f32 v[220:221], v[28:29], v[224:225] op_sel_hi:[1,0]
  v_pk_mul_f32 v[222:223], v[30:31], v[224:225] op_sel_hi:[1,0]
  v_exp_f32 v220, v220 clamp
  v_exp_f32 v221, v221 clamp
  v_exp_f32 v222, v222 clamp
  v_exp_f32 v223, v223 clamp
  v_max_f32 v28, s52, v28
  v_max_f32 v29, s52, v29
  v_max_f32 v30, s52, v30
  v_max_f32 v31, s52, v31
  v_pk_add_f32 v[28:29], v[28:29], v[220:221]
  v_pk_add_f32 v[30:31], v[30:31], v[222:223]
  v_cvt_pk_bf16_f32 v150, v28, v29
  v_cvt_pk_bf16_f32 v151, v30, v31
  v_cndmask_b32 v150, v150, 0, s[46:47]
  v_cndmask_b32 v151, v151, 0, s[46:47]
  buffer_store_dwordx4 v[152:155], v1, s[16:19], s95 offen offset:0 sc1
  buffer_store_dwordx4 v[156:159], v1, s[16:19], s95 offen offset:1024 sc1
  buffer_store_dwordx4 v[144:147], v1, s[16:19], s94 offen offset:0 sc1
  buffer_store_dwordx4 v[148:151], v1, s[16:19], s94 offen offset:1024 sc1
  s_waitcnt lgkmcnt(0)
  s_barrier
  s_branch L_join
L_roleVA:
  v_and_b32 v16, 31, v0
  v_lshl_add_u32 v16, v16, 5, s91
  v_subrev_u32 v17, 896, v16
  v_min_u32 v16, v16, v17
  v_lshrrev_b32 v17, 5, v0
  v_lshl_add_u32 v16, v17, 4, v16
  buffer_load_dwordx4 v[208:211], v16, s[32:35], 0 offen
  s_mov_b32 s94, 1
  s_mov_b32 s95, 1
  s_waitcnt vmcnt(8)
  s_barrier
  ds_read_b128 a[0:3], v5 offset:0
  ds_read_b128 a[4:7], v6 offset:0
  s_add_u32 s96, s96, 128
  s_cmp_eq_u32 s96, 896
  s_cselect_b32 s96, 0, s96
  s_add_u32 m0, s39, 8192
  s_add_u32 s53, s40, s96
  buffer_load_dwordx4 v2, s[4:7], s53 offen lds
  ds_read_b128 a[8:11], v7 offset:0
  ds_read_b128 a[12:15], v8 offset:0
  ds_read_b64_tr_b16 a[112:113], v9 offset:0
  s_add_u32 m0, s39, 9216
  s_add_u32 s54, s41, s96
  buffer_load_dwordx4 v3, s[4:7], s54 offen lds
  ds_read_b64_tr_b16 a[114:115], v9 offset:512
  ds_read_b64_tr_b16 a[116:117], v10 offset:0
  ds_read_b64_tr_b16 a[118:119], v10 offset:512
  s_add_u32 m0, s39, 10240
  s_add_u32 s53, s42, s96
  buffer_load_dwordx4 v2, s[4:7], s53 offen lds
  ds_read_b64_tr_b16 a[120:121], v9 offset:2048
  ds_read_b64_tr_b16 a[122:123], v9 offset:2560
  ds_read_b64_tr_b16 a[124:125], v10 offset:2048
  s_add_u32 m0, s39, 11264
  s_add_u32 s54, s43, s96
  buffer_load_dwordx4 v3, s[4:7], s54 offen lds
  s_add_u32 m0, s45, 16384
  ds_read_b64_tr_b16 a[126:127], v10 offset:2560
  ds_read_b64_tr_b16 a[128:129], v9 offset:4096
  ds_read_b64_tr_b16 a[130:131], v9 offset:4608
  ds_read_b64_tr_b16 a[132:133], v10 offset:4096
  ds_read_b64_tr_b16 a[134:135], v10 offset:4608
  ds_read_b64_tr_b16 a[136:137], v9 offset:6144
  global_load_lds_dwordx4 v164, s[98:99]
  s_add_u32 m0, s45, 17408
  ds_read_b64_tr_b16 a[138:139], v9 offset:6656
  ds_read_b64_tr_b16 a[140:141], v10 offset:6144
  ds_read_b64_tr_b16 a[142:143], v10 offset:6656
  global_load_lds_dwordx4 v165, s[98:99]
  s_waitcnt lgkmcnt(14)
  v_mfma_f32_32x32x16_bf16 v[16:31], a[0:3], a[112:115], 0
  s_waitcnt lgkmcnt(6)
  s_waitcnt vmcnt(7)
  s_barrier
  s_waitcnt vmcnt(6)
  v_cndmask_b32 v212, 0, v208, s[94:95]
  v_cndmask_b32 v213, 0, v209, s[94:95]
  v_cndmask_b32 v214, 0, v210, s[94:95]
  v_mfma_f32_32x32x16_bf16 v[32:47], a[0:3], a[116:119], 0
  ds_read_b128 a[16:19], v5 offset:4096
  ds_read_b128 a[20:23], v6 offset:4096
  s_add_u32 s96, s96, 128
  s_cmp_eq_u32 s96, 896
  s_cselect_b32 s96, 0, s96
  s_add_u32 m0, s39, 12288
  s_add_u32 s53, s40, s96
  buffer_load_dwordx4 v2, s[4:7], s53 offen lds
  v_cndmask_b32 v215, 0, v211, s[94:95]
  s_lshl_b64 s[94:95], s[94:95], 1
  s_nop 0
  v_mfma_f32_32x32x16_bf16 v[80:95], v[212:215], a[0:3], 0
  v_mfma_f32_32x32x16_bf16 v[16:31], a[4:7], a[120:123], v[16:31]
  ds_read_b128 a[24:27], v7 offset:4096
  ds_read_b128 a[28:31], v8 offset:4096
  ds_read_b64_tr_b16 a[144:145], v9 offset:8192
  s_add_u32 m0, s39, 13312
  s_add_u32 s54, s41, s96
  buffer_load_dwordx4 v3, s[4:7], s54 offen lds
  v_cndmask_b32 v216, 0, v208, s[94:95]
  v_cndmask_b32 v217, 0, v209, s[94:95]
  v_cndmask_b32 v218, 0, v210, s[94:95]
  v_mfma_f32_32x32x16_bf16 v[32:47], a[4:7], a[124:127], v[32:47]
  ds_read_b64_tr_b16 a[146:147], v9 offset:8704
  ds_read_b64_tr_b16 a[148:149], v10 offset:8192
  ds_read_b64_tr_b16 a[150:151], v10 offset:8704
  s_add_u32 m0, s39, 14336
  s_add_u32 s53, s42, s96
  buffer_load_dwordx4 v2, s[4:7], s53 offen lds
  v_cndmask_b32 v219, 0, v211, s[94:95]
  s_lshl_b64 s[94:95], s[94:95], 1
  s_nop 0
  v_mfma_f32_32x32x16_bf16 v[80:95], v[216:219], a[4:7], v[80:95]
  v_mfma_f32_32x32x16_bf16 v[16:31], a[8:11], a[128:131], v[16:31]
  s_waitcnt lgkmcnt(2)
  ds_read_b64_tr_b16 a[152:153], v9 offset:10240
  ds_read_b64_tr_b16 a[154:155], v9 offset:10752
  ds_read_b64_tr_b16 a[156:157], v10 offset:10240
  s_add_u32 m0, s39, 15360
  s_add_u32 s54, s43, s96
  buffer_load_dwordx4 v3, s[4:7], s54 offen lds
  v_cndmask_b32 v212, 0, v208, s[94:95]
  v_cndmask_b32 v213, 0, v209, s[94:95]
  v_cndmask_b32 v214, 0, v210, s[94:95]
  v_mfma_f32_32x32x16_bf16 v[32:47], a[8:11], a[132:135], v[32:47]
  s_add_u32 m0, s45, 24576
  ds_read_b64_tr_b16 a[158:159], v10 offset:10752
  ds_read_b64_tr_b16 a[160:161], v9 offset:12288
  ds_read_b64_tr_b16 a[162:163], v9 offset:12800
  v_cndmask_b32 v215, 0, v211, s[94:95]
  s_lshl_b64 s[94:95], s[94:95], 1
  s_nop 0
  v_mfma_f32_32x32x16_bf16 v[80:95], v[212:215], a[8:11], v[80:95]
  v_mfma_f32_32x32x16_bf16 v[16:31], a[12:15], a[136:139], v[16:31]
  ds_read_b64_tr_b16 a[164:165], v10 offset:12288
  ds_read_b64_tr_b16 a[166:167], v10 offset:12800
  ds_read_b64_tr_b16 a[168:169], v9 offset:14336
  global_load_lds_dwordx4 v166, s[98:99]
  v_cndmask_b32 v216, 0, v208, s[94:95]
  v_cndmask_b32 v217, 0, v209, s[94:95]
  v_cndmask_b32 v218, 0, v210, s[94:95]
  v_mfma_f32_32x32x16_bf16 v[32:47], a[12:15], a[140:143], v[32:47]
  s_add_u32 m0, s45, 25600
  ds_read_b64_tr_b16 a[170:171], v9 offset:14848
  ds_read_b64_tr_b16 a[172:173], v10 offset:14336
  ds_read_b64_tr_b16 a[174:175], v10 offset:14848
  global_load_lds_dwordx4 v167, s[98:99]
  v_cndmask_b32 v219, 0, v211, s[94:95]
  s_lshl_b64 s[94:95], s[94:95], 1
  s_nop 0
  v_mfma_f32_32x32x16_bf16 v[80:95], v[216:219], a[12:15], v[80:95]
  v_mfma_f32_32x32x16_bf16 v[16:31], a[16:19], a[144:147], v[16:31]
  s_waitcnt lgkmcnt(6)
  s_waitcnt vmcnt(6)
  s_barrier
  v_cndmask_b32 v212, 0, v208, s[94:95]
  v_cndmask_b32 v213, 0, v209, s[94:95]
  v_cndmask_b32 v214, 0, v210, s[94:95]
  v_mfma_f32_32x32x16_bf16 v[32:47], a[16:19], a[148:151], v[32:47]
  ds_read_b128 a[32:35], v5 offset:8192
  ds_read_b128 a[36:39], v6 offset:8192
  s_add_u32 s96, s96, 128
  s_cmp_eq_u32 s96, 896
  s_cselect_b32 s96, 0, s96
  s_add_u32 m0, s39, 16384
  s_add_u32 s53, s40, s96
  buffer_load_dwordx4 v2, s[4:7], s53 offen lds
  v_cndmask_b32 v215, 0, v211, s[94:95]
  s_lshl_b64 s[94:95], s[94:95], 1
  s_nop 0
  v_mfma_f32_32x32x16_bf16 v[80:95], v[212:215], a[16:19], v[80:95]
  v_mfma_f32_32x32x16_bf16 v[16:31], a[20:23], a[152:155], v[16:31]
  ds_read_b128 a[40:43], v7 offset:8192
  ds_read_b128 a[44:47], v8 offset:8192
  ds_read_b64_tr_b16 a[112:113], v9 offset:16384
  s_add_u32 m0, s39, 17408
  s_add_u32 s54, s41, s96
  buffer_load_dwordx4 v3, s[4:7], s54 offen lds
  v_cndmask_b32 v216, 0, v208, s[94:95]
  v_cndmask_b32 v217, 0, v209, s[94:95]
  v_cndmask_b32 v218, 0, v210, s[94:95]
  v_mfma_f32_32x32x16_bf16 v[32:47], a[20:23], a[156:159], v[32:47]
  ds_read_b64_tr_b16 a[114:115], v9 offset:16896
  ds_read_b64_tr_b16 a[116:117], v10 offset:16384
  ds_read_b64_tr_b16 a[118:119], v10 offset:16896
  s_add_u32 m0, s39, 18432
  s_add_u32 s53, s42, s96
  buffer_load_dwordx4 v2, s[4:7], s53 offen lds
  v_cndmask_b32 v219, 0, v211, s[94:95]
  s_lshl_b64 s[94:95], s[94:95], 1
  s_nop 0
  v_mfma_f32_32x32x16_bf16 v[80:95], v[216:219], a[20:23], v[80:95]
  v_mfma_f32_32x32x16_bf16 v[16:31], a[24:27], a[160:163], v[16:31]
  s_waitcnt lgkmcnt(2)
  ds_read_b64_tr_b16 a[120:121], v9 offset:18432
  ds_read_b64_tr_b16 a[122:123], v9 offset:18944
  ds_read_b64_tr_b16 a[124:125], v10 offset:18432
  s_add_u32 m0, s39, 19456
  s_add_u32 s54, s43, s96
  buffer_load_dwordx4 v3, s[4:7], s54 offen lds
  v_cndmask_b32 v212, 0, v208, s[94:95]
  v_cndmask_b32 v213, 0, v209, s[94:95]
  v_cndmask_b32 v214, 0, v210, s[94:95]
  v_mfma_f32_32x32x16_bf16 v[32:47], a[24:27], a[164:167], v[32:47]
  s_add_u32 m0, s45, 32768
  ds_read_b64_tr_b16 a[126:127], v10 offset:18944
  ds_read_b64_tr_b16 a[128:129], v9 offset:20480
  ds_read_b64_tr_b16 a[130:131], v9 offset:20992
  v_cndmask_b32 v215, 0, v211, s[94:95]
  s_lshl_b64 s[94:95], s[94:95], 1
  s_nop 0
  v_mfma_f32_32x32x16_bf16 v[80:95], v[212:215], a[24:27], v[80:95]
  v_mfma_f32_32x32x16_bf16 v[16:31], a[28:31], a[168:171], v[16:31]
  ds_read_b64_tr_b16 a[132:133], v10 offset:20480
  ds_read_b64_tr_b16 a[134:135], v10 offset:20992
  ds_read_b64_tr_b16 a[136:137], v9 offset:22528
  global_load_lds_dwordx4 v168, s[98:99]
  v_cndmask_b32 v216, 0, v208, s[94:95]
  v_cndmask_b32 v217, 0, v209, s[94:95]
  v_cndmask_b32 v218, 0, v210, s[94:95]
  v_mfma_f32_32x32x16_bf16 v[32:47], a[28:31], a[172:175], v[32:47]
  s_add_u32 m0, s45, 33792
  ds_read_b64_tr_b16 a[138:139], v9 offset:23040
  ds_read_b64_tr_b16 a[140:141], v10 offset:22528
  ds_read_b64_tr_b16 a[142:143], v10 offset:23040
  global_load_lds_dwordx4 v169, s[98:99]
  v_cndmask_b32 v219, 0, v211, s[94:95]
  s_lshl_b64 s[94:95], s[94:95], 1
  s_nop 0
  v_mfma_f32_32x32x16_bf16 v[80:95], v[216:219], a[28:31], v[80:95]
  v_mfma_f32_32x32x16_bf16 v[16:31], a[32:35], a[112:115], v[16:31]
  s_waitcnt lgkmcnt(6)
  s_waitcnt vmcnt(6)
  s_barrier
  v_cndmask_b32 v212, 0, v208, s[94:95]
  v_cndmask_b32 v213, 0, v209, s[94:95]
  v_cndmask_b32 v214, 0, v210, s[94:95]
  v_mfma_f32_32x32x16_bf16 v[32:47], a[32:35], a[116:119], v[32:47]
  ds_read_b128 a[48:51], v5 offset:12288
  ds_read_b128 a[52:55], v6 offset:12288
  s_add_u32 s96, s96, 128
  s_cmp_eq_u32 s96, 896
  s_cselect_b32 s96, 0, s96
  s_add_u32 m0, s39, 20480
  s_add_u32 s53, s40, s96
  buffer_load_dwordx4 v2, s[4:7], s53 offen lds
  v_cndmask_b32 v215, 0, v211, s[94:95]
  s_lshl_b64 s[94:95], s[94:95], 1
  s_nop 0
  v_mfma_f32_32x32x16_bf16 v[80:95], v[212:215], a[32:35], v[80:95]
  v_mfma_f32_32x32x16_bf16 v[16:31], a[36:39], a[120:123], v[16:31]
  ds_read_b128 a[56:59], v7 offset:12288
  ds_read_b128 a[60:63], v8 offset:12288
  ds_read_b64_tr_b16 a[144:145], v9 offset:24576
  s_add_u32 m0, s39, 21504
  s_add_u32 s54, s41, s96
  buffer_load_dwordx4 v3, s[4:7], s54 offen lds
  v_cndmask_b32 v216, 0, v208, s[94:95]
  v_cndmask_b32 v217, 0, v209, s[94:95]
  v_cndmask_b32 v218, 0, v210, s[94:95]
  v_mfma_f32_32x32x16_bf16 v[32:47], a[36:39], a[124:127], v[32:47]
  ds_read_b64_tr_b16 a[146:147], v9 offset:25088
  ds_read_b64_tr_b16 a[148:149], v10 offset:24576
  ds_read_b64_tr_b16 a[150:151], v10 offset:25088
  s_add_u32 m0, s39, 22528
  s_add_u32 s53, s42, s96
  buffer_load_dwordx4 v2, s[4:7], s53 offen lds
  v_cndmask_b32 v219, 0, v211, s[94:95]
  s_lshl_b64 s[94:95], s[94:95], 1
  s_nop 0
  v_mfma_f32_32x32x16_bf16 v[80:95], v[216:219], a[36:39], v[80:95]
  v_mfma_f32_32x32x16_bf16 v[16:31], a[40:43], a[128:131], v[16:31]
  s_waitcnt lgkmcnt(2)
  ds_read_b64_tr_b16 a[152:153], v9 offset:26624
  ds_read_b64_tr_b16 a[154:155], v9 offset:27136
  ds_read_b64_tr_b16 a[156:157], v10 offset:26624
  s_add_u32 m0, s39, 23552
  s_add_u32 s54, s43, s96
  buffer_load_dwordx4 v3, s[4:7], s54 offen lds
  v_cndmask_b32 v212, 0, v208, s[94:95]
  v_cndmask_b32 v213, 0, v209, s[94:95]
  v_cndmask_b32 v214, 0, v210, s[94:95]
  v_mfma_f32_32x32x16_bf16 v[32:47], a[40:43], a[132:135], v[32:47]
  s_add_u32 m0, s45, 40960
  ds_read_b64_tr_b16 a[158:159], v10 offset:27136
  ds_read_b64_tr_b16 a[160:161], v9 offset:28672
  ds_read_b64_tr_b16 a[162:163], v9 offset:29184
  v_cndmask_b32 v215, 0, v211, s[94:95]
  s_lshl_b64 s[94:95], s[94:95], 1
  s_nop 0
  v_mfma_f32_32x32x16_bf16 v[80:95], v[212:215], a[40:43], v[80:95]
  v_mfma_f32_32x32x16_bf16 v[16:31], a[44:47], a[136:139], v[16:31]
  ds_read_b64_tr_b16 a[164:165], v10 offset:28672
  ds_read_b64_tr_b16 a[166:167], v10 offset:29184
  ds_read_b64_tr_b16 a[168:169], v9 offset:30720
  global_load_lds_dwordx4 v170, s[98:99]
  v_cndmask_b32 v216, 0, v208, s[94:95]
  v_cndmask_b32 v217, 0, v209, s[94:95]
  v_cndmask_b32 v218, 0, v210, s[94:95]
  v_mfma_f32_32x32x16_bf16 v[32:47], a[44:47], a[140:143], v[32:47]
  s_add_u32 m0, s45, 41984
  ds_read_b64_tr_b16 a[170:171], v9 offset:31232
  ds_read_b64_tr_b16 a[172:173], v10 offset:30720
  ds_read_b64_tr_b16 a[174:175], v10 offset:31232
  global_load_lds_dwordx4 v171, s[98:99]
  v_cndmask_b32 v219, 0, v211, s[94:95]
  s_lshl_b64 s[94:95], s[94:95], 1
  s_nop 0
  v_mfma_f32_32x32x16_bf16 v[80:95], v[216:219], a[44:47], v[80:95]
  v_mfma_f32_32x32x16_bf16 v[16:31], a[48:51], a[144:147], v[16:31]
  s_waitcnt lgkmcnt(6)
  s_waitcnt vmcnt(6)
  s_barrier
  v_cndmask_b32 v212, 0, v208, s[94:95]
  v_cndmask_b32 v213, 0, v209, s[94:95]
  v_cndmask_b32 v214, 0, v210, s[94:95]
  v_mfma_f32_32x32x16_bf16 v[32:47], a[48:51], a[148:151], v[32:47]
  ds_read_b128 a[64:67], v5 offset:16384
  ds_read_b128 a[68:71], v6 offset:16384
  s_add_u32 s96, s96, 128
  s_cmp_eq_u32 s96, 896
  s_cselect_b32 s96, 0, s96
  s_add_u32 m0, s39, 24576
  s_add_u32 s53, s40, s96
  buffer_load_dwordx4 v2, s[4:7], s53 offen lds
  v_cndmask_b32 v215, 0, v211, s[94:95]
  s_lshl_b64 s[94:95], s[94:95], 1
  s_nop 0
  v_mfma_f32_32x32x16_bf16 v[80:95], v[212:215], a[48:51], v[80:95]
  v_mfma_f32_32x32x16_bf16 v[16:31], a[52:55], a[152:155], v[16:31]
  ds_read_b128 a[72:75], v7 offset:16384
  ds_read_b128 a[76:79], v8 offset:16384
  ds_read_b64_tr_b16 a[112:113], v9 offset:32768
  s_add_u32 m0, s39, 25600
  s_add_u32 s54, s41, s96
  buffer_load_dwordx4 v3, s[4:7], s54 offen lds
  s_add_u32 m0, s39, 26624
  s_add_u32 s53, s42, s96
  buffer_load_dwordx4 v2, s[4:7], s53 offen lds
  v_cndmask_b32 v216, 0, v208, s[94:95]
  v_cndmask_b32 v217, 0, v209, s[94:95]
  v_cndmask_b32 v218, 0, v210, s[94:95]
  v_mfma_f32_32x32x16_bf16 v[32:47], a[52:55], a[156:159], v[32:47]
  ds_read_b64_tr_b16 a[114:115], v9 offset:33280
  ds_read_b64_tr_b16 a[116:117], v10 offset:32768
  ds_read_b64_tr_b16 a[118:119], v10 offset:33280
  s_add_u32 m0, s39, 27648
  s_add_u32 s54, s43, s96
  buffer_load_dwordx4 v3, s[4:7], s54 offen lds
  s_add_u32 m0, s45, 0
  v_cndmask_b32 v219, 0, v211, s[94:95]
  s_lshl_b64 s[94:95], s[94:95], 1
  s_nop 0
  v_mfma_f32_32x32x16_bf16 v[80:95], v[216:219], a[52:55], v[80:95]
  v_mfma_f32_32x32x16_bf16 v[16:31], a[56:59], a[160:163], v[16:31]
  s_waitcnt lgkmcnt(2)
  ds_read_b64_tr_b16 a[120:121], v9 offset:34816
  ds_read_b64_tr_b16 a[122:123], v9 offset:35328
  ds_read_b64_tr_b16 a[124:125], v10 offset:34816
  global_load_lds_dwordx4 v172, s[98:99]
  s_add_u32 m0, s45, 1024
  v_cndmask_b32 v212, 0, v208, s[94:95]
  v_cndmask_b32 v213, 0, v209, s[94:95]
  v_cndmask_b32 v214, 0, v210, s[94:95]
  v_mfma_f32_32x32x16_bf16 v[32:47], a[56:59], a[164:167], v[32:47]
  ds_read_b64_tr_b16 a[126:127], v10 offset:35328
  ds_read_b64_tr_b16 a[128:129], v9 offset:36864
  ds_read_b64_tr_b16 a[130:131], v9 offset:37376
  global_load_lds_dwordx4 v173, s[98:99]
  s_add_u32 s98, s44, 896
  s_add_u32 s98, s98, s8
  s_addc_u32 s99, s9, 0
  v_cndmask_b32 v215, 0, v211, s[94:95]
  s_lshl_b64 s[94:95], s[94:95], 1
  s_nop 0
  v_mfma_f32_32x32x16_bf16 v[80:95], v[212:215], a[56:59], v[80:95]
  v_mfma_f32_32x32x16_bf16 v[16:31], a[60:63], a[168:171], v[16:31]
  s_add_u32 m0, s45, 8192
  ds_read_b64_tr_b16 a[132:133], v10 offset:36864
  ds_read_b64_tr_b16 a[134:135], v10 offset:37376
  ds_read_b64_tr_b16 a[136:137], v9 offset:38912
  global_load_lds_dwordx4 v160, s[98:99]
  v_cndmask_b32 v216, 0, v208, s[94:95]
  v_cndmask_b32 v217, 0, v209, s[94:95]
  v_cndmask_b32 v218, 0, v210, s[94:95]
  v_mfma_f32_32x32x16_bf16 v[32:47], a[60:63], a[172:175], v[32:47]
  s_add_u32 m0, s45, 9216
  ds_read_b64_tr_b16 a[138:139], v9 offset:39424
  ds_read_b64_tr_b16 a[140:141], v10 offset:38912
  ds_read_b64_tr_b16 a[142:143], v10 offset:39424
  global_load_lds_dwordx4 v161, s[98:99]
  v_cndmask_b32 v219, 0, v211, s[94:95]
  s_lshl_b64 s[94:95], s[94:95], 1
  s_nop 0
  v_mfma_f32_32x32x16_bf16 v[80:95], v[216:219], a[60:63], v[80:95]
  v_mfma_f32_32x32x16_bf16 v[16:31], a[64:67], a[112:115], v[16:31]
  s_waitcnt lgkmcnt(6)
  s_waitcnt vmcnt(8)
  s_barrier
  v_cndmask_b32 v212, 0, v208, s[94:95]
  v_cndmask_b32 v213, 0, v209, s[94:95]
  v_cndmask_b32 v214, 0, v210, s[94:95]
  v_mfma_f32_32x32x16_bf16 v[32:47], a[64:67], a[116:119], v[32:47]
  s_add_u32 m0, s45, 16384
  ds_read_b128 a[80:83], v5 offset:20480
  ds_read_b128 a[84:87], v6 offset:20480
  v_cndmask_b32 v215, 0, v211, s[94:95]
  s_lshl_b64 s[94:95], s[94:95], 1
  s_nop 0
  v_mfma_f32_32x32x16_bf16 v[80:95], v[212:215], a[64:67], v[80:95]
  v_mfma_f32_32x32x16_bf16 v[16:31], a[68:71], a[120:123], v[16:31]
  ds_read_b128 a[88:91], v7 offset:20480
  ds_read_b128 a[92:95], v8 offset:20480
  ds_read_b64_tr_b16 a[144:145], v9 offset:40960
  global_load_lds_dwordx4 v162, s[98:99]
  v_cndmask_b32 v216, 0, v208, s[94:95]
  v_cndmask_b32 v217, 0, v209, s[94:95]
  v_cndmask_b32 v218, 0, v210, s[94:95]
  v_mfma_f32_32x32x16_bf16 v[32:47], a[68:71], a[124:127], v[32:47]
  s_add_u32 m0, s45, 17408
  ds_read_b64_tr_b16 a[146:147], v9 offset:41472
  ds_read_b64_tr_b16 a[148:149], v10 offset:40960
  ds_read_b64_tr_b16 a[150:151], v10 offset:41472
  v_cndmask_b32 v219, 0, v211, s[94:95]
  s_lshl_b64 s[94:95], s[94:95], 1
  s_nop 0
  v_mfma_f32_32x32x16_bf16 v[80:95], v[216:219], a[68:71], v[80:95]
  v_mfma_f32_32x32x16_bf16 v[16:31], a[72:75], a[128:131], v[16:31]
  s_waitcnt lgkmcnt(2)
  ds_read_b64_tr_b16 a[152:153], v9 offset:43008
  ds_read_b64_tr_b16 a[154:155], v9 offset:43520
  ds_read_b64_tr_b16 a[156:157], v10 offset:43008
  global_load_lds_dwordx4 v163, s[98:99]
  v_cndmask_b32 v212, 0, v208, s[94:95]
  v_cndmask_b32 v213, 0, v209, s[94:95]
  v_cndmask_b32 v214, 0, v210, s[94:95]
  v_mfma_f32_32x32x16_bf16 v[32:47], a[72:75], a[132:135], v[32:47]
  s_add_u32 m0, s45, 24576
  ds_read_b64_tr_b16 a[158:159], v10 offset:43520
  ds_read_b64_tr_b16 a[160:161], v9 offset:45056
  ds_read_b64_tr_b16 a[162:163], v9 offset:45568
  v_cndmask_b32 v215, 0, v211, s[94:95]
  s_lshl_b64 s[94:95], s[94:95], 1
  s_nop 0
  v_mfma_f32_32x32x16_bf16 v[80:95], v[212:215], a[72:75], v[80:95]
  v_mfma_f32_32x32x16_bf16 v[16:31], a[76:79], a[136:139], v[16:31]
  ds_read_b64_tr_b16 a[164:165], v10 offset:45056
  ds_read_b64_tr_b16 a[166:167], v10 offset:45568
  ds_read_b64_tr_b16 a[168:169], v9 offset:47104
  global_load_lds_dwordx4 v164, s[98:99]
  v_cndmask_b32 v216, 0, v208, s[94:95]
  v_cndmask_b32 v217, 0, v209, s[94:95]
  v_cndmask_b32 v218, 0, v210, s[94:95]
  v_mfma_f32_32x32x16_bf16 v[32:47], a[76:79], a[140:143], v[32:47]
  s_add_u32 m0, s45, 25600
  ds_read_b64_tr_b16 a[170:171], v9 offset:47616
  ds_read_b64_tr_b16 a[172:173], v10 offset:47104
  ds_read_b64_tr_b16 a[174:175], v10 offset:47616
  global_load_lds_dwordx4 v165, s[98:99]
  v_cndmask_b32 v219, 0, v211, s[94:95]
  s_lshl_b64 s[94:95], s[94:95], 1
  s_nop 0
  v_mfma_f32_32x32x16_bf16 v[80:95], v[216:219], a[76:79], v[80:95]
  v_mfma_f32_32x32x16_bf16 v[16:31], a[80:83], a[144:147], v[16:31]
  s_waitcnt lgkmcnt(6)
  s_waitcnt vmcnt(6)
  s_barrier
  v_cndmask_b32 v212, 0, v208, s[94:95]
  v_cndmask_b32 v213, 0, v209, s[94:95]
  v_cndmask_b32 v214, 0, v210, s[94:95]
  v_mfma_f32_32x32x16_bf16 v[32:47], a[80:83], a[148:151], v[32:47]
  ds_read_b128 a[96:99], v5 offset:24576
  ds_read_b128 a[100:103], v6 offset:24576
  v_cndmask_b32 v215, 0, v211, s[94:95]
  s_lshl_b64 s[94:95], s[94:95], 1
  s_nop 0
  v_mfma_f32_32x32x16_bf16 v[80:95], v[212:215], a[80:83], v[80:95]
  v_mfma_f32_32x32x16_bf16 v[16:31], a[84:87], a[152:155], v[16:31]
  s_add_u32 m0, s45, 32768
  ds_read_b128 a[104:107], v7 offset:24576
  ds_read_b128 a[108:111], v8 offset:24576
  ds_read_b64_tr_b16 a[112:113], v9 offset:0
  v_cndmask_b32 v216, 0, v208, s[94:95]
  v_cndmask_b32 v217, 0, v209, s[94:95]
  v_cndmask_b32 v218, 0, v210, s[94:95]
  v_mfma_f32_32x32x16_bf16 v[32:47], a[84:87], a[156:159], v[32:47]
  ds_read_b64_tr_b16 a[114:115], v9 offset:512
  ds_read_b64_tr_b16 a[116:117], v10 offset:0
  ds_read_b64_tr_b16 a[118:119], v10 offset:512
  v_cndmask_b32 v219, 0, v211, s[94:95]
  s_lshl_b64 s[94:95], s[94:95], 1
  s_nop 0
  v_mfma_f32_32x32x16_bf16 v[80:95], v[216:219], a[84:87], v[80:95]
  v_mfma_f32_32x32x16_bf16 v[16:31], a[88:91], a[160:163], v[16:31]
  s_waitcnt lgkmcnt(2)
  ds_read_b64_tr_b16 a[120:121], v9 offset:2048
  ds_read_b64_tr_b16 a[122:123], v9 offset:2560
  ds_read_b64_tr_b16 a[124:125], v10 offset:2048
  global_load_lds_dwordx4 v166, s[98:99]
  v_cndmask_b32 v212, 0, v208, s[94:95]
  v_cndmask_b32 v213, 0, v209, s[94:95]
  v_cndmask_b32 v214, 0, v210, s[94:95]
  v_mfma_f32_32x32x16_bf16 v[32:47], a[88:91], a[164:167], v[32:47]
  ds_read_b64_tr_b16 a[126:127], v10 offset:2560
  ds_read_b64_tr_b16 a[128:129], v9 offset:4096
  ds_read_b64_tr_b16 a[130:131], v9 offset:4608
  v_cndmask_b32 v215, 0, v211, s[94:95]
  s_lshl_b64 s[94:95], s[94:95], 1
  s_nop 0
  v_mfma_f32_32x32x16_bf16 v[80:95], v[212:215], a[88:91], v[80:95]
  v_mfma_f32_32x32x16_bf16 v[16:31], a[92:95], a[168:171], v[16:31]
  s_add_u32 m0, s45, 33792
  ds_read_b64_tr_b16 a[132:133], v10 offset:4096
  ds_read_b64_tr_b16 a[134:135], v10 offset:4608
  ds_read_b64_tr_b16 a[136:137], v9 offset:6144
  v_cndmask_b32 v216, 0, v208, s[94:95]
  v_cndmask_b32 v217, 0, v209, s[94:95]
  v_cndmask_b32 v218, 0, v210, s[94:95]
  v_mfma_f32_32x32x16_bf16 v[32:47], a[92:95], a[172:175], v[32:47]
  ds_read_b64_tr_b16 a[138:139], v9 offset:6656
  ds_read_b64_tr_b16 a[140:141], v10 offset:6144
  ds_read_b64_tr_b16 a[142:143], v10 offset:6656
  global_load_lds_dwordx4 v167, s[98:99]
  v_cndmask_b32 v219, 0, v211, s[94:95]
  s_lshl_b64 s[94:95], s[94:95], 1
  s_nop 0
  v_mfma_f32_32x32x16_bf16 v[80:95], v[216:219], a[92:95], v[80:95]
  v_mfma_f32_32x32x16_bf16 v[16:31], a[96:99], a[112:115], v[16:31]
  s_waitcnt lgkmcnt(6)
  s_waitcnt vmcnt(6)
  s_barrier
  v_add_u32 v15, 2654435769, v15
  v_cndmask_b32 v212, 0, v208, s[94:95]
  v_cndmask_b32 v213, 0, v209, s[94:95]
  v_mfma_f32_32x32x16_bf16 v[32:47], a[96:99], a[116:119], v[32:47]
  ds_read_b64_tr_b16 a[144:145], v9 offset:8192
  ds_read_b64_tr_b16 a[146:147], v9 offset:8704
  v_cndmask_b32 v214, 0, v210, s[94:95]
  v_cndmask_b32 v215, 0, v211, s[94:95]
  s_lshl_b64 s[94:95], s[94:95], 1
  s_nop 0
  v_mfma_f32_32x32x16_bf16 v[16:31], a[100:103], a[120:123], v[16:31]
  s_add_u32 m0, s45, 40960
  ds_read_b64_tr_b16 a[148:149], v10 offset:8192
  ds_read_b64_tr_b16 a[150:151], v10 offset:8704
  v_mfma_f32_32x32x16_bf16 v[80:95], v[212:215], a[96:99], v[80:95]
  v_cndmask_b32 v216, 0, v208, s[94:95]
  v_cndmask_b32 v217, 0, v209, s[94:95]
  v_mfma_f32_32x32x16_bf16 v[32:47], a[100:103], a[124:127], v[32:47]
  ds_read_b64_tr_b16 a[152:153], v9 offset:10240
  ds_read_b64_tr_b16 a[154:155], v9 offset:10752
  v_cndmask_b32 v218, 0, v210, s[94:95]
  v_cndmask_b32 v219, 0, v211, s[94:95]
  s_lshl_b64 s[94:95], s[94:95], 1
  s_nop 0
  v_mfma_f32_32x32x16_bf16 v[16:31], a[104:107], a[128:131], v[16:31]
  s_waitcnt lgkmcnt(4)
  ds_read_b64_tr_b16 a[156:157], v10 offset:10240
  ds_read_b64_tr_b16 a[158:159], v10 offset:10752
  ds_read_b64_tr_b16 a[160:161], v9 offset:12288
  global_load_lds_dwordx4 v168, s[98:99]
  v_mfma_f32_32x32x16_bf16 v[80:95], v[216:219], a[100:103], v[80:95]
  v_cndmask_b32 v212, 0, v208, s[94:95]
  v_cndmask_b32 v213, 0, v209, s[94:95]
  v_cndmask_b32 v214, 0, v210, s[94:95]
  v_mfma_f32_32x32x16_bf16 v[32:47], a[104:107], a[132:135], v[32:47]
  ds_read_b64_tr_b16 a[162:163], v9 offset:12800
  ds_read_b64_tr_b16 a[164:165], v10 offset:12288
  v_cndmask_b32 v215, 0, v211, s[94:95]
  s_lshl_b64 s[94:95], s[94:95], 1
  s_nop 0
  v_mfma_f32_32x32x16_bf16 v[16:31], a[108:111], a[136:139], v[16:31]
  s_add_u32 m0, s45, 41984
  ds_read_b64_tr_b16 a[166:167], v10 offset:12800
  ds_read_b64_tr_b16 a[168:169], v9 offset:14336
  v_mfma_f32_32x32x16_bf16 v[80:95], v[212:215], a[104:107], v[80:95]
  v_cndmask_b32 v216, 0, v208, s[94:95]
  v_cndmask_b32 v217, 0, v209, s[94:95]
  v_cndmask_b32 v218, 0, v210, s[94:95]
  v_mfma_f32_32x32x16_bf16 v[32:47], a[108:111], a[140:143], v[32:47]
  ds_read_b64_tr_b16 a[170:171], v9 offset:14848
  ds_read_b64_tr_b16 a[172:173], v10 offset:14336
  ds_read_b64_tr_b16 a[174:175], v10 offset:14848
  global_load_lds_dwordx4 v169, s[98:99]
  v_cndmask_b32 v219, 0, v211, s[94:95]
  s_lshl_b64 s[94:95], s[94:95], 1
  s_nop 0
  v_mfma_f32_32x32x16_bf16 v[80:95], v[216:219], a[108:111], v[80:95]
  v_mfma_f32_32x32x16_bf16 v[48:63], a[0:3], a[144:147], 0
  s_waitcnt lgkmcnt(6)
  s_waitcnt vmcnt(6)
  s_barrier
  v_mfma_f32_32x32x16_bf16 v[64:79], a[0:3], a[148:151], 0
  ds_read_b64_tr_b16 a[112:113], v9 offset:16384
  ds_read_b64_tr_b16 a[114:115], v9 offset:16896
  s_lshl_b32 s56, s59, 19
  s_lshl_b32 s57, s37, 12
  s_add_u32 s56, s56, s57
  s_lshl_b32 s57, s38, 16
  v_mfma_f32_32x32x16_bf16 v[48:63], a[4:7], a[152:155], v[48:63]
  s_add_u32 m0, s69, 0
  ds_read_b64_tr_b16 a[116:117], v10 offset:16384
  ds_read_b64_tr_b16 a[118:119], v10 offset:16896
  s_add_u32 s56, s56, s57
  s_add_u32 s56, s56, 1050624
  s_add_u32 s57, s56, 0x40000
  v_cvt_pk_bf16_f32 v112, v16, v17
  v_cvt_pk_bf16_f32 v113, v18, v19
  v_mfma_f32_32x32x16_bf16 v[64:79], a[4:7], a[156:159], v[64:79]
  ds_read_b64_tr_b16 a[120:121], v9 offset:18432
  ds_read_b64_tr_b16 a[122:123], v9 offset:18944
  v_cvt_pk_bf16_f32 v114, v20, v21
  v_cvt_pk_bf16_f32 v115, v22, v23
  v_cvt_pk_bf16_f32 v116, v24, v25
  v_cvt_pk_bf16_f32 v117, v26, v27
  v_cvt_pk_bf16_f32 v118, v28, v29
  v_mfma_f32_32x32x16_bf16 v[48:63], a[8:11], a[160:163], v[48:63]
  s_waitcnt lgkmcnt(4)
  ds_read_b64_tr_b16 a[124:125], v10 offset:18432
  ds_read_b64_tr_b16 a[126:127], v10 offset:18944
  ds_read_b64_tr_b16 a[128:129], v9 offset:20480
  global_load_lds_dwordx4 v170, s[98:99]
  v_cvt_pk_bf16_f32 v119, v30, v31
  v_cndmask_b32 v112, v112, v12, s[48:49]
  v_cndmask_b32 v113, v113, v12, s[48:49]
  v_cndmask_b32 v114, v114, v12, s[48:49]
  v_cndmask_b32 v115, v115, v12, s[48:49]
  v_mfma_f32_32x32x16_bf16 v[64:79], a[8:11], a[164:167], v[64:79]
  ds_read_b64_tr_b16 a[130:131], v9 offset:20992
  ds_read_b64_tr_b16 a[132:133], v10 offset:20480
  v_cndmask_b32 v116, v116, v12, s[48:49]
  v_cndmask_b32 v117, v117, v12, s[48:49]
  v_cndmask_b32 v118, v118, v12, s[48:49]
  v_cndmask_b32 v119, v119, v12, s[48:49]
  buffer_store_dwordx4 v[112:115], v1, s[16:19], s56 offen offset:0 sc1
  v_mfma_f32_32x32x16_bf16 v[48:63], a[12:15], a[168:171], v[48:63]
  s_add_u32 m0, s69, 1024
  ds_read_b64_tr_b16 a[134:135], v10 offset:20992
  ds_read_b64_tr_b16 a[136:137], v9 offset:22528
  buffer_store_dwordx4 v[116:119], v1, s[16:19], s56 offen offset:1024 sc1
  v_cvt_pk_bf16_f32 v120, v32, v33
  v_cvt_pk_bf16_f32 v121, v34, v35
  v_cvt_pk_bf16_f32 v122, v36, v37
  v_cvt_pk_bf16_f32 v123, v38, v39
  v_mfma_f32_32x32x16_bf16 v[64:79], a[12:15], a[172:175], v[64:79]
  ds_read_b64_tr_b16 a[138:139], v9 offset:23040
  ds_read_b64_tr_b16 a[140:141], v10 offset:22528
  ds_read_b64_tr_b16 a[142:143], v10 offset:23040
  global_load_lds_dwordx4 v171, s[98:99]
  v_cvt_pk_bf16_f32 v124, v40, v41
  v_cvt_pk_bf16_f32 v125, v42, v43
  v_cvt_pk_bf16_f32 v126, v44, v45
  v_cvt_pk_bf16_f32 v127, v46, v47
  v_cndmask_b32 v120, v120, v12, s[48:49]
  v_mfma_f32_32x32x16_bf16 v[48:63], a[16:19], a[112:115], v[48:63]
  s_waitcnt lgkmcnt(6)
  s_waitcnt vmcnt(8)
  s_barrier
  v_cndmask_b32 v121, v121, v12, s[48:49]
  v_cndmask_b32 v122, v122, v12, s[48:49]
  v_cndmask_b32 v123, v123, v12, s[48:49]
  v_cndmask_b32 v124, v124, v12, s[48:49]
  v_cndmask_b32 v125, v125, v12, s[48:49]
  v_mfma_f32_32x32x16_bf16 v[64:79], a[16:19], a[116:119], v[64:79]
  ds_read_b64_tr_b16 a[144:145], v9 offset:24576
  ds_read_b64_tr_b16 a[146:147], v9 offset:25088
  v_cndmask_b32 v126, v126, v12, s[48:49]
  v_cndmask_b32 v127, v127, v12, s[48:49]
  buffer_store_dwordx4 v[120:123], v1, s[16:19], s57 offen offset:0 sc1
  buffer_store_dwordx4 v[124:127], v1, s[16:19], s57 offen offset:1024 sc1
  v_pk_add_f32 v[80:81], v[80:81], v[88:89]
  v_mfma_f32_32x32x16_bf16 v[48:63], a[20:23], a[120:123], v[48:63]
  s_add_u32 m0, s69, 8192
  ds_read_b64_tr_b16 a[148:149], v10 offset:24576
  ds_read_b64_tr_b16 a[150:151], v10 offset:25088
  v_pk_add_f32 v[82:83], v[82:83], v[90:91]
  v_pk_add_f32 v[84:85], v[84:85], v[92:93]
  v_pk_add_f32 v[86:87], v[86:87], v[94:95]
  v_pk_add_f32 v[80:81], v[80:81], v[84:85]
  v_pk_add_f32 v[82:83], v[82:83], v[86:87]
  v_mfma_f32_32x32x16_bf16 v[64:79], a[20:23], a[124:127], v[64:79]
  ds_read_b64_tr_b16 a[152:153], v9 offset:26624
  ds_read_b64_tr_b16 a[154:155], v9 offset:27136
  v_pk_add_f32 v[80:81], v[80:81], v[82:83]
  v_add_f32 v80, v80, v81
  v_mov_b32 v203, v80
  v_mov_b32 v204, v80
  s_nop 1
  v_mfma_f32_32x32x16_bf16 v[48:63], a[24:27], a[128:131], v[48:63]
  s_waitcnt lgkmcnt(4)
  ds_read_b64_tr_b16 a[156:157], v10 offset:26624
  ds_read_b64_tr_b16 a[158:159], v10 offset:27136
  ds_read_b64_tr_b16 a[160:161], v9 offset:28672
  global_load_lds_dwordx4 v172, s[98:99]
  v_permlane32_swap_b32 v203, v204
  v_add_f32 v204, v204, v203
  v_cvt_pk_bf16_f32 v204, v204, 0
  v_lshlrev_b32 v204, 16, v204
  v_mul_f32 v204, s51, v204
  v_mfma_f32_32x32x16_bf16 v[64:79], a[24:27], a[132:135], v[64:79]
  ds_read_b64_tr_b16 a[162:163], v9 offset:29184
  ds_read_b64_tr_b16 a[164:165], v10 offset:28672
  v_exp_f32 v204, -v204
  s_lshl_b32 s55, s61, 9
  v_add_f32 v204, 1.0, v204
  v_rcp_f32 v204, v204
  s_lshl_b32 s56, s38, 7
  v_mfma_f32_32x32x16_bf16 v[48:63], a[28:31], a[136:139], v[48:63]
  s_add_u32 m0, s69, 9216
  ds_read_b64_tr_b16 a[166:167], v10 offset:29184
  ds_read_b64_tr_b16 a[168:169], v9 offset:30720
  v_cvt_pk_bf16_f32 v204, v204, 0
  v_lshlrev_b32 v204, 16, v204
  v_sub_f32 v203, 1.0, v204
  v_cvt_pk_bf16_f32 v204, v204, v203
  s_add_u32 s55, s55, s56
  v_mfma_f32_32x32x16_bf16 v[64:79], a[28:31], a[140:143], v[64:79]
  ds_read_b64_tr_b16 a[170:171], v9 offset:31232
  ds_read_b64_tr_b16 a[172:173], v10 offset:30720
  ds_read_b64_tr_b16 a[174:175], v10 offset:31232
  global_load_lds_dwordx4 v173, s[98:99]
  s_add_u32 s55, s55, 14680064
  v_lshrrev_b32 v203, 5, v0
  v_lshlrev_b32 v203, 30, v203
  v_lshl_add_u32 v203, v0, 2, v203
  buffer_store_dword v204, v203, s[16:19], s55 offen sc1
  v_mfma_f32_32x32x16_bf16 v[48:63], a[32:35], a[144:147], v[48:63]
  s_waitcnt lgkmcnt(6)
  s_waitcnt vmcnt(11)
  s_barrier
  v_mfma_f32_32x32x16_bf16 v[64:79], a[32:35], a[148:151], v[64:79]
  ds_read_b64_tr_b16 a[112:113], v9 offset:32768
  ds_read_b64_tr_b16 a[114:115], v9 offset:33280
  v_mfma_f32_32x32x16_bf16 v[48:63], a[36:39], a[152:155], v[48:63]
  ds_read_b64_tr_b16 a[116:117], v10 offset:32768
  ds_read_b64_tr_b16 a[118:119], v10 offset:33280
  s_add_u32 s98, s44, 1792
  s_add_u32 s98, s98, s8
  s_addc_u32 s99, s9, 0
  v_mfma_f32_32x32x16_bf16 v[64:79], a[36:39], a[156:159], v[64:79]
  s_add_u32 m0, s69, 16384
  ds_read_b64_tr_b16 a[120:121], v9 offset:34816
  ds_read_b64_tr_b16 a[122:123], v9 offset:35328
  v_mfma_f32_32x32x16_bf16 v[48:63], a[40:43], a[160:163], v[48:63]
  s_waitcnt lgkmcnt(4)
  ds_read_b64_tr_b16 a[124:125], v10 offset:34816
  ds_read_b64_tr_b16 a[126:127], v10 offset:35328
  ds_read_b64_tr_b16 a[128:129], v9 offset:36864
  v_mfma_f32_32x32x16_bf16 v[64:79], a[40:43], a[164:167], v[64:79]
  ds_read_b64_tr_b16 a[130:131], v9 offset:37376
  ds_read_b64_tr_b16 a[132:133], v10 offset:36864
  global_load_lds_dwordx4 v160, s[98:99]
  v_mfma_f32_32x32x16_bf16 v[48:63], a[44:47], a[168:171], v[48:63]
  s_add_u32 m0, s69, 17408
  ds_read_b64_tr_b16 a[134:135], v10 offset:37376
  ds_read_b64_tr_b16 a[136:137], v9 offset:38912
  v_mfma_f32_32x32x16_bf16 v[64:79], a[44:47], a[172:175], v[64:79]
  ds_read_b64_tr_b16 a[138:139], v9 offset:39424
  ds_read_b64_tr_b16 a[140:141], v10 offset:38912
  ds_read_b64_tr_b16 a[142:143], v10 offset:39424
  global_load_lds_dwordx4 v161, s[98:99]
  v_mfma_f32_32x32x16_bf16 v[48:63], a[48:51], a[112:115], v[48:63]
  s_waitcnt lgkmcnt(6)
  s_waitcnt vmcnt(11)
  s_barrier
  v_mfma_f32_32x32x16_bf16 v[64:79], a[48:51], a[116:119], v[64:79]
  ds_read_b64_tr_b16 a[144:145], v9 offset:40960
  ds_read_b64_tr_b16 a[146:147], v9 offset:41472
  s_add_u32 s4, s63, 4096
  v_mfma_f32_32x32x16_bf16 v[48:63], a[52:55], a[120:123], v[48:63]
  s_add_u32 m0, s69, 24576
  ds_read_b64_tr_b16 a[148:149], v10 offset:40960
  ds_read_b64_tr_b16 a[150:151], v10 offset:41472
  v_mfma_f32_32x32x16_bf16 v[64:79], a[52:55], a[124:127], v[64:79]
  ds_read_b64_tr_b16 a[152:153], v9 offset:43008
  ds_read_b64_tr_b16 a[154:155], v9 offset:43520
  s_add_u32 s4, s4, s16
  s_addc_u32 s5, s17, 0
  v_mfma_f32_32x32x16_bf16 v[48:63], a[56:59], a[128:131], v[48:63]
  s_waitcnt lgkmcnt(4)
  ds_read_b64_tr_b16 a[156:157], v10 offset:43008
  ds_read_b64_tr_b16 a[158:159], v10 offset:43520
  ds_read_b64_tr_b16 a[160:161], v9 offset:45056
  global_load_lds_dwordx4 v162, s[98:99]
  v_xor_b32 v245, v245, v15
  v_mfma_f32_32x32x16_bf16 v[64:79], a[56:59], a[132:135], v[64:79]
  ds_read_b64_tr_b16 a[162:163], v9 offset:45568
  ds_read_b64_tr_b16 a[164:165], v10 offset:45056
  v_mfma_f32_32x32x16_bf16 v[48:63], a[60:63], a[136:139], v[48:63]
  s_add_u32 m0, s69, 25600
  ds_read_b64_tr_b16 a[166:167], v10 offset:45568
  ds_read_b64_tr_b16 a[168:169], v9 offset:47104
  v_cndmask_b32 v245, 0, v245, s[46:47]
  v_mfma_f32_32x32x16_bf16 v[64:79], a[60:63], a[140:143], v[64:79]
  ds_read_b64_tr_b16 a[170:171], v9 offset:47616
  ds_read_b64_tr_b16 a[172:173], v10 offset:47104
  ds_read_b64_tr_b16 a[174:175], v10 offset:47616
  global_load_lds_dwordx4 v163, s[98:99]
  v_and_b32 v207, 0xFFFF0000, v245
  v_mfma_f32_32x32x16_bf16 v[48:63], a[64:67], a[144:147], v[48:63]
  s_waitcnt lgkmcnt(6)
  s_waitcnt vmcnt(9)
  s_barrier
  s_lshl_b32 s55, s59, 2
  v_mfma_f32_32x32x16_bf16 v[64:79], a[64:67], a[148:151], v[64:79]
  ds_read_b64_tr_b16 a[112:113], v200 offset:0
  ds_read_b64_tr_b16 a[114:115], v200 offset:512
  s_add_u32 s55, s55, s38
  v_mfma_f32_32x32x16_bf16 v[48:63], a[68:71], a[152:155], v[48:63]
  s_add_u32 m0, s69, 32768
  ds_read_b64_tr_b16 a[116:117], v201 offset:0
  ds_read_b64_tr_b16 a[118:119], v201 offset:512
  s_lshl_b32 s55, s55, 5
  v_mfma_f32_32x32x16_bf16 v[64:79], a[68:71], a[156:159], v[64:79]
  ds_read_b64_tr_b16 a[120:121], v200 offset:2048
  ds_read_b64_tr_b16 a[122:123], v200 offset:2560
  s_add_u32 s55, s55, s37
  v_mfma_f32_32x32x16_bf16 v[48:63], a[72:75], a[160:163], v[48:63]
  s_waitcnt lgkmcnt(4)
  ds_read_b64_tr_b16 a[124:125], v201 offset:2048
  ds_read_b64_tr_b16 a[126:127], v201 offset:2560
  ds_read_b64_tr_b16 a[128:129], v200 offset:4096
  global_load_lds_dwordx4 v164, s[98:99]
  s_add_u32 s55, s55, 16
  v_mfma_f32_32x32x16_bf16 v[64:79], a[72:75], a[164:167], v[64:79]
  ds_read_b64_tr_b16 a[130:131], v200 offset:4608
  ds_read_b64_tr_b16 a[132:133], v201 offset:4096
  s_lshl_b32 s55, s55, 7
  v_mfma_f32_32x32x16_bf16 v[48:63], a[76:79], a[168:171], v[48:63]
  s_add_u32 m0, s69, 33792
  ds_read_b64_tr_b16 a[134:135], v201 offset:4608
  ds_read_b64_tr_b16 a[136:137], v200 offset:6144
  s_add_u32 s55, s55, 65536
  v_mfma_f32_32x32x16_bf16 v[64:79], a[76:79], a[172:175], v[64:79]
  ds_read_b64_tr_b16 a[138:139], v200 offset:6656
  ds_read_b64_tr_b16 a[140:141], v201 offset:6144
  ds_read_b64_tr_b16 a[142:143], v201 offset:6656
  global_load_lds_dwordx4 v165, s[98:99]
  s_waitcnt vmcnt(6)
  buffer_store_dword v15, v14, s[16:19], s55 offen sc1
  v_mfma_f32_32x32x16_bf16 v[48:63], a[80:83], a[112:115], v[48:63]
  s_waitcnt lgkmcnt(6)
  s_barrier
  s_lshl_b32 s94, s38, 12
  v_mfma_f32_32x32x16_bf16 v[64:79], a[80:83], a[116:119], v[64:79]
  ds_read_b64_tr_b16 a[144:145], v200 offset:8192
  ds_read_b64_tr_b16 a[146:147], v200 offset:8704
  s_add_u32 s94, s94, 73728
  v_mfma_f32_32x32x16_bf16 v[48:63], a[84:87], a[120:123], v[48:63]
  s_add_u32 m0, s69, 40960
  ds_read_b64_tr_b16 a[148:149], v201 offset:8192
  ds_read_b64_tr_b16 a[150:151], v201 offset:8704
  v_add_u32 v5, s94, v1
  v_mfma_f32_32x32x16_bf16 v[64:79], a[84:87], a[124:127], v[64:79]
  ds_read_b64_tr_b16 a[152:153], v200 offset:10240
  ds_read_b64_tr_b16 a[154:155], v200 offset:10752
  s_lshl_b32 s94, s38, 10
  v_mfma_f32_32x32x16_bf16 v[48:63], a[88:91], a[128:131], v[48:63]
  s_waitcnt lgkmcnt(4)
  ds_read_b64_tr_b16 a[156:157], v201 offset:10240
  ds_read_b64_tr_b16 a[158:159], v201 offset:10752
  ds_read_b64_tr_b16 a[160:161], v200 offset:12288
  global_load_lds_dwordx4 v166, s[98:99]
  s_add_u32 s94, s94, 73728
  v_mfma_f32_32x32x16_bf16 v[64:79], a[88:91], a[132:135], v[64:79]
  ds_read_b64_tr_b16 a[162:163], v200 offset:12800
  ds_read_b64_tr_b16 a[164:165], v201 offset:12288
  v_add_u32 v6, s94, v1
  v_mfma_f32_32x32x16_bf16 v[48:63], a[92:95], a[136:139], v[48:63]
  s_add_u32 m0, s69, 41984
  ds_read_b64_tr_b16 a[166:167], v201 offset:12800
  ds_read_b64_tr_b16 a[168:169], v200 offset:14336
  s_lshl_b32 s94, s59, 17
  v_mfma_f32_32x32x16_bf16 v[64:79], a[92:95], a[140:143], v[64:79]
  ds_read_b64_tr_b16 a[170:171], v200 offset:14848
  ds_read_b64_tr_b16 a[172:173], v201 offset:14336
  ds_read_b64_tr_b16 a[174:175], v201 offset:14848
  global_load_lds_dwordx4 v167, s[98:99]
  s_lshl_b32 s95, s37, 10
  s_add_u32 s94, s94, s95
  v_mfma_f32_32x32x16_bf16 v[48:63], a[96:99], a[144:147], v[48:63]
  s_waitcnt lgkmcnt(6)
  s_waitcnt vmcnt(7)
  s_barrier
  s_lshl_b32 s95, s38, 14
  v_mfma_f32_32x32x16_bf16 v[64:79], a[96:99], a[148:151], v[64:79]
  ds_read_b64_tr_b16 a[112:113], v200 offset:16384
  ds_read_b64_tr_b16 a[114:115], v200 offset:16896
  s_add_u32 s94, s94, s95
  v_mfma_f32_32x32x16_bf16 v[48:63], a[100:103], a[152:155], v[48:63]
  s_add_u32 m0, s69, 49152
  ds_read_b64_tr_b16 a[116:117], v201 offset:16384
  ds_read_b64_tr_b16 a[118:119], v201 offset:16896
  s_add_u32 s94, s94, 5242880
  v_mfma_f32_32x32x16_bf16 v[64:79], a[100:103], a[156:159], v[64:79]
  ds_read_b64_tr_b16 a[120:121], v200 offset:18432
  ds_read_b64_tr_b16 a[122:123], v200 offset:18944
  s_add_u32 s95, s94, 0x10000
  s_lshl_b32 s62, s59, 2
  v_mfma_f32_32x32x16_bf16 v[48:63], a[104:107], a[160:163], v[48:63]
  s_waitcnt lgkmcnt(4)
  ds_read_b64_tr_b16 a[124:125], v201 offset:18432
  ds_read_b64_tr_b16 a[126:127], v201 offset:18944
  ds_read_b64_tr_b16 a[128:129], v200 offset:20480
  global_load_lds_dwordx4 v168, s[98:99]
  s_add_u32 s62, s62, s38
  v_mfma_f32_32x32x16_bf16 v[64:79], a[104:107], a[164:167], v[64:79]
  ds_read_b64_tr_b16 a[130:131], v200 offset:20992
  ds_read_b64_tr_b16 a[132:133], v201 offset:20480
  s_lshl_b32 s62, s62, 4
  v_mfma_f32_32x32x16_bf16 v[48:63], a[108:111], a[168:171], v[48:63]
  s_add_u32 m0, s69, 50176
  ds_read_b64_tr_b16 a[134:135], v201 offset:20992
  ds_read_b64_tr_b16 a[136:137], v200 offset:22528
  s_add_u32 s62, s62, s37
  v_mfma_f32_32x32x16_bf16 v[64:79], a[108:111], a[172:175], v[64:79]
  ds_read_b64_tr_b16 a[138:139], v200 offset:23040
  ds_read_b64_tr_b16 a[140:141], v201 offset:22528
  ds_read_b64_tr_b16 a[142:143], v201 offset:23040
  global_load_lds_dwordx4 v169, s[98:99]
  s_lshl_b32 s62, s62, 7
  s_add_u32 s62, s62, 327680
  v_mfma_f32_32x32x16_bf16 v[16:31], a[0:3], a[112:115], 0
  s_waitcnt lgkmcnt(6)
  s_waitcnt vmcnt(7)
  s_barrier
  v_mfma_f32_32x32x16_bf16 v[32:47], a[0:3], a[116:119], 0
  ds_read_b64_tr_b16 a[144:145], v200 offset:24576
  ds_read_b64_tr_b16 a[146:147], v200 offset:25088
  v_mfma_f32_32x32x16_bf16 v[16:31], a[4:7], a[120:123], v[16:31]
  s_add_u32 m0, s69, 57344
  ds_read_b64_tr_b16 a[148:149], v201 offset:24576
  ds_read_b64_tr_b16 a[150:151], v201 offset:25088
  v_mfma_f32_32x32x16_bf16 v[32:47], a[4:7], a[124:127], v[32:47]
  ds_read_b64_tr_b16 a[152:153], v200 offset:26624
  ds_read_b64_tr_b16 a[154:155], v200 offset:27136
  v_pk_mul_f32 v[220:221], v[48:49], v[224:225] op_sel_hi:[1,0]
  v_pk_mul_f32 v[222:223], v[50:51], v[224:225] op_sel_hi:[1,0]
  v_mfma_f32_32x32x16_bf16 v[16:31], a[8:11], a[128:131], v[16:31]
  s_waitcnt lgkmcnt(4)
  ds_read_b64_tr_b16 a[156:157], v201 offset:26624
  ds_read_b64_tr_b16 a[158:159], v201 offset:27136
  ds_read_b64_tr_b16 a[160:161], v200 offset:28672
  global_load_lds_dwordx4 v170, s[98:99]
  v_exp_f32 v220, v220 clamp
  v_exp_f32 v221, v221 clamp
  v_mfma_f32_32x32x16_bf16 v[32:47], a[8:11], a[132:135], v[32:47]
  ds_read_b64_tr_b16 a[162:163], v200 offset:29184
  ds_read_b64_tr_b16 a[164:165], v201 offset:28672
  v_exp_f32 v222, v222 clamp
  v_mfma_f32_32x32x16_bf16 v[16:31], a[12:15], a[136:139], v[16:31]
  s_add_u32 m0, s69, 58368
  ds_read_b64_tr_b16 a[166:167], v201 offset:29184
  ds_read_b64_tr_b16 a[168:169], v200 offset:30720
  v_exp_f32 v223, v223 clamp
  v_max_f32 v48, s52, v48
  v_mfma_f32_32x32x16_bf16 v[32:47], a[12:15], a[140:143], v[32:47]
  ds_read_b64_tr_b16 a[170:171], v200 offset:31232
  ds_read_b64_tr_b16 a[172:173], v201 offset:30720
  ds_read_b64_tr_b16 a[174:175], v201 offset:31232
  global_load_lds_dwordx4 v171, s[98:99]
  v_max_f32 v49, s52, v49
  v_max_f32 v50, s52, v50
  v_mfma_f32_32x32x16_bf16 v[16:31], a[16:19], a[144:147], v[16:31]
  s_waitcnt lgkmcnt(6)
  s_waitcnt vmcnt(7)
  s_barrier
  v_max_f32 v51, s52, v51
  v_mfma_f32_32x32x16_bf16 v[32:47], a[16:19], a[148:151], v[32:47]
  ds_read_b64_tr_b16 a[112:113], v200 offset:32768
  ds_read_b64_tr_b16 a[114:115], v200 offset:33280
  v_pk_add_f32 v[48:49], v[48:49], v[220:221]
  v_pk_add_f32 v[50:51], v[50:51], v[222:223]
  v_mfma_f32_32x32x16_bf16 v[16:31], a[20:23], a[152:155], v[16:31]
  s_add_u32 m0, s45, 16384
  ds_read_b64_tr_b16 a[116:117], v201 offset:32768
  ds_read_b64_tr_b16 a[118:119], v201 offset:33280
  v_cvt_pk_bf16_f32 v128, v48, v49
  v_cvt_pk_bf16_f32 v129, v50, v51
  v_mfma_f32_32x32x16_bf16 v[32:47], a[20:23], a[156:159], v[32:47]
  ds_read_b64_tr_b16 a[120:121], v200 offset:34816
  ds_read_b64_tr_b16 a[122:123], v200 offset:35328
  v_pk_mul_f32 v[220:221], v[52:53], v[224:225] op_sel_hi:[1,0]
  v_pk_mul_f32 v[222:223], v[54:55], v[224:225] op_sel_hi:[1,0]
  v_mfma_f32_32x32x16_bf16 v[16:31], a[24:27], a[160:163], v[16:31]
  s_waitcnt lgkmcnt(4)
  ds_read_b64_tr_b16 a[124:125], v201 offset:34816
  ds_read_b64_tr_b16 a[126:127], v201 offset:35328
  ds_read_b64_tr_b16 a[128:129], v200 offset:36864
  global_load_lds_dwordx4 v172, s[98:99]
  v_exp_f32 v220, v220 clamp
  v_mfma_f32_32x32x16_bf16 v[32:47], a[24:27], a[164:167], v[32:47]
  ds_read_b64_tr_b16 a[130:131], v200 offset:37376
  ds_read_b64_tr_b16 a[132:133], v201 offset:36864
  v_exp_f32 v221, v221 clamp
  v_exp_f32 v222, v222 clamp
  v_mfma_f32_32x32x16_bf16 v[16:31], a[28:31], a[168:171], v[16:31]
  s_add_u32 m0, s45, 17408
  ds_read_b64_tr_b16 a[134:135], v201 offset:37376
  ds_read_b64_tr_b16 a[136:137], v200 offset:38912
  v_exp_f32 v223, v223 clamp
  v_max_f32 v52, s52, v52
  v_mfma_f32_32x32x16_bf16 v[32:47], a[28:31], a[172:175], v[32:47]
  ds_read_b64_tr_b16 a[138:139], v200 offset:39424
  ds_read_b64_tr_b16 a[140:141], v201 offset:38912
  ds_read_b64_tr_b16 a[142:143], v201 offset:39424
  global_load_lds_dwordx4 v173, s[98:99]
  v_max_f32 v53, s52, v53
  v_max_f32 v54, s52, v54
  v_mfma_f32_32x32x16_bf16 v[16:31], a[32:35], a[112:115], v[16:31]
  s_waitcnt lgkmcnt(6)
  s_waitcnt vmcnt(6)
  s_barrier
  v_max_f32 v55, s52, v55
  v_mfma_f32_32x32x16_bf16 v[32:47], a[32:35], a[116:119], v[32:47]
  ds_read_b64_tr_b16 a[144:145], v200 offset:40960
  ds_read_b64_tr_b16 a[146:147], v200 offset:41472
  v_pk_add_f32 v[52:53], v[52:53], v[220:221]
  v_pk_add_f32 v[54:55], v[54:55], v[222:223]
  v_mfma_f32_32x32x16_bf16 v[16:31], a[36:39], a[120:123], v[16:31]
  ds_read_b64_tr_b16 a[148:149], v201 offset:40960
  ds_read_b64_tr_b16 a[150:151], v201 offset:41472
  v_cvt_pk_bf16_f32 v130, v52, v53
  v_cvt_pk_bf16_f32 v131, v54, v55
  v_mfma_f32_32x32x16_bf16 v[32:47], a[36:39], a[124:127], v[32:47]
  ds_read_b64_tr_b16 a[152:153], v200 offset:43008
  ds_read_b64_tr_b16 a[154:155], v200 offset:43520
  v_pk_mul_f32 v[220:221], v[56:57], v[224:225] op_sel_hi:[1,0]
  v_pk_mul_f32 v[222:223], v[58:59], v[224:225] op_sel_hi:[1,0]
  v_mfma_f32_32x32x16_bf16 v[16:31], a[40:43], a[128:131], v[16:31]
  s_waitcnt lgkmcnt(4)
  ds_read_b64_tr_b16 a[156:157], v201 offset:43008
  ds_read_b64_tr_b16 a[158:159], v201 offset:43520
  ds_read_b64_tr_b16 a[160:161], v200 offset:45056
  buffer_load_dword v2, v236, s[16:19], 0 offen sc1
  v_exp_f32 v220, v220 clamp
  v_mfma_f32_32x32x16_bf16 v[32:47], a[40:43], a[132:135], v[32:47]
  ds_read_b64_tr_b16 a[162:163], v200 offset:45568
  ds_read_b64_tr_b16 a[164:165], v201 offset:45056
  v_exp_f32 v221, v221 clamp
  v_exp_f32 v222, v222 clamp
  v_mfma_f32_32x32x16_bf16 v[16:31], a[44:47], a[136:139], v[16:31]
  ds_read_b64_tr_b16 a[166:167], v201 offset:45568
  ds_read_b64_tr_b16 a[168:169], v200 offset:47104
  v_exp_f32 v223, v223 clamp
  v_max_f32 v56, s52, v56
  v_mfma_f32_32x32x16_bf16 v[32:47], a[44:47], a[140:143], v[32:47]
  ds_read_b64_tr_b16 a[170:171], v200 offset:47616
  ds_read_b64_tr_b16 a[172:173], v201 offset:47104
  ds_read_b64_tr_b16 a[174:175], v201 offset:47616
  v_max_f32 v57, s52, v57
  v_max_f32 v58, s52, v58
  v_mfma_f32_32x32x16_bf16 v[16:31], a[48:51], a[144:147], v[16:31]
  s_waitcnt lgkmcnt(6)
  s_waitcnt vmcnt(5)
  s_barrier
  v_max_f32 v59, s52, v59
  v_mfma_f32_32x32x16_bf16 v[32:47], a[48:51], a[148:151], v[32:47]
  ds_read_b64_tr_b16 a[112:113], v200 offset:49152
  ds_read_b64_tr_b16 a[114:115], v200 offset:49664
  v_pk_add_f32 v[56:57], v[56:57], v[220:221]
  v_pk_add_f32 v[58:59], v[58:59], v[222:223]
  v_mfma_f32_32x32x16_bf16 v[16:31], a[52:55], a[152:155], v[16:31]
  ds_read_b64_tr_b16 a[116:117], v201 offset:49152
  ds_read_b64_tr_b16 a[118:119], v201 offset:49664
  v_cvt_pk_bf16_f32 v132, v56, v57
  v_mfma_f32_32x32x16_bf16 v[32:47], a[52:55], a[156:159], v[32:47]
  ds_read_b64_tr_b16 a[120:121], v200 offset:51200
  ds_read_b64_tr_b16 a[122:123], v200 offset:51712
  v_cvt_pk_bf16_f32 v133, v58, v59
  v_pk_mul_f32 v[220:221], v[60:61], v[224:225] op_sel_hi:[1,0]
  v_mfma_f32_32x32x16_bf16 v[16:31], a[56:59], a[160:163], v[16:31]
  s_waitcnt lgkmcnt(4)
  ds_read_b64_tr_b16 a[124:125], v201 offset:51200
  ds_read_b64_tr_b16 a[126:127], v201 offset:51712
  ds_read_b64_tr_b16 a[128:129], v200 offset:53248
  v_pk_mul_f32 v[222:223], v[62:63], v[224:225] op_sel_hi:[1,0]
  v_exp_f32 v220, v220 clamp
  v_mfma_f32_32x32x16_bf16 v[32:47], a[56:59], a[164:167], v[32:47]
  ds_read_b64_tr_b16 a[130:131], v200 offset:53760
  ds_read_b64_tr_b16 a[132:133], v201 offset:53248
  v_exp_f32 v221, v221 clamp
  v_mfma_f32_32x32x16_bf16 v[16:31], a[60:63], a[168:171], v[16:31]
  ds_read_b64_tr_b16 a[134:135], v201 offset:53760
  ds_read_b64_tr_b16 a[136:137], v200 offset:55296
  v_exp_f32 v222, v222 clamp
  v_exp_f32 v223, v223 clamp
  v_mfma_f32_32x32x16_bf16 v[32:47], a[60:63], a[172:175], v[32:47]
  ds_read_b64_tr_b16 a[138:139], v200 offset:55808
  ds_read_b64_tr_b16 a[140:141], v201 offset:55296
  ds_read_b64_tr_b16 a[142:143], v201 offset:55808
  v_max_f32 v60, s52, v60
  v_max_f32 v61, s52, v61
  v_mfma_f32_32x32x16_bf16 v[16:31], a[64:67], a[112:115], v[16:31]
  s_waitcnt lgkmcnt(6)
  s_waitcnt vmcnt(3)
  s_barrier
  v_max_f32 v62, s52, v62
  v_mfma_f32_32x32x16_bf16 v[32:47], a[64:67], a[116:119], v[32:47]
  ds_read_b64_tr_b16 a[144:145], v200 offset:57344
  ds_read_b64_tr_b16 a[146:147], v200 offset:57856
  v_max_f32 v63, s52, v63
  v_pk_add_f32 v[60:61], v[60:61], v[220:221]
  v_mfma_f32_32x32x16_bf16 v[16:31], a[68:71], a[120:123], v[16:31]
  ds_read_b64_tr_b16 a[148:149], v201 offset:57344
  ds_read_b64_tr_b16 a[150:151], v201 offset:57856
  v_pk_add_f32 v[62:63], v[62:63], v[222:223]
  v_cvt_pk_bf16_f32 v134, v60, v61
  v_mfma_f32_32x32x16_bf16 v[32:47], a[68:71], a[124:127], v[32:47]
  ds_read_b64_tr_b16 a[152:153], v200 offset:59392
  ds_read_b64_tr_b16 a[154:155], v200 offset:59904
  v_cvt_pk_bf16_f32 v135, v62, v63
  v_pk_mul_f32 v[220:221], v[64:65], v[224:225] op_sel_hi:[1,0]
  v_mfma_f32_32x32x16_bf16 v[16:31], a[72:75], a[128:131], v[16:31]
  s_waitcnt lgkmcnt(4)
  ds_read_b64_tr_b16 a[156:157], v201 offset:59392
  ds_read_b64_tr_b16 a[158:159], v201 offset:59904
  ds_read_b64_tr_b16 a[160:161], v200 offset:61440
  v_pk_mul_f32 v[222:223], v[66:67], v[224:225] op_sel_hi:[1,0]
  v_mfma_f32_32x32x16_bf16 v[32:47], a[72:75], a[132:135], v[32:47]
  ds_read_b64_tr_b16 a[162:163], v200 offset:61952
  ds_read_b64_tr_b16 a[164:165], v201 offset:61440
  v_exp_f32 v220, v220 clamp
  v_exp_f32 v221, v221 clamp
  v_mfma_f32_32x32x16_bf16 v[16:31], a[76:79], a[136:139], v[16:31]
  ds_read_b64_tr_b16 a[166:167], v201 offset:61952
  ds_read_b64_tr_b16 a[168:169], v200 offset:63488
  v_exp_f32 v222, v222 clamp
  v_exp_f32 v223, v223 clamp
  v_mfma_f32_32x32x16_bf16 v[32:47], a[76:79], a[140:143], v[32:47]
  ds_read_b64_tr_b16 a[170:171], v200 offset:64000
  ds_read_b64_tr_b16 a[172:173], v201 offset:63488
  ds_read_b64_tr_b16 a[174:175], v201 offset:64000
  v_max_f32 v64, s52, v64
  v_max_f32 v65, s52, v65
  v_mfma_f32_32x32x16_bf16 v[16:31], a[80:83], a[144:147], v[16:31]
  s_waitcnt lgkmcnt(6)
  s_waitcnt vmcnt(1)
  s_barrier
  v_max_f32 v66, s52, v66
  s_lshl_b32 s3, s61, 14
  s_add_u32 s3, s3, 10489856
  s_add_u32 s56, s16, s3
  s_addc_u32 s57, s17, 0
  v_max_f32 v67, s52, v67
  v_mfma_f32_32x32x16_bf16 v[32:47], a[80:83], a[148:151], v[32:47]
  ds_read_b64_tr_b16 a[112:113], v9 offset:16384
  ds_read_b64_tr_b16 a[114:115], v9 offset:16896
  global_load_dwordx4 v[160:163], v242, s[56:57] offset:-4096 sc1
  v_pk_add_f32 v[64:65], v[64:65], v[220:221]
  v_pk_add_f32 v[66:67], v[66:67], v[222:223]
  v_mfma_f32_32x32x16_bf16 v[16:31], a[84:87], a[152:155], v[16:31]
  ds_read_b64_tr_b16 a[116:117], v10 offset:16384
  ds_read_b64_tr_b16 a[118:119], v10 offset:16896
  global_load_dwordx4 v[164:167], v242, s[56:57] offset:-3072 sc1
  v_cvt_pk_bf16_f32 v136, v64, v65
  global_load_dwordx4 v[168:171], v242, s[56:57] offset:-2048 sc1
  v_mfma_f32_32x32x16_bf16 v[32:47], a[84:87], a[156:159], v[32:47]
  ds_read_b64_tr_b16 a[120:121], v9 offset:18432
  ds_read_b64_tr_b16 a[122:123], v9 offset:18944
  v_cvt_pk_bf16_f32 v137, v66, v67
  v_pk_mul_f32 v[220:221], v[68:69], v[224:225] op_sel_hi:[1,0]
  global_load_dwordx4 v[172:175], v242, s[56:57] offset:-1024 sc1
  v_mfma_f32_32x32x16_bf16 v[16:31], a[88:91], a[160:163], v[16:31]
  s_waitcnt lgkmcnt(4)
  ds_read_b64_tr_b16 a[124:125], v10 offset:18432
  ds_read_b64_tr_b16 a[126:127], v10 offset:18944
  ds_read_b64_tr_b16 a[128:129], v9 offset:20480
  s_waitcnt vmcnt(4)
  v_cmp_ne_u32 vcc, v15, v2
  s_cbranch_vccnz L_oolK1
L_retK1:
  v_pk_mul_f32 v[222:223], v[70:71], v[224:225] op_sel_hi:[1,0]
  v_exp_f32 v220, v220 clamp
  v_mfma_f32_32x32x16_bf16 v[32:47], a[88:91], a[164:167], v[32:47]
  ds_read_b64_tr_b16 a[130:131], v9 offset:20992
  ds_read_b64_tr_b16 a[132:133], v10 offset:20480
  global_load_dwordx4 v[176:179], v242, s[56:57] offset:0 sc1
  v_exp_f32 v221, v221 clamp
  global_load_dwordx4 v[180:183], v242, s[56:57] offset:1024 sc1
  v_mfma_f32_32x32x16_bf16 v[16:31], a[92:95], a[168:171], v[16:31]
  ds_read_b64_tr_b16 a[134:135], v10 offset:20992
  ds_read_b64_tr_b16 a[136:137], v9 offset:22528
  v_exp_f32 v222, v222 clamp
  v_exp_f32 v223, v223 clamp
  global_load_dwordx4 v[184:187], v242, s[56:57] offset:2048 sc1
  v_mfma_f32_32x32x16_bf16 v[32:47], a[92:95], a[172:175], v[32:47]
  ds_read_b64_tr_b16 a[138:139], v9 offset:23040
  ds_read_b64_tr_b16 a[140:141], v10 offset:22528
  ds_read_b64_tr_b16 a[142:143], v10 offset:23040
  v_max_f32 v68, s52, v68
  global_load_dwordx4 v[188:191], v242, s[56:57] offset:3072 sc1
  v_max_f32 v69, s52, v69
  v_mfma_f32_32x32x16_bf16 v[16:31], a[96:99], a[112:115], v[16:31]
  s_waitcnt lgkmcnt(6)
  v_max_f32 v70, s52, v70
  v_mfma_f32_32x32x16_bf16 v[32:47], a[96:99], a[116:119], v[32:47]
  v_max_f32 v71, s52, v71
  v_pk_add_f32 v[68:69], v[68:69], v[220:221]
  v_mfma_f32_32x32x16_bf16 v[16:31], a[100:103], a[120:123], v[16:31]
  v_pk_add_f32 v[70:71], v[70:71], v[222:223]
  v_cvt_pk_bf16_f32 v138, v68, v69
  v_mfma_f32_32x32x16_bf16 v[32:47], a[100:103], a[124:127], v[32:47]
  v_cvt_pk_bf16_f32 v139, v70, v71
  v_pk_mul_f32 v[220:221], v[72:73], v[224:225] op_sel_hi:[1,0]
  v_mfma_f32_32x32x16_bf16 v[16:31], a[104:107], a[128:131], v[16:31]
  s_waitcnt lgkmcnt(0)
  v_pk_mul_f32 v[222:223], v[74:75], v[224:225] op_sel_hi:[1,0]
  global_load_dwordx4 a[176:179], v1, s[4:5] offset:-4096 sc1
  v_mfma_f32_32x32x16_bf16 v[32:47], a[104:107], a[132:135], v[32:47]
  v_exp_f32 v220, v220 clamp
  v_exp_f32 v221, v221 clamp
  global_load_dwordx4 a[180:183], v1, s[4:5] offset:-3072 sc1
  v_mfma_f32_32x32x16_bf16 v[16:31], a[108:111], a[136:139], v[16:31]
  v_exp_f32 v222, v222 clamp
  global_load_dwordx4 a[184:187], v1, s[4:5] offset:-2048 sc1
  v_exp_f32 v223, v223 clamp
  v_mfma_f32_32x32x16_bf16 v[32:47], a[108:111], a[140:143], v[32:47]
  v_max_f32 v72, s52, v72
  global_load_dwordx4 a[188:191], v1, s[4:5] offset:-1024 sc1
  v_max_f32 v73, s52, v73
  v_max_f32 v74, s52, v74
  v_max_f32 v75, s52, v75
  v_pk_add_f32 v[72:73], v[72:73], v[220:221]
  v_pk_add_f32 v[74:75], v[74:75], v[222:223]
  v_cvt_pk_bf16_f32 v140, v72, v73
  v_cvt_pk_bf16_f32 v141, v74, v75
  v_pk_mul_f32 v[220:221], v[76:77], v[224:225] op_sel_hi:[1,0]
  v_pk_mul_f32 v[222:223], v[78:79], v[224:225] op_sel_hi:[1,0]
  v_exp_f32 v220, v220 clamp
  v_exp_f32 v221, v221 clamp
  v_exp_f32 v222, v222 clamp
  v_exp_f32 v223, v223 clamp
  v_max_f32 v76, s52, v76
  v_max_f32 v77, s52, v77
  v_max_f32 v78, s52, v78
  v_max_f32 v79, s52, v79
  v_pk_add_f32 v[76:77], v[76:77], v[220:221]
  v_pk_add_f32 v[78:79], v[78:79], v[222:223]
  v_cvt_pk_bf16_f32 v142, v76, v77
  v_cvt_pk_bf16_f32 v143, v78, v79
  v_cvt_pk_bf16_f32 v144, v16, v17
  v_cvt_pk_bf16_f32 v145, v18, v19
  v_cvt_pk_bf16_f32 v146, v20, v21
  v_cvt_pk_bf16_f32 v147, v22, v23
  v_cvt_pk_bf16_f32 v148, v24, v25
  global_load_dwordx4 a[192:195], v1, s[4:5] offset:0 sc1
  v_cvt_pk_bf16_f32 v149, v26, v27
  v_cvt_pk_bf16_f32 v150, v28, v29
  v_cvt_pk_bf16_f32 v151, v30, v31
  v_cndmask_b32 v144, v144, v12, s[48:49]
  global_load_dwordx4 a[196:199], v1, s[4:5] offset:1024 sc1
  v_cndmask_b32 v145, v145, v12, s[48:49]
  v_cndmask_b32 v146, v146, v12, s[48:49]
  v_cndmask_b32 v147, v147, v12, s[48:49]
  v_cndmask_b32 v148, v148, v12, s[48:49]
  v_cndmask_b32 v149, v149, v12, s[48:49]
  global_load_dwordx4 a[200:203], v1, s[4:5] offset:2048 sc1
  v_cndmask_b32 v150, v150, v12, s[48:49]
  v_cndmask_b32 v151, v151, v12, s[48:49]
  s_nop 0
  v_mfma_f32_32x32x16_bf16 v[80:95], v[128:131], v[144:147], 0
  v_mfma_f32_32x32x16_bf16 v[80:95], v[132:135], v[148:151], v[80:95]
  global_load_dwordx4 a[204:207], v1, s[4:5] offset:3072 sc1
  v_cvt_pk_bf16_f32 v152, v32, v33
  v_cvt_pk_bf16_f32 v153, v34, v35
  v_cvt_pk_bf16_f32 v154, v36, v37
  v_cvt_pk_bf16_f32 v155, v38, v39
  v_cvt_pk_bf16_f32 v156, v40, v41
  v_cvt_pk_bf16_f32 v157, v42, v43
  v_cvt_pk_bf16_f32 v158, v44, v45
  v_cvt_pk_bf16_f32 v159, v46, v47
  v_cndmask_b32 v152, v152, v12, s[48:49]
  v_cndmask_b32 v153, v153, v12, s[48:49]
  v_cndmask_b32 v154, v154, v12, s[48:49]
  v_cndmask_b32 v155, v155, v12, s[48:49]
  v_cndmask_b32 v156, v156, v12, s[48:49]
  v_cndmask_b32 v157, v157, v12, s[48:49]
  v_cndmask_b32 v158, v158, v12, s[48:49]
  v_cndmask_b32 v159, v159, v12, s[48:49]
  s_nop 0
  v_mfma_f32_32x32x16_bf16 v[96:111], v[136:139], v[152:155], 0
  v_mfma_f32_32x32x16_bf16 v[96:111], v[140:143], v[156:159], v[96:111]
  ds_write_b128 v5, v[80:83] offset:0
  ds_write_b128 v5, v[84:87] offset:1024
  ds_write_b128 v5, v[88:91] offset:2048
  ds_write_b128 v5, v[92:95] offset:3072
  s_waitcnt vmcnt(8)
  v_xor_b32 v191, v191, v207
  v_xor_b32 v187, v187, v207
  v_xor_b32 v183, v183, v207
  v_xor_b32 v179, v179, v207
  v_xor_b32 v175, v175, v207
  v_xor_b32 v171, v171, v207
  v_xor_b32 v167, v167, v207
  v_xor_b32 v163, v163, v207
  ds_write_b128 v5, v[96:99] offset:16384
  ds_write_b128 v5, v[100:103] offset:17408
  ds_write_b128 v5, v[104:107] offset:18432
  ds_write_b128 v5, v[108:111] offset:19456
  v_or3_b32 v2, v163, v167, v171
  v_or3_b32 v3, v175, v179, v183
  v_or3_b32 v2, v2, v187, v191
  v_or_b32 v2, v2, v3
  v_cmp_lt_u32 vcc, 0xFFFF, v2
  s_nop 2
  s_and_b64 vcc, vcc, s[46:47]
  s_cbranch_scc1 L_oolQ
L_retQ:
  s_waitcnt lgkmcnt(0)
  s_barrier
  ds_read_b128 v[16:19], v6 offset:0
  ds_read_b128 v[20:23], v6 offset:4096
  ds_read_b128 v[24:27], v6 offset:8192
  ds_read_b128 v[28:31], v6 offset:12288
  ds_read_b128 v[32:35], v6 offset:16384
  ds_read_b128 v[36:39], v6 offset:20480
  ds_read_b128 v[40:43], v6 offset:24576
  ds_read_b128 v[44:47], v6 offset:28672
  buffer_load_dword v249, v14, s[16:19], 0 offen
  buffer_load_dword v249, v14, s[16:19], 0 offen
  s_waitcnt lgkmcnt(6)
  v_pk_add_f32 v[16:17], v[16:17], v[20:21]
  s_waitcnt lgkmcnt(4)
  v_pk_add_f32 v[24:25], v[24:25], v[28:29]
  v_pk_add_f32 v[18:19], v[18:19], v[22:23]
  v_pk_add_f32 v[26:27], v[26:27], v[30:31]
  v_pk_add_f32 v[16:17], v[16:17], v[24:25]
  v_pk_add_f32 v[18:19], v[18:19], v[26:27]
  buffer_store_dwordx4 v[16:19], v1, s[16:19], s94 offen sc1
  s_waitcnt lgkmcnt(2)
  v_pk_add_f32 v[32:33], v[32:33], v[36:37]
  s_waitcnt lgkmcnt(0)
  v_pk_add_f32 v[40:41], v[40:41], v[44:45]
  v_pk_add_f32 v[34:35], v[34:35], v[38:39]
  v_pk_add_f32 v[42:43], v[42:43], v[46:47]
  v_pk_add_f32 v[32:33], v[32:33], v[40:41]
  v_pk_add_f32 v[34:35], v[34:35], v[42:43]
  buffer_store_dwordx4 v[32:35], v1, s[16:19], s95 offen sc1
L_join:
  s_nop 4
  s_add_u32 s4, s4, 8192
  s_addc_u32 s5, s5, 0
  s_waitcnt vmcnt(11)
  v_mfma_f32_32x32x16_bf16 v[16:31], a[176:179], v[160:163], 0
  s_waitcnt vmcnt(10)
  v_mfma_f32_32x32x16_bf16 v[16:31], a[180:183], v[164:167], v[16:31]
  v_mfma_f32_32x32x16_bf16 v[32:47], a[176:179], v[168:171], 0
  global_load_dwordx4 a[208:211], v1, s[4:5] offset:-4096 sc1
  s_nop 9
  v_exp_f32 v16, v16
  v_exp_f32 v17, v17
  v_exp_f32 v18, v18
  v_exp_f32 v19, v19
  v_cvt_pk_bf16_f32 v48, v16, v17
  v_cvt_pk_bf16_f32 v49, v18, v19
  v_mfma_f32_32x32x16_bf16 v[32:47], a[180:183], v[172:175], v[32:47]
  global_load_dwordx4 a[212:215], v1, s[4:5] offset:-3072 sc1
  v_exp_f32 v20, v20
  v_exp_f32 v21, v21
  v_exp_f32 v22, v22
  v_exp_f32 v23, v23
  v_cvt_pk_bf16_f32 v50, v20, v21
  v_cvt_pk_bf16_f32 v51, v22, v23
  global_load_dwordx4 a[216:219], v1, s[4:5] offset:-2048 sc1
  v_exp_f32 v24, v24
  v_exp_f32 v25, v25
  v_exp_f32 v26, v26
  v_exp_f32 v27, v27
  v_cvt_pk_bf16_f32 v52, v24, v25
  v_cvt_pk_bf16_f32 v53, v26, v27
  s_waitcnt vmcnt(9)
  v_exp_f32 v28, v28
  v_exp_f32 v29, v29
  v_exp_f32 v30, v30
  v_exp_f32 v31, v31
  v_cvt_pk_bf16_f32 v54, v28, v29
  v_cvt_pk_bf16_f32 v55, v30, v31
  v_mfma_f32_32x32x16_bf16 v[16:31], a[192:195], v[160:163], 0
  global_load_dwordx4 a[220:223], v1, s[4:5] offset:-1024 sc1
  v_exp_f32 v32, v32
  v_exp_f32 v33, v33
  v_exp_f32 v34, v34
  v_exp_f32 v35, v35
  v_cvt_pk_bf16_f32 v56, v32, v33
  v_cvt_pk_bf16_f32 v57, v34, v35
  v_mfma_f32_32x32x16_bf16 v[16:31], a[196:199], v[164:167], v[16:31]
  global_load_dwordx4 a[224:227], v1, s[4:5] offset:0 sc1
  v_exp_f32 v36, v36
  v_exp_f32 v37, v37
  v_exp_f32 v38, v38
  v_exp_f32 v39, v39
  v_cvt_pk_bf16_f32 v58, v36, v37
  v_cvt_pk_bf16_f32 v59, v38, v39
  v_mfma_f32_32x32x16_bf16 v[64:79], a[184:187], v[48:51], 0
  global_load_dwordx4 a[228:231], v1, s[4:5] offset:1024 sc1
  v_exp_f32 v40, v40
  v_exp_f32 v41, v41
  v_exp_f32 v42, v42
  v_exp_f32 v43, v43
  v_cvt_pk_bf16_f32 v60, v40, v41
  v_cvt_pk_bf16_f32 v61, v42, v43
  v_mfma_f32_32x32x16_bf16 v[64:79], a[188:191], v[52:55], v[64:79]
  v_exp_f32 v44, v44
  v_exp_f32 v45, v45
  v_exp_f32 v46, v46
  v_exp_f32 v47, v47
  v_cvt_pk_bf16_f32 v62, v44, v45
  v_cvt_pk_bf16_f32 v63, v46, v47
  v_mfma_f32_32x32x16_bf16 v[32:47], a[192:195], v[168:171], 0
  global_load_dwordx4 a[232:235], v1, s[4:5] offset:2048 sc1
  v_exp_f32 v16, v16
  v_exp_f32 v17, v17
  v_exp_f32 v18, v18
  v_exp_f32 v19, v19
  v_cvt_pk_bf16_f32 v48, v16, v17
  v_cvt_pk_bf16_f32 v49, v18, v19
  v_mfma_f32_32x32x16_bf16 v[32:47], a[196:199], v[172:175], v[32:47]
  global_load_dwordx4 a[236:239], v1, s[4:5] offset:3072 sc1
  s_add_u32 s4, s4, 8192
  s_addc_u32 s5, s5, 0
  v_exp_f32 v20, v20
  v_exp_f32 v21, v21
  v_exp_f32 v22, v22
  v_exp_f32 v23, v23
  v_cvt_pk_bf16_f32 v50, v20, v21
  v_cvt_pk_bf16_f32 v51, v22, v23
  v_mfma_f32_32x32x16_bf16 v[80:95], a[184:187], v[56:59], 0
  global_load_dwordx4 a[240:243], v1, s[4:5] offset:-4096 sc1
  v_exp_f32 v24, v24
  v_exp_f32 v25, v25
  v_exp_f32 v26, v26
  v_exp_f32 v27, v27
  v_cvt_pk_bf16_f32 v52, v24, v25
  v_cvt_pk_bf16_f32 v53, v26, v27
  v_mfma_f32_32x32x16_bf16 v[80:95], a[188:191], v[60:63], v[80:95]
  s_waitcnt vmcnt(7)
  v_exp_f32 v28, v28
  v_exp_f32 v29, v29
  v_exp_f32 v30, v30
  v_exp_f32 v31, v31
  v_cvt_pk_bf16_f32 v54, v28, v29
  v_cvt_pk_bf16_f32 v55, v30, v31
  v_mfma_f32_32x32x16_bf16 v[16:31], a[208:211], v[160:163], 0
  global_load_dwordx4 a[244:247], v1, s[4:5] offset:-3072 sc1
  v_exp_f32 v32, v32
  v_exp_f32 v33, v33
  v_exp_f32 v34, v34
  v_exp_f32 v35, v35
  v_cvt_pk_bf16_f32 v56, v32, v33
  v_cvt_pk_bf16_f32 v57, v34, v35
  v_mfma_f32_32x32x16_bf16 v[16:31], a[212:215], v[164:167], v[16:31]
  global_load_dwordx4 a[248:251], v1, s[4:5] offset:-2048 sc1
  v_exp_f32 v36, v36
  v_exp_f32 v37, v37
  v_exp_f32 v38, v38
  v_exp_f32 v39, v39
  v_cvt_pk_bf16_f32 v58, v36, v37
  v_cvt_pk_bf16_f32 v59, v38, v39
  v_mfma_f32_32x32x16_bf16 v[64:79], a[200:203], v[48:51], v[64:79]
  global_load_dwordx4 a[252:255], v1, s[4:5] offset:-1024 sc1
  v_exp_f32 v40, v40
  v_exp_f32 v41, v41
  v_exp_f32 v42, v42
  v_exp_f32 v43, v43
  v_cvt_pk_bf16_f32 v60, v40, v41
  v_cvt_pk_bf16_f32 v61, v42, v43
  v_mfma_f32_32x32x16_bf16 v[64:79], a[204:207], v[52:55], v[64:79]
  buffer_store_dword v15, v14, s[16:19], s62 offen sc1
  v_exp_f32 v44, v44
  v_exp_f32 v45, v45
  v_exp_f32 v46, v46
  v_exp_f32 v47, v47
  v_cvt_pk_bf16_f32 v62, v44, v45
  v_cvt_pk_bf16_f32 v63, v46, v47
  v_mfma_f32_32x32x16_bf16 v[32:47], a[208:211], v[168:171], 0
  global_load_dwordx4 a[0:3], v1, s[4:5] offset:0 sc1
  v_exp_f32 v16, v16
  v_exp_f32 v17, v17
  v_exp_f32 v18, v18
  v_exp_f32 v19, v19
  v_cvt_pk_bf16_f32 v48, v16, v17
  v_cvt_pk_bf16_f32 v49, v18, v19
  v_mfma_f32_32x32x16_bf16 v[32:47], a[212:215], v[172:175], v[32:47]
  global_load_dwordx4 a[4:7], v1, s[4:5] offset:1024 sc1
  v_exp_f32 v20, v20
  v_exp_f32 v21, v21
  v_exp_f32 v22, v22
  v_exp_f32 v23, v23
  v_cvt_pk_bf16_f32 v50, v20, v21
  v_cvt_pk_bf16_f32 v51, v22, v23
  v_mfma_f32_32x32x16_bf16 v[80:95], a[200:203], v[56:59], v[80:95]
  global_load_dwordx4 a[8:11], v1, s[4:5] offset:2048 sc1
  v_exp_f32 v24, v24
  v_exp_f32 v25, v25
  v_exp_f32 v26, v26
  v_exp_f32 v27, v27
  v_cvt_pk_bf16_f32 v52, v24, v25
  v_cvt_pk_bf16_f32 v53, v26, v27
  v_mfma_f32_32x32x16_bf16 v[80:95], a[204:207], v[60:63], v[80:95]
  s_waitcnt vmcnt(10)
  v_exp_f32 v28, v28
  v_exp_f32 v29, v29
  v_exp_f32 v30, v30
  v_exp_f32 v31, v31
  v_cvt_pk_bf16_f32 v54, v28, v29
  v_cvt_pk_bf16_f32 v55, v30, v31
  v_mfma_f32_32x32x16_bf16 v[16:31], a[224:227], v[160:163], 0
  global_load_dwordx4 a[12:15], v1, s[4:5] offset:3072 sc1
  s_add_u32 s4, s4, 8192
  s_addc_u32 s5, s5, 0
  v_exp_f32 v32, v32
  v_exp_f32 v33, v33
  v_exp_f32 v34, v34
  v_exp_f32 v35, v35
  v_cvt_pk_bf16_f32 v56, v32, v33
  v_cvt_pk_bf16_f32 v57, v34, v35
  v_mfma_f32_32x32x16_bf16 v[16:31], a[228:231], v[164:167], v[16:31]
  global_load_dwordx4 a[16:19], v1, s[4:5] offset:-4096 sc1
  v_exp_f32 v36, v36
  v_exp_f32 v37, v37
  v_exp_f32 v38, v38
  v_exp_f32 v39, v39
  v_cvt_pk_bf16_f32 v58, v36, v37
  v_cvt_pk_bf16_f32 v59, v38, v39
  v_mfma_f32_32x32x16_bf16 v[64:79], a[216:219], v[48:51], v[64:79]
  global_load_dwordx4 a[20:23], v1, s[4:5] offset:-3072 sc1
  v_exp_f32 v40, v40
  v_exp_f32 v41, v41
  v_exp_f32 v42, v42
  v_exp_f32 v43, v43
  v_cvt_pk_bf16_f32 v60, v40, v41
  v_cvt_pk_bf16_f32 v61, v42, v43
  v_mfma_f32_32x32x16_bf16 v[64:79], a[220:223], v[52:55], v[64:79]
  v_exp_f32 v44, v44
  v_exp_f32 v45, v45
  v_exp_f32 v46, v46
  v_exp_f32 v47, v47
  v_cvt_pk_bf16_f32 v62, v44, v45
  v_cvt_pk_bf16_f32 v63, v46, v47
  v_mfma_f32_32x32x16_bf16 v[32:47], a[224:227], v[168:171], 0
  global_load_dwordx4 a[24:27], v1, s[4:5] offset:-2048 sc1
  v_exp_f32 v16, v16
  v_exp_f32 v17, v17
  v_exp_f32 v18, v18
  v_exp_f32 v19, v19
  v_cvt_pk_bf16_f32 v48, v16, v17
  v_cvt_pk_bf16_f32 v49, v18, v19
  v_mfma_f32_32x32x16_bf16 v[32:47], a[228:231], v[172:175], v[32:47]
  global_load_dwordx4 a[28:31], v1, s[4:5] offset:-1024 sc1
  v_exp_f32 v20, v20
  v_exp_f32 v21, v21
  v_exp_f32 v22, v22
  v_exp_f32 v23, v23
  v_cvt_pk_bf16_f32 v50, v20, v21
  v_cvt_pk_bf16_f32 v51, v22, v23
  v_mfma_f32_32x32x16_bf16 v[80:95], a[216:219], v[56:59], v[80:95]
  global_load_dwordx4 a[32:35], v1, s[4:5] offset:0 sc1
  v_exp_f32 v24, v24
  v_exp_f32 v25, v25
  v_exp_f32 v26, v26
  v_exp_f32 v27, v27
  v_cvt_pk_bf16_f32 v52, v24, v25
  v_cvt_pk_bf16_f32 v53, v26, v27
  v_mfma_f32_32x32x16_bf16 v[80:95], a[220:223], v[60:63], v[80:95]
  s_waitcnt vmcnt(12)
  v_exp_f32 v28, v28
  v_exp_f32 v29, v29
  v_exp_f32 v30, v30
  v_exp_f32 v31, v31
  v_cvt_pk_bf16_f32 v54, v28, v29
  v_cvt_pk_bf16_f32 v55, v30, v31
  v_mfma_f32_32x32x16_bf16 v[16:31], a[240:243], v[160:163], 0
  global_load_dwordx4 a[36:39], v1, s[4:5] offset:1024 sc1
  v_exp_f32 v32, v32
  v_exp_f32 v33, v33
  v_exp_f32 v34, v34
  v_exp_f32 v35, v35
  v_cvt_pk_bf16_f32 v56, v32, v33
  v_cvt_pk_bf16_f32 v57, v34, v35
  v_mfma_f32_32x32x16_bf16 v[16:31], a[244:247], v[164:167], v[16:31]
  s_lshl_b32 s57, s61, 14
  v_exp_f32 v36, v36
  v_exp_f32 v37, v37
  v_exp_f32 v38, v38
  v_exp_f32 v39, v39
  v_cvt_pk_bf16_f32 v58, v36, v37
  v_cvt_pk_bf16_f32 v59, v38, v39
  v_mfma_f32_32x32x16_bf16 v[64:79], a[232:235], v[48:51], v[64:79]
  global_load_dwordx4 a[40:43], v1, s[4:5] offset:2048 sc1
  v_exp_f32 v40, v40
  v_exp_f32 v41, v41
  v_exp_f32 v42, v42
  v_exp_f32 v43, v43
  v_cvt_pk_bf16_f32 v60, v40, v41
  v_cvt_pk_bf16_f32 v61, v42, v43
  v_mfma_f32_32x32x16_bf16 v[64:79], a[236:239], v[52:55], v[64:79]
  v_exp_f32 v44, v44
  v_exp_f32 v45, v45
  v_exp_f32 v46, v46
  v_exp_f32 v47, v47
  v_cvt_pk_bf16_f32 v62, v44, v45
  v_cvt_pk_bf16_f32 v63, v46, v47
  v_mfma_f32_32x32x16_bf16 v[32:47], a[240:243], v[168:171], 0
  global_load_dwordx4 a[44:47], v1, s[4:5] offset:3072 sc1
  s_add_u32 s4, s4, 8192
  s_addc_u32 s5, s5, 0
  v_exp_f32 v16, v16
  v_exp_f32 v17, v17
  v_exp_f32 v18, v18
  v_exp_f32 v19, v19
  v_cvt_pk_bf16_f32 v48, v16, v17
  v_cvt_pk_bf16_f32 v49, v18, v19
  v_mfma_f32_32x32x16_bf16 v[32:47], a[244:247], v[172:175], v[32:47]
  global_load_dwordx4 a[48:51], v1, s[4:5] offset:-4096 sc1
  v_exp_f32 v20, v20
  v_exp_f32 v21, v21
  v_exp_f32 v22, v22
  v_exp_f32 v23, v23
  v_cvt_pk_bf16_f32 v50, v20, v21
  v_cvt_pk_bf16_f32 v51, v22, v23
  v_mfma_f32_32x32x16_bf16 v[80:95], a[232:235], v[56:59], v[80:95]
  global_load_dwordx4 a[52:55], v1, s[4:5] offset:-3072 sc1
  v_exp_f32 v24, v24
  v_exp_f32 v25, v25
  v_exp_f32 v26, v26
  v_exp_f32 v27, v27
  v_cvt_pk_bf16_f32 v52, v24, v25
  v_cvt_pk_bf16_f32 v53, v26, v27
  v_mfma_f32_32x32x16_bf16 v[80:95], a[236:239], v[60:63], v[80:95]
  s_waitcnt vmcnt(12)
  v_exp_f32 v28, v28
  v_exp_f32 v29, v29
  v_exp_f32 v30, v30
  v_exp_f32 v31, v31
  v_cvt_pk_bf16_f32 v54, v28, v29
  v_cvt_pk_bf16_f32 v55, v30, v31
  v_mfma_f32_32x32x16_bf16 v[16:31], a[0:3], v[160:163], 0
  global_load_dwordx4 a[56:59], v1, s[4:5] offset:-2048 sc1
  v_exp_f32 v32, v32
  v_exp_f32 v33, v33
  v_exp_f32 v34, v34
  v_exp_f32 v35, v35
  v_cvt_pk_bf16_f32 v56, v32, v33
  v_cvt_pk_bf16_f32 v57, v34, v35
  v_mfma_f32_32x32x16_bf16 v[16:31], a[4:7], v[164:167], v[16:31]
  s_lshl_b32 s55, s60, 13
  v_exp_f32 v36, v36
  v_exp_f32 v37, v37
  v_exp_f32 v38, v38
  v_exp_f32 v39, v39
  v_cvt_pk_bf16_f32 v58, v36, v37
  v_cvt_pk_bf16_f32 v59, v38, v39
  v_mfma_f32_32x32x16_bf16 v[64:79], a[248:251], v[48:51], v[64:79]
  global_load_dwordx4 a[60:63], v1, s[4:5] offset:-1024 sc1
  v_exp_f32 v40, v40
  v_exp_f32 v41, v41
  v_exp_f32 v42, v42
  v_exp_f32 v43, v43
  v_cvt_pk_bf16_f32 v60, v40, v41
  v_cvt_pk_bf16_f32 v61, v42, v43
  v_mfma_f32_32x32x16_bf16 v[64:79], a[252:255], v[52:55], v[64:79]
  v_exp_f32 v44, v44
  v_exp_f32 v45, v45
  v_exp_f32 v46, v46
  v_exp_f32 v47, v47
  v_cvt_pk_bf16_f32 v62, v44, v45
  v_cvt_pk_bf16_f32 v63, v46, v47
  v_mfma_f32_32x32x16_bf16 v[32:47], a[0:3], v[168:171], 0
  global_load_dwordx4 a[64:67], v1, s[4:5] offset:0 sc1
  v_exp_f32 v16, v16
  v_exp_f32 v17, v17
  v_exp_f32 v18, v18
  v_exp_f32 v19, v19
  v_cvt_pk_bf16_f32 v48, v16, v17
  v_cvt_pk_bf16_f32 v49, v18, v19
  v_mfma_f32_32x32x16_bf16 v[32:47], a[4:7], v[172:175], v[32:47]
  global_load_dwordx4 a[68:71], v1, s[4:5] offset:1024 sc1
  v_exp_f32 v20, v20
  v_exp_f32 v21, v21
  v_exp_f32 v22, v22
  v_exp_f32 v23, v23
  v_cvt_pk_bf16_f32 v50, v20, v21
  v_cvt_pk_bf16_f32 v51, v22, v23
  v_mfma_f32_32x32x16_bf16 v[80:95], a[248:251], v[56:59], v[80:95]
  global_load_dwordx4 a[72:75], v1, s[4:5] offset:2048 sc1
  v_exp_f32 v24, v24
  v_exp_f32 v25, v25
  v_exp_f32 v26, v26
  v_exp_f32 v27, v27
  v_cvt_pk_bf16_f32 v52, v24, v25
  v_cvt_pk_bf16_f32 v53, v26, v27
  v_mfma_f32_32x32x16_bf16 v[80:95], a[252:255], v[60:63], v[80:95]
  s_waitcnt vmcnt(13)
  v_exp_f32 v28, v28
  v_exp_f32 v29, v29
  v_exp_f32 v30, v30
  v_exp_f32 v31, v31
  v_cvt_pk_bf16_f32 v54, v28, v29
  v_cvt_pk_bf16_f32 v55, v30, v31
  v_mfma_f32_32x32x16_bf16 v[16:31], a[16:19], v[160:163], 0
  global_load_dwordx4 a[76:79], v1, s[4:5] offset:3072 sc1
  s_add_u32 s4, s4, 8192
  s_addc_u32 s5, s5, 0
  v_exp_f32 v32, v32
  v_exp_f32 v33, v33
  v_exp_f32 v34, v34
  v_exp_f32 v35, v35
  v_cvt_pk_bf16_f32 v56, v32, v33
  v_cvt_pk_bf16_f32 v57, v34, v35
  v_mfma_f32_32x32x16_bf16 v[16:31], a[20:23], v[164:167], v[16:31]
  s_add_u32 s57, s57, s55
  v_exp_f32 v36, v36
  v_exp_f32 v37, v37
  v_exp_f32 v38, v38
  v_exp_f32 v39, v39
  v_cvt_pk_bf16_f32 v58, v36, v37
  v_cvt_pk_bf16_f32 v59, v38, v39
  v_mfma_f32_32x32x16_bf16 v[64:79], a[8:11], v[48:51], v[64:79]
  global_load_dwordx4 a[80:83], v1, s[4:5] offset:-4096 sc1
  v_exp_f32 v40, v40
  v_exp_f32 v41, v41
  v_exp_f32 v42, v42
  v_exp_f32 v43, v43
  v_cvt_pk_bf16_f32 v60, v40, v41
  v_cvt_pk_bf16_f32 v61, v42, v43
  v_mfma_f32_32x32x16_bf16 v[64:79], a[12:15], v[52:55], v[64:79]
  v_exp_f32 v44, v44
  v_exp_f32 v45, v45
  v_exp_f32 v46, v46
  v_exp_f32 v47, v47
  v_cvt_pk_bf16_f32 v62, v44, v45
  v_cvt_pk_bf16_f32 v63, v46, v47
  v_mfma_f32_32x32x16_bf16 v[32:47], a[16:19], v[168:171], 0
  global_load_dwordx4 a[84:87], v1, s[4:5] offset:-3072 sc1
  v_exp_f32 v16, v16
  v_exp_f32 v17, v17
  v_exp_f32 v18, v18
  v_exp_f32 v19, v19
  v_cvt_pk_bf16_f32 v48, v16, v17
  v_cvt_pk_bf16_f32 v49, v18, v19
  v_mfma_f32_32x32x16_bf16 v[32:47], a[20:23], v[172:175], v[32:47]
  global_load_dwordx4 a[88:91], v1, s[4:5] offset:-2048 sc1
  v_exp_f32 v20, v20
  v_exp_f32 v21, v21
  v_exp_f32 v22, v22
  v_exp_f32 v23, v23
  v_cvt_pk_bf16_f32 v50, v20, v21
  v_cvt_pk_bf16_f32 v51, v22, v23
  v_mfma_f32_32x32x16_bf16 v[80:95], a[8:11], v[56:59], v[80:95]
  global_load_dwordx4 a[92:95], v1, s[4:5] offset:-1024 sc1
  v_exp_f32 v24, v24
  v_exp_f32 v25, v25
  v_exp_f32 v26, v26
  v_exp_f32 v27, v27
  v_cvt_pk_bf16_f32 v52, v24, v25
  v_cvt_pk_bf16_f32 v53, v26, v27
  v_mfma_f32_32x32x16_bf16 v[80:95], a[12:15], v[60:63], v[80:95]
  s_waitcnt vmcnt(14)
  v_exp_f32 v28, v28
  v_exp_f32 v29, v29
  v_exp_f32 v30, v30
  v_exp_f32 v31, v31
  v_cvt_pk_bf16_f32 v54, v28, v29
  v_cvt_pk_bf16_f32 v55, v30, v31
  v_mfma_f32_32x32x16_bf16 v[16:31], a[32:35], v[160:163], 0
  global_load_dwordx4 a[96:99], v1, s[4:5] offset:0 sc1
  v_exp_f32 v32, v32
  v_exp_f32 v33, v33
  v_exp_f32 v34, v34
  v_exp_f32 v35, v35
  v_cvt_pk_bf16_f32 v56, v32, v33
  v_cvt_pk_bf16_f32 v57, v34, v35
  v_mfma_f32_32x32x16_bf16 v[16:31], a[36:39], v[164:167], v[16:31]
  s_lshl_b32 s55, s38, 11
  v_exp_f32 v36, v36
  v_exp_f32 v37, v37
  v_exp_f32 v38, v38
  v_exp_f32 v39, v39
  v_cvt_pk_bf16_f32 v58, v36, v37
  v_cvt_pk_bf16_f32 v59, v38, v39
  v_mfma_f32_32x32x16_bf16 v[64:79], a[24:27], v[48:51], v[64:79]
  global_load_dwordx4 a[100:103], v1, s[4:5] offset:1024 sc1
  v_exp_f32 v40, v40
  v_exp_f32 v41, v41
  v_exp_f32 v42, v42
  v_exp_f32 v43, v43
  v_cvt_pk_bf16_f32 v60, v40, v41
  v_cvt_pk_bf16_f32 v61, v42, v43
  v_mfma_f32_32x32x16_bf16 v[64:79], a[28:31], v[52:55], v[64:79]
  v_exp_f32 v44, v44
  v_exp_f32 v45, v45
  v_exp_f32 v46, v46
  v_exp_f32 v47, v47
  v_cvt_pk_bf16_f32 v62, v44, v45
  v_cvt_pk_bf16_f32 v63, v46, v47
  v_mfma_f32_32x32x16_bf16 v[32:47], a[32:35], v[168:171], 0
  global_load_dwordx4 a[104:107], v1, s[4:5] offset:2048 sc1
  v_exp_f32 v16, v16
  v_exp_f32 v17, v17
  v_exp_f32 v18, v18
  v_exp_f32 v19, v19
  v_cvt_pk_bf16_f32 v48, v16, v17
  v_cvt_pk_bf16_f32 v49, v18, v19
  v_mfma_f32_32x32x16_bf16 v[32:47], a[36:39], v[172:175], v[32:47]
  global_load_dwordx4 a[108:111], v1, s[4:5] offset:3072 sc1
  s_add_u32 s4, s4, 8192
  s_addc_u32 s5, s5, 0
  v_exp_f32 v20, v20
  v_exp_f32 v21, v21
  v_exp_f32 v22, v22
  v_exp_f32 v23, v23
  v_cvt_pk_bf16_f32 v50, v20, v21
  v_cvt_pk_bf16_f32 v51, v22, v23
  v_mfma_f32_32x32x16_bf16 v[80:95], a[24:27], v[56:59], v[80:95]
  global_load_dwordx4 a[112:115], v1, s[4:5] offset:-4096 sc1
  v_exp_f32 v24, v24
  v_exp_f32 v25, v25
  v_exp_f32 v26, v26
  v_exp_f32 v27, v27
  v_cvt_pk_bf16_f32 v52, v24, v25
  v_cvt_pk_bf16_f32 v53, v26, v27
  v_mfma_f32_32x32x16_bf16 v[80:95], a[28:31], v[60:63], v[80:95]
  s_waitcnt vmcnt(15)
  v_exp_f32 v28, v28
  v_exp_f32 v29, v29
  v_exp_f32 v30, v30
  v_exp_f32 v31, v31
  v_cvt_pk_bf16_f32 v54, v28, v29
  v_cvt_pk_bf16_f32 v55, v30, v31
  v_mfma_f32_32x32x16_bf16 v[16:31], a[48:51], v[160:163], 0
  global_load_dwordx4 a[116:119], v1, s[4:5] offset:-3072 sc1
  v_exp_f32 v32, v32
  v_exp_f32 v33, v33
  v_exp_f32 v34, v34
  v_exp_f32 v35, v35
  v_cvt_pk_bf16_f32 v56, v32, v33
  v_cvt_pk_bf16_f32 v57, v34, v35
  v_mfma_f32_32x32x16_bf16 v[16:31], a[52:55], v[164:167], v[16:31]
  s_add_u32 s57, s57, s55
  v_exp_f32 v36, v36
  v_exp_f32 v37, v37
  v_exp_f32 v38, v38
  v_exp_f32 v39, v39
  v_cvt_pk_bf16_f32 v58, v36, v37
  v_cvt_pk_bf16_f32 v59, v38, v39
  v_mfma_f32_32x32x16_bf16 v[64:79], a[40:43], v[48:51], v[64:79]
  global_load_dwordx4 a[120:123], v1, s[4:5] offset:-2048 sc1
  v_exp_f32 v40, v40
  v_exp_f32 v41, v41
  v_exp_f32 v42, v42
  v_exp_f32 v43, v43
  v_cvt_pk_bf16_f32 v60, v40, v41
  v_cvt_pk_bf16_f32 v61, v42, v43
  v_mfma_f32_32x32x16_bf16 v[64:79], a[44:47], v[52:55], v[64:79]
  v_exp_f32 v44, v44
  v_exp_f32 v45, v45
  v_exp_f32 v46, v46
  v_exp_f32 v47, v47
  v_cvt_pk_bf16_f32 v62, v44, v45
  v_cvt_pk_bf16_f32 v63, v46, v47
  v_mfma_f32_32x32x16_bf16 v[32:47], a[48:51], v[168:171], 0
  global_load_dwordx4 a[124:127], v1, s[4:5] offset:-1024 sc1
  v_exp_f32 v16, v16
  v_exp_f32 v17, v17
  v_exp_f32 v18, v18
  v_exp_f32 v19, v19
  v_cvt_pk_bf16_f32 v48, v16, v17
  v_cvt_pk_bf16_f32 v49, v18, v19
  v_mfma_f32_32x32x16_bf16 v[32:47], a[52:55], v[172:175], v[32:47]
  global_load_dwordx4 a[128:131], v1, s[4:5] offset:0 sc1
  v_exp_f32 v20, v20
  v_exp_f32 v21, v21
  v_exp_f32 v22, v22
  v_exp_f32 v23, v23
  v_cvt_pk_bf16_f32 v50, v20, v21
  v_cvt_pk_bf16_f32 v51, v22, v23
  v_mfma_f32_32x32x16_bf16 v[80:95], a[40:43], v[56:59], v[80:95]
  global_load_dwordx4 a[132:135], v1, s[4:5] offset:1024 sc1
  v_exp_f32 v24, v24
  v_exp_f32 v25, v25
  v_exp_f32 v26, v26
  v_exp_f32 v27, v27
  v_cvt_pk_bf16_f32 v52, v24, v25
  v_cvt_pk_bf16_f32 v53, v26, v27
  v_mfma_f32_32x32x16_bf16 v[80:95], a[44:47], v[60:63], v[80:95]
  s_waitcnt vmcnt(16)
  v_exp_f32 v28, v28
  v_exp_f32 v29, v29
  v_exp_f32 v30, v30
  v_exp_f32 v31, v31
  v_cvt_pk_bf16_f32 v54, v28, v29
  v_cvt_pk_bf16_f32 v55, v30, v31
  v_mfma_f32_32x32x16_bf16 v[16:31], a[64:67], v[160:163], 0
  global_load_dwordx4 a[136:139], v1, s[4:5] offset:2048 sc1
  v_exp_f32 v32, v32
  v_exp_f32 v33, v33
  v_exp_f32 v34, v34
  v_exp_f32 v35, v35
  v_cvt_pk_bf16_f32 v56, v32, v33
  v_cvt_pk_bf16_f32 v57, v34, v35
  v_mfma_f32_32x32x16_bf16 v[16:31], a[68:71], v[164:167], v[16:31]
  s_add_u32 s57, s57, 12582912
  v_exp_f32 v36, v36
  v_exp_f32 v37, v37
  v_exp_f32 v38, v38
  v_exp_f32 v39, v39
  v_cvt_pk_bf16_f32 v58, v36, v37
  v_cvt_pk_bf16_f32 v59, v38, v39
  v_mfma_f32_32x32x16_bf16 v[64:79], a[56:59], v[48:51], v[64:79]
  global_load_dwordx4 a[140:143], v1, s[4:5] offset:3072 sc1
  s_add_u32 s4, s4, 8192
  s_addc_u32 s5, s5, 0
  v_exp_f32 v40, v40
  v_exp_f32 v41, v41
  v_exp_f32 v42, v42
  v_exp_f32 v43, v43
  v_cvt_pk_bf16_f32 v60, v40, v41
  v_cvt_pk_bf16_f32 v61, v42, v43
  v_mfma_f32_32x32x16_bf16 v[64:79], a[60:63], v[52:55], v[64:79]
  buffer_load_dword v2, v235, s[16:19], 0 offen sc1
  v_exp_f32 v44, v44
  v_exp_f32 v45, v45
  v_exp_f32 v46, v46
  v_exp_f32 v47, v47
  v_cvt_pk_bf16_f32 v62, v44, v45
  v_cvt_pk_bf16_f32 v63, v46, v47
  v_mfma_f32_32x32x16_bf16 v[32:47], a[64:67], v[168:171], 0
  global_load_dwordx4 a[144:147], v1, s[4:5] offset:-4096 sc1
  v_exp_f32 v16, v16
  v_exp_f32 v17, v17
  v_exp_f32 v18, v18
  v_exp_f32 v19, v19
  v_cvt_pk_bf16_f32 v48, v16, v17
  v_cvt_pk_bf16_f32 v49, v18, v19
  v_mfma_f32_32x32x16_bf16 v[32:47], a[68:71], v[172:175], v[32:47]
  global_load_dwordx4 a[148:151], v1, s[4:5] offset:-3072 sc1
  v_exp_f32 v20, v20
  v_exp_f32 v21, v21
  v_exp_f32 v22, v22
  v_exp_f32 v23, v23
  v_cvt_pk_bf16_f32 v50, v20, v21
  v_cvt_pk_bf16_f32 v51, v22, v23
  v_mfma_f32_32x32x16_bf16 v[80:95], a[56:59], v[56:59], v[80:95]
  global_load_dwordx4 a[152:155], v1, s[4:5] offset:-2048 sc1
  v_exp_f32 v24, v24
  v_exp_f32 v25, v25
  v_exp_f32 v26, v26
  v_exp_f32 v27, v27
  v_cvt_pk_bf16_f32 v52, v24, v25
  v_cvt_pk_bf16_f32 v53, v26, v27
  v_mfma_f32_32x32x16_bf16 v[80:95], a[60:63], v[60:63], v[80:95]
  s_waitcnt vmcnt(18)
  v_exp_f32 v28, v28
  v_exp_f32 v29, v29
  v_exp_f32 v30, v30
  v_exp_f32 v31, v31
  v_cvt_pk_bf16_f32 v54, v28, v29
  v_cvt_pk_bf16_f32 v55, v30, v31
  v_mfma_f32_32x32x16_bf16 v[16:31], a[80:83], v[160:163], 0
  global_load_dwordx4 a[156:159], v1, s[4:5] offset:-1024 sc1
  v_exp_f32 v32, v32
  v_exp_f32 v33, v33
  v_exp_f32 v34, v34
  v_exp_f32 v35, v35
  v_cvt_pk_bf16_f32 v56, v32, v33
  v_cvt_pk_bf16_f32 v57, v34, v35
  v_mfma_f32_32x32x16_bf16 v[16:31], a[84:87], v[164:167], v[16:31]
  s_add_u32 s8, s64, 4096
  v_exp_f32 v36, v36
  v_exp_f32 v37, v37
  v_exp_f32 v38, v38
  v_exp_f32 v39, v39
  v_cvt_pk_bf16_f32 v58, v36, v37
  v_cvt_pk_bf16_f32 v59, v38, v39
  v_mfma_f32_32x32x16_bf16 v[64:79], a[72:75], v[48:51], v[64:79]
  global_load_dwordx4 a[160:163], v1, s[4:5] offset:0 sc1
  v_exp_f32 v40, v40
  v_exp_f32 v41, v41
  v_exp_f32 v42, v42
  v_exp_f32 v43, v43
  v_cvt_pk_bf16_f32 v60, v40, v41
  v_cvt_pk_bf16_f32 v61, v42, v43
  v_mfma_f32_32x32x16_bf16 v[64:79], a[76:79], v[52:55], v[64:79]
  v_exp_f32 v44, v44
  v_exp_f32 v45, v45
  v_exp_f32 v46, v46
  v_exp_f32 v47, v47
  v_cvt_pk_bf16_f32 v62, v44, v45
  v_cvt_pk_bf16_f32 v63, v46, v47
  v_mfma_f32_32x32x16_bf16 v[32:47], a[80:83], v[168:171], 0
  global_load_dwordx4 a[164:167], v1, s[4:5] offset:1024 sc1
  v_exp_f32 v16, v16
  v_exp_f32 v17, v17
  v_exp_f32 v18, v18
  v_exp_f32 v19, v19
  v_cvt_pk_bf16_f32 v48, v16, v17
  v_cvt_pk_bf16_f32 v49, v18, v19
  v_mfma_f32_32x32x16_bf16 v[32:47], a[84:87], v[172:175], v[32:47]
  global_load_dwordx4 a[168:171], v1, s[4:5] offset:2048 sc1
  v_exp_f32 v20, v20
  v_exp_f32 v21, v21
  v_exp_f32 v22, v22
  v_exp_f32 v23, v23
  v_cvt_pk_bf16_f32 v50, v20, v21
  v_cvt_pk_bf16_f32 v51, v22, v23
  v_mfma_f32_32x32x16_bf16 v[80:95], a[72:75], v[56:59], v[80:95]
  global_load_dwordx4 a[172:175], v1, s[4:5] offset:3072 sc1
  v_exp_f32 v24, v24
  v_exp_f32 v25, v25
  v_exp_f32 v26, v26
  v_exp_f32 v27, v27
  v_cvt_pk_bf16_f32 v52, v24, v25
  v_cvt_pk_bf16_f32 v53, v26, v27
  v_mfma_f32_32x32x16_bf16 v[80:95], a[76:79], v[60:63], v[80:95]
  s_waitcnt vmcnt(19)
  v_exp_f32 v28, v28
  v_exp_f32 v29, v29
  v_exp_f32 v30, v30
  v_exp_f32 v31, v31
  v_cvt_pk_bf16_f32 v54, v28, v29
  v_cvt_pk_bf16_f32 v55, v30, v31
  v_mfma_f32_32x32x16_bf16 v[16:31], a[96:99], v[160:163], 0
  s_add_u32 s8, s8, s16
  s_addc_u32 s9, s17, 0
  v_exp_f32 v32, v32
  v_exp_f32 v33, v33
  v_exp_f32 v34, v34
  v_exp_f32 v35, v35
  v_cvt_pk_bf16_f32 v56, v32, v33
  v_cvt_pk_bf16_f32 v57, v34, v35
  s_waitcnt vmcnt(8)
  v_cmp_ne_u32 vcc, v15, v2
  s_cbranch_vccnz L_oolZ
L_retZ:
  v_mfma_f32_32x32x16_bf16 v[16:31], a[100:103], v[164:167], v[16:31]
  global_load_dwordx4 v[192:195], v1, s[8:9] offset:-4096 sc1
  v_exp_f32 v36, v36
  v_exp_f32 v37, v37
  v_exp_f32 v38, v38
  v_exp_f32 v39, v39
  v_cvt_pk_bf16_f32 v58, v36, v37
  v_cvt_pk_bf16_f32 v59, v38, v39
  v_mfma_f32_32x32x16_bf16 v[64:79], a[88:91], v[48:51], v[64:79]
  global_load_dwordx4 v[196:199], v1, s[8:9] offset:-3072 sc1
  v_exp_f32 v40, v40
  v_exp_f32 v41, v41
  v_exp_f32 v42, v42
  v_exp_f32 v43, v43
  v_cvt_pk_bf16_f32 v60, v40, v41
  v_cvt_pk_bf16_f32 v61, v42, v43
  v_mfma_f32_32x32x16_bf16 v[64:79], a[92:95], v[52:55], v[64:79]
  global_load_dwordx4 v[200:203], v1, s[8:9] offset:-2048 sc1
  v_exp_f32 v44, v44
  v_exp_f32 v45, v45
  v_exp_f32 v46, v46
  v_exp_f32 v47, v47
  v_cvt_pk_bf16_f32 v62, v44, v45
  v_cvt_pk_bf16_f32 v63, v46, v47
  v_mfma_f32_32x32x16_bf16 v[32:47], a[96:99], v[168:171], 0
  global_load_dwordx4 v[204:207], v1, s[8:9] offset:-1024 sc1
  v_exp_f32 v16, v16
  v_exp_f32 v17, v17
  v_exp_f32 v18, v18
  v_exp_f32 v19, v19
  v_cvt_pk_bf16_f32 v48, v16, v17
  v_cvt_pk_bf16_f32 v49, v18, v19
  v_mfma_f32_32x32x16_bf16 v[32:47], a[100:103], v[172:175], v[32:47]
  global_load_dwordx4 v[208:211], v1, s[8:9] offset:0 sc1
  v_exp_f32 v20, v20
  v_exp_f32 v21, v21
  v_exp_f32 v22, v22
  v_exp_f32 v23, v23
  v_cvt_pk_bf16_f32 v50, v20, v21
  v_cvt_pk_bf16_f32 v51, v22, v23
  v_mfma_f32_32x32x16_bf16 v[80:95], a[88:91], v[56:59], v[80:95]
  global_load_dwordx4 v[212:215], v1, s[8:9] offset:1024 sc1
  v_exp_f32 v24, v24
  v_exp_f32 v25, v25
  v_exp_f32 v26, v26
  v_exp_f32 v27, v27
  v_cvt_pk_bf16_f32 v52, v24, v25
  v_cvt_pk_bf16_f32 v53, v26, v27
  v_mfma_f32_32x32x16_bf16 v[80:95], a[92:95], v[60:63], v[80:95]
  global_load_dwordx4 v[216:219], v1, s[8:9] offset:2048 sc1
  v_exp_f32 v28, v28
  v_exp_f32 v29, v29
  v_exp_f32 v30, v30
  v_exp_f32 v31, v31
  v_cvt_pk_bf16_f32 v54, v28, v29
  v_cvt_pk_bf16_f32 v55, v30, v31
  v_mfma_f32_32x32x16_bf16 v[16:31], a[112:115], v[160:163], 0
  global_load_dwordx4 v[220:223], v1, s[8:9] offset:3072 sc1
  v_exp_f32 v32, v32
  v_exp_f32 v33, v33
  v_exp_f32 v34, v34
  v_exp_f32 v35, v35
  v_cvt_pk_bf16_f32 v56, v32, v33
  v_cvt_pk_bf16_f32 v57, v34, v35
  v_mfma_f32_32x32x16_bf16 v[16:31], a[116:119], v[164:167], v[16:31]
  s_add_u32 s8, s8, 8192
  s_addc_u32 s9, s9, 0
  v_exp_f32 v36, v36
  v_exp_f32 v37, v37
  v_exp_f32 v38, v38
  v_exp_f32 v39, v39
  v_cvt_pk_bf16_f32 v58, v36, v37
  v_cvt_pk_bf16_f32 v59, v38, v39
  v_mfma_f32_32x32x16_bf16 v[64:79], a[104:107], v[48:51], v[64:79]
  global_load_dwordx4 v[96:99], v1, s[8:9] offset:-4096 sc1
  v_exp_f32 v40, v40
  v_exp_f32 v41, v41
  v_exp_f32 v42, v42
  v_exp_f32 v43, v43
  v_cvt_pk_bf16_f32 v60, v40, v41
  v_cvt_pk_bf16_f32 v61, v42, v43
  v_mfma_f32_32x32x16_bf16 v[64:79], a[108:111], v[52:55], v[64:79]
  global_load_dwordx4 v[100:103], v1, s[8:9] offset:-3072 sc1
  v_exp_f32 v44, v44
  v_exp_f32 v45, v45
  v_exp_f32 v46, v46
  v_exp_f32 v47, v47
  v_cvt_pk_bf16_f32 v62, v44, v45
  v_cvt_pk_bf16_f32 v63, v46, v47
  v_mfma_f32_32x32x16_bf16 v[32:47], a[112:115], v[168:171], 0
  global_load_dwordx4 v[104:107], v1, s[8:9] offset:-2048 sc1
  v_exp_f32 v16, v16
  v_exp_f32 v17, v17
  v_exp_f32 v18, v18
  v_exp_f32 v19, v19
  v_cvt_pk_bf16_f32 v48, v16, v17
  v_cvt_pk_bf16_f32 v49, v18, v19
  v_mfma_f32_32x32x16_bf16 v[32:47], a[116:119], v[172:175], v[32:47]
  global_load_dwordx4 v[108:111], v1, s[8:9] offset:-1024 sc1
  v_exp_f32 v20, v20
  v_exp_f32 v21, v21
  v_exp_f32 v22, v22
  v_exp_f32 v23, v23
  v_cvt_pk_bf16_f32 v50, v20, v21
  v_cvt_pk_bf16_f32 v51, v22, v23
  v_mfma_f32_32x32x16_bf16 v[80:95], a[104:107], v[56:59], v[80:95]
  global_load_dwordx4 v[112:115], v1, s[8:9] offset:0 sc1
  v_exp_f32 v24, v24
  v_exp_f32 v25, v25
  v_exp_f32 v26, v26
  v_exp_f32 v27, v27
  v_cvt_pk_bf16_f32 v52, v24, v25
  v_cvt_pk_bf16_f32 v53, v26, v27
  v_mfma_f32_32x32x16_bf16 v[80:95], a[108:111], v[60:63], v[80:95]
  global_load_dwordx4 v[116:119], v1, s[8:9] offset:1024 sc1
  v_exp_f32 v28, v28
  v_exp_f32 v29, v29
  v_exp_f32 v30, v30
  v_exp_f32 v31, v31
  v_cvt_pk_bf16_f32 v54, v28, v29
  v_cvt_pk_bf16_f32 v55, v30, v31
  v_mfma_f32_32x32x16_bf16 v[16:31], a[128:131], v[160:163], 0
  global_load_dwordx4 v[120:123], v1, s[8:9] offset:2048 sc1
  v_exp_f32 v32, v32
  v_exp_f32 v33, v33
  v_exp_f32 v34, v34
  v_exp_f32 v35, v35
  v_cvt_pk_bf16_f32 v56, v32, v33
  v_cvt_pk_bf16_f32 v57, v34, v35
  v_mfma_f32_32x32x16_bf16 v[16:31], a[132:135], v[164:167], v[16:31]
  global_load_dwordx4 v[124:127], v1, s[8:9] offset:3072 sc1
  v_exp_f32 v36, v36
  v_exp_f32 v37, v37
  v_exp_f32 v38, v38
  v_exp_f32 v39, v39
  v_cvt_pk_bf16_f32 v58, v36, v37
  v_cvt_pk_bf16_f32 v59, v38, v39
  v_mfma_f32_32x32x16_bf16 v[64:79], a[120:123], v[48:51], v[64:79]
  s_mov_b32 s50, 763363328
  v_exp_f32 v40, v40
  v_exp_f32 v41, v41
  v_exp_f32 v42, v42
  v_exp_f32 v43, v43
  v_cvt_pk_bf16_f32 v60, v40, v41
  v_cvt_pk_bf16_f32 v61, v42, v43
  v_mfma_f32_32x32x16_bf16 v[64:79], a[124:127], v[52:55], v[64:79]
  s_add_u32 s6, s20, s66
  s_addc_u32 s7, s21, 0
  v_exp_f32 v44, v44
  v_exp_f32 v45, v45
  v_exp_f32 v46, v46
  v_exp_f32 v47, v47
  v_cvt_pk_bf16_f32 v62, v44, v45
  v_cvt_pk_bf16_f32 v63, v46, v47
  v_mfma_f32_32x32x16_bf16 v[32:47], a[128:131], v[168:171], 0
  buffer_load_dwordx4 v[128:131], v1, s[16:19], s57 offen sc1
  v_exp_f32 v16, v16
  v_exp_f32 v17, v17
  v_exp_f32 v18, v18
  v_exp_f32 v19, v19
  v_cvt_pk_bf16_f32 v48, v16, v17
  v_cvt_pk_bf16_f32 v49, v18, v19
  v_mfma_f32_32x32x16_bf16 v[32:47], a[132:135], v[172:175], v[32:47]
  buffer_load_dwordx4 v[132:135], v1, s[16:19], s57 offen offset:1024 sc1
  v_exp_f32 v20, v20
  v_exp_f32 v21, v21
  v_exp_f32 v22, v22
  v_exp_f32 v23, v23
  v_cvt_pk_bf16_f32 v50, v20, v21
  v_cvt_pk_bf16_f32 v51, v22, v23
  v_mfma_f32_32x32x16_bf16 v[80:95], a[120:123], v[56:59], v[80:95]
  s_lshl_b32 s54, s61, 9
  v_exp_f32 v24, v24
  v_exp_f32 v25, v25
  v_exp_f32 v26, v26
  v_exp_f32 v27, v27
  v_cvt_pk_bf16_f32 v52, v24, v25
  v_cvt_pk_bf16_f32 v53, v26, v27
  v_mfma_f32_32x32x16_bf16 v[80:95], a[124:127], v[60:63], v[80:95]
  s_waitcnt vmcnt(24)
  s_add_u32 s54, s54, 14680064
  v_exp_f32 v28, v28
  v_exp_f32 v29, v29
  v_exp_f32 v30, v30
  v_exp_f32 v31, v31
  v_cvt_pk_bf16_f32 v54, v28, v29
  v_cvt_pk_bf16_f32 v55, v30, v31
  v_mfma_f32_32x32x16_bf16 v[16:31], a[144:147], v[160:163], 0
  s_lshl_b32 s55, s38, 7
  v_exp_f32 v32, v32
  v_exp_f32 v33, v33
  v_exp_f32 v34, v34
  v_exp_f32 v35, v35
  v_cvt_pk_bf16_f32 v56, v32, v33
  v_cvt_pk_bf16_f32 v57, v34, v35
  v_mfma_f32_32x32x16_bf16 v[16:31], a[148:151], v[164:167], v[16:31]
  s_add_u32 s55, s55, s54
  buffer_load_dword v9, v228, s[16:19], s55 offen sc1
  v_exp_f32 v36, v36
  v_exp_f32 v37, v37
  v_exp_f32 v38, v38
  v_exp_f32 v39, v39
  v_cvt_pk_bf16_f32 v58, v36, v37
  v_cvt_pk_bf16_f32 v59, v38, v39
  v_mfma_f32_32x32x16_bf16 v[64:79], a[136:139], v[48:51], v[64:79]
  s_lshr_b32 s55, s38, 1
  v_exp_f32 v40, v40
  v_exp_f32 v41, v41
  v_exp_f32 v42, v42
  v_exp_f32 v43, v43
  v_cvt_pk_bf16_f32 v60, v40, v41
  v_cvt_pk_bf16_f32 v61, v42, v43
  v_mfma_f32_32x32x16_bf16 v[64:79], a[140:143], v[52:55], v[64:79]
  s_lshl_b32 s55, s55, 7
  v_exp_f32 v44, v44
  v_exp_f32 v45, v45
  v_exp_f32 v46, v46
  v_exp_f32 v47, v47
  v_cvt_pk_bf16_f32 v62, v44, v45
  v_cvt_pk_bf16_f32 v63, v46, v47
  v_mfma_f32_32x32x16_bf16 v[32:47], a[144:147], v[168:171], 0
  s_add_u32 s55, s55, s54
  buffer_load_dword v10, v228, s[16:19], s55 offen sc1
  v_exp_f32 v16, v16
  v_exp_f32 v17, v17
  v_exp_f32 v18, v18
  v_exp_f32 v19, v19
  v_cvt_pk_bf16_f32 v48, v16, v17
  v_cvt_pk_bf16_f32 v49, v18, v19
  v_mfma_f32_32x32x16_bf16 v[32:47], a[148:151], v[172:175], v[32:47]
  buffer_load_dword v11, v228, s[16:19], s55 offen offset:256 sc1
  v_exp_f32 v20, v20
  v_exp_f32 v21, v21
  v_exp_f32 v22, v22
  v_exp_f32 v23, v23
  v_cvt_pk_bf16_f32 v50, v20, v21
  v_cvt_pk_bf16_f32 v51, v22, v23
  v_mfma_f32_32x32x16_bf16 v[80:95], a[136:139], v[56:59], v[80:95]
  s_add_u32 s10, s24, s66
  s_addc_u32 s11, s25, 0
  v_exp_f32 v24, v24
  v_exp_f32 v25, v25
  v_exp_f32 v26, v26
  v_exp_f32 v27, v27
  v_cvt_pk_bf16_f32 v52, v24, v25
  v_cvt_pk_bf16_f32 v53, v26, v27
  v_mfma_f32_32x32x16_bf16 v[80:95], a[140:143], v[60:63], v[80:95]
  s_waitcnt vmcnt(23)
  s_add_u32 s14, s6, 50176
  s_addc_u32 s15, s7, 0
  v_exp_f32 v28, v28
  v_exp_f32 v29, v29
  v_exp_f32 v30, v30
  v_exp_f32 v31, v31
  v_cvt_pk_bf16_f32 v54, v28, v29
  v_cvt_pk_bf16_f32 v55, v30, v31
  v_mfma_f32_32x32x16_bf16 v[16:31], a[160:163], v[160:163], 0
  s_add_u32 s32, s10, 50176
  s_addc_u32 s33, s11, 0
  v_exp_f32 v32, v32
  v_exp_f32 v33, v33
  v_exp_f32 v34, v34
  v_exp_f32 v35, v35
  v_cvt_pk_bf16_f32 v56, v32, v33
  v_cvt_pk_bf16_f32 v57, v34, v35
  v_mfma_f32_32x32x16_bf16 v[16:31], a[164:167], v[164:167], v[16:31]
  v_exp_f32 v36, v36
  v_exp_f32 v37, v37
  v_exp_f32 v38, v38
  v_exp_f32 v39, v39
  v_cvt_pk_bf16_f32 v58, v36, v37
  v_cvt_pk_bf16_f32 v59, v38, v39
  v_mfma_f32_32x32x16_bf16 v[64:79], a[152:155], v[48:51], v[64:79]
  v_exp_f32 v40, v40
  v_exp_f32 v41, v41
  v_exp_f32 v42, v42
  v_exp_f32 v43, v43
  v_cvt_pk_bf16_f32 v60, v40, v41
  v_cvt_pk_bf16_f32 v61, v42, v43
  v_mfma_f32_32x32x16_bf16 v[64:79], a[156:159], v[52:55], v[64:79]
  v_exp_f32 v44, v44
  v_exp_f32 v45, v45
  v_exp_f32 v46, v46
  v_exp_f32 v47, v47
  v_cvt_pk_bf16_f32 v62, v44, v45
  v_cvt_pk_bf16_f32 v63, v46, v47
  v_mfma_f32_32x32x16_bf16 v[32:47], a[160:163], v[168:171], 0
  v_exp_f32 v16, v16
  v_exp_f32 v17, v17
  v_exp_f32 v18, v18
  v_exp_f32 v19, v19
  v_cvt_pk_bf16_f32 v48, v16, v17
  v_cvt_pk_bf16_f32 v49, v18, v19
  v_mfma_f32_32x32x16_bf16 v[32:47], a[164:167], v[172:175], v[32:47]
  v_exp_f32 v20, v20
  v_exp_f32 v21, v21
  v_exp_f32 v22, v22
  v_exp_f32 v23, v23
  v_cvt_pk_bf16_f32 v50, v20, v21
  v_cvt_pk_bf16_f32 v51, v22, v23
  v_mfma_f32_32x32x16_bf16 v[80:95], a[152:155], v[56:59], v[80:95]
  v_exp_f32 v24, v24
  v_exp_f32 v25, v25
  v_exp_f32 v26, v26
  v_exp_f32 v27, v27
  v_cvt_pk_bf16_f32 v52, v24, v25
  v_cvt_pk_bf16_f32 v53, v26, v27
  v_mfma_f32_32x32x16_bf16 v[80:95], a[156:159], v[60:63], v[80:95]
  s_waitcnt vmcnt(21)
  v_exp_f32 v28, v28
  v_exp_f32 v29, v29
  v_exp_f32 v30, v30
  v_exp_f32 v31, v31
  v_cvt_pk_bf16_f32 v54, v28, v29
  v_cvt_pk_bf16_f32 v55, v30, v31
  v_mfma_f32_32x32x16_bf16 v[16:31], a[176:179], v[176:179], 0
  buffer_load_dword v249, v239, s[20:23], s90 offen
  v_exp_f32 v32, v32
  v_exp_f32 v33, v33
  v_exp_f32 v34, v34
  v_exp_f32 v35, v35
  v_cvt_pk_bf16_f32 v56, v32, v33
  v_cvt_pk_bf16_f32 v57, v34, v35
  s_waitcnt vmcnt(13)
  v_pk_add_f32 v[192:193], v[192:193], v[96:97]
  v_pk_add_f32 v[194:195], v[194:195], v[98:99]
  s_waitcnt vmcnt(12)
  v_pk_add_f32 v[196:197], v[196:197], v[100:101]
  v_pk_add_f32 v[198:199], v[198:199], v[102:103]
  v_mfma_f32_32x32x16_bf16 v[16:31], a[180:183], v[180:183], v[16:31]
  buffer_load_dword v249, v239, s[24:27], s90 offen
  v_exp_f32 v36, v36
  v_exp_f32 v37, v37
  v_exp_f32 v38, v38
  v_exp_f32 v39, v39
  v_cvt_pk_bf16_f32 v58, v36, v37
  v_cvt_pk_bf16_f32 v59, v38, v39
  s_waitcnt vmcnt(12)
  v_pk_add_f32 v[200:201], v[200:201], v[104:105]
  v_pk_add_f32 v[202:203], v[202:203], v[106:107]
  s_waitcnt vmcnt(11)
  v_pk_add_f32 v[204:205], v[204:205], v[108:109]
  v_pk_add_f32 v[206:207], v[206:207], v[110:111]
  v_mfma_f32_32x32x16_bf16 v[64:79], a[168:171], v[48:51], v[64:79]
  s_lshr_b32 s64, s38, 1
  v_exp_f32 v40, v40
  v_exp_f32 v41, v41
  v_exp_f32 v42, v42
  v_exp_f32 v43, v43
  v_cvt_pk_bf16_f32 v60, v40, v41
  v_cvt_pk_bf16_f32 v61, v42, v43
  s_waitcnt vmcnt(10)
  v_pk_add_f32 v[208:209], v[208:209], v[112:113]
  v_pk_add_f32 v[210:211], v[210:211], v[114:115]
  s_waitcnt vmcnt(9)
  v_pk_add_f32 v[212:213], v[212:213], v[116:117]
  v_pk_add_f32 v[214:215], v[214:215], v[118:119]
  v_mfma_f32_32x32x16_bf16 v[64:79], a[172:175], v[52:55], v[64:79]
  s_lshl_b32 s64, s64, 16
  v_exp_f32 v44, v44
  v_exp_f32 v45, v45
  v_exp_f32 v46, v46
  v_exp_f32 v47, v47
  v_cvt_pk_bf16_f32 v62, v44, v45
  v_cvt_pk_bf16_f32 v63, v46, v47
  s_waitcnt vmcnt(8)
  v_pk_add_f32 v[216:217], v[216:217], v[120:121]
  v_pk_add_f32 v[218:219], v[218:219], v[122:123]
  s_waitcnt vmcnt(7)
  v_pk_add_f32 v[220:221], v[220:221], v[124:125]
  v_pk_add_f32 v[222:223], v[222:223], v[126:127]
  v_mfma_f32_32x32x16_bf16 v[32:47], a[176:179], v[184:187], 0
  s_and_b32 s55, s38, 1
  v_exp_f32 v16, v16
  v_exp_f32 v17, v17
  v_exp_f32 v18, v18
  v_exp_f32 v19, v19
  v_cvt_pk_bf16_f32 v48, v16, v17
  v_cvt_pk_bf16_f32 v49, v18, v19
  v_pk_add_f32 v[192:193], v[192:193], v[208:209]
  v_pk_add_f32 v[194:195], v[194:195], v[210:211]
  v_pk_add_f32 v[196:197], v[196:197], v[212:213]
  v_pk_add_f32 v[198:199], v[198:199], v[214:215]
  v_mfma_f32_32x32x16_bf16 v[32:47], a[180:183], v[188:191], v[32:47]
  s_lshl_b32 s55, s55, 10
  v_exp_f32 v20, v20
  v_exp_f32 v21, v21
  v_exp_f32 v22, v22
  v_exp_f32 v23, v23
  v_cvt_pk_bf16_f32 v50, v20, v21
  v_cvt_pk_bf16_f32 v51, v22, v23
  v_pk_add_f32 v[200:201], v[200:201], v[216:217]
  v_pk_add_f32 v[202:203], v[202:203], v[218:219]
  v_pk_add_f32 v[204:205], v[204:205], v[220:221]
  v_pk_add_f32 v[206:207], v[206:207], v[222:223]
  v_mfma_f32_32x32x16_bf16 v[80:95], a[168:171], v[56:59], v[80:95]
  ds_write_b128 v230, v[64:67] offset:0
  v_exp_f32 v24, v24
  v_exp_f32 v25, v25
  v_exp_f32 v26, v26
  v_exp_f32 v27, v27
  v_cvt_pk_bf16_f32 v52, v24, v25
  v_cvt_pk_bf16_f32 v53, v26, v27
  v_pk_add_f32 v[192:193], v[192:193], v[200:201]
  v_pk_add_f32 v[194:195], v[194:195], v[202:203]
  v_pk_add_f32 v[196:197], v[196:197], v[204:205]
  v_pk_add_f32 v[198:199], v[198:199], v[206:207]
  v_mfma_f32_32x32x16_bf16 v[80:95], a[172:175], v[60:63], v[80:95]
  ds_write_b128 v230, v[68:71] offset:1024
  v_exp_f32 v28, v28
  v_exp_f32 v29, v29
  v_exp_f32 v30, v30
  v_exp_f32 v31, v31
  v_cvt_pk_bf16_f32 v54, v28, v29
  v_cvt_pk_bf16_f32 v55, v30, v31
  v_pk_add_f32 v[192:193], v[192:193], v[196:197]
  v_pk_add_f32 v[194:195], v[194:195], v[198:199]
  v_cvt_pk_bf16_f32 v192, v192, v193
  v_cvt_pk_bf16_f32 v193, v194, v195
  v_mfma_f32_32x32x16_bf16 v[16:31], a[192:195], v[176:179], 0
  ds_write_b128 v230, v[72:75] offset:2048
  v_exp_f32 v32, v32
  v_exp_f32 v33, v33
  v_exp_f32 v34, v34
  v_exp_f32 v35, v35
  v_cvt_pk_bf16_f32 v56, v32, v33
  v_cvt_pk_bf16_f32 v57, v34, v35
  v_mfma_f32_32x32x16_bf16 v[16:31], a[196:199], v[180:183], v[16:31]
  ds_write_b64 v226, v[192:193]
  v_exp_f32 v36, v36
  v_exp_f32 v37, v37
  v_exp_f32 v38, v38
  v_exp_f32 v39, v39
  v_cvt_pk_bf16_f32 v58, v36, v37
  v_cvt_pk_bf16_f32 v59, v38, v39
  v_mfma_f32_32x32x16_bf16 v[96:111], a[184:187], v[48:51], 0
  ds_write_b128 v230, v[76:79] offset:3072
  v_exp_f32 v40, v40
  v_exp_f32 v41, v41
  v_exp_f32 v42, v42
  v_exp_f32 v43, v43
  v_cvt_pk_bf16_f32 v60, v40, v41
  v_cvt_pk_bf16_f32 v61, v42, v43
  v_mfma_f32_32x32x16_bf16 v[96:111], a[188:191], v[52:55], v[96:111]
  ds_write_b128 v230, v[80:83] offset:4096
  v_exp_f32 v44, v44
  v_exp_f32 v45, v45
  v_exp_f32 v46, v46
  v_exp_f32 v47, v47
  v_cvt_pk_bf16_f32 v62, v44, v45
  v_cvt_pk_bf16_f32 v63, v46, v47
  v_mfma_f32_32x32x16_bf16 v[32:47], a[192:195], v[184:187], 0
  ds_write_b128 v230, v[84:87] offset:5120
  v_exp_f32 v16, v16
  v_exp_f32 v17, v17
  v_exp_f32 v18, v18
  v_exp_f32 v19, v19
  v_cvt_pk_bf16_f32 v48, v16, v17
  v_cvt_pk_bf16_f32 v49, v18, v19
  v_mfma_f32_32x32x16_bf16 v[32:47], a[196:199], v[188:191], v[32:47]
  s_add_u32 s64, s64, s55
  v_exp_f32 v20, v20
  v_exp_f32 v21, v21
  v_exp_f32 v22, v22
  v_exp_f32 v23, v23
  v_cvt_pk_bf16_f32 v50, v20, v21
  v_cvt_pk_bf16_f32 v51, v22, v23
  v_mfma_f32_32x32x16_bf16 v[112:127], a[184:187], v[56:59], 0
  ds_write_b128 v230, v[88:91] offset:6144
  v_exp_f32 v24, v24
  v_exp_f32 v25, v25
  v_exp_f32 v26, v26
  v_exp_f32 v27, v27
  v_cvt_pk_bf16_f32 v52, v24, v25
  v_cvt_pk_bf16_f32 v53, v26, v27
  v_mfma_f32_32x32x16_bf16 v[112:127], a[188:191], v[60:63], v[112:127]
  ds_write_b128 v230, v[92:95] offset:7168
  v_exp_f32 v28, v28
  v_exp_f32 v29, v29
  v_exp_f32 v30, v30
  v_exp_f32 v31, v31
  v_cvt_pk_bf16_f32 v54, v28, v29
  v_cvt_pk_bf16_f32 v55, v30, v31
  v_mfma_f32_32x32x16_bf16 v[16:31], a[208:211], v[176:179], 0
  s_add_u32 s64, s64, s65
  v_exp_f32 v32, v32
  v_exp_f32 v33, v33
  v_exp_f32 v34, v34
  v_exp_f32 v35, v35
  v_cvt_pk_bf16_f32 v56, v32, v33
  v_cvt_pk_bf16_f32 v57, v34, v35
  v_mfma_f32_32x32x16_bf16 v[16:31], a[212:215], v[180:183], v[16:31]
  s_waitcnt lgkmcnt(0)
  s_barrier
  v_exp_f32 v36, v36
  v_exp_f32 v37, v37
  v_exp_f32 v38, v38
  v_exp_f32 v39, v39
  v_cvt_pk_bf16_f32 v58, v36, v37
  v_cvt_pk_bf16_f32 v59, v38, v39
  v_mfma_f32_32x32x16_bf16 v[96:111], a[200:203], v[48:51], v[96:111]
  ds_read2st64_b32 v[144:145], v232 offset0:0 offset1:32
  ds_read2st64_b32 v[146:147], v232 offset0:64 offset1:96
  ds_read2st64_b32 v[148:149], v233 offset0:0 offset1:32
  ds_read2st64_b32 v[150:151], v233 offset0:64 offset1:96
  v_exp_f32 v40, v40
  v_exp_f32 v41, v41
  v_exp_f32 v42, v42
  v_exp_f32 v43, v43
  v_cvt_pk_bf16_f32 v60, v40, v41
  v_cvt_pk_bf16_f32 v61, v42, v43
  v_mfma_f32_32x32x16_bf16 v[96:111], a[204:207], v[52:55], v[96:111]
  ds_read_b128 v[192:195], v231 offset:0
  ds_read_b64 v[196:197], v253 offset:0
  ds_read_b64 v[198:199], v253 offset:2048
  v_exp_f32 v44, v44
  v_exp_f32 v45, v45
  v_exp_f32 v46, v46
  v_exp_f32 v47, v47
  v_cvt_pk_bf16_f32 v62, v44, v45
  v_cvt_pk_bf16_f32 v63, v46, v47
  v_mfma_f32_32x32x16_bf16 v[32:47], a[208:211], v[184:187], 0
  ds_read_b128 v[200:203], v231 offset:8192
  ds_read_b64 v[204:205], v253 offset:8192
  ds_read_b64 v[206:207], v253 offset:10240
  ds_read_b128 v[208:211], v231 offset:16384
  v_exp_f32 v16, v16
  v_exp_f32 v17, v17
  v_exp_f32 v18, v18
  v_exp_f32 v19, v19
  v_cvt_pk_bf16_f32 v48, v16, v17
  v_cvt_pk_bf16_f32 v49, v18, v19
  v_mfma_f32_32x32x16_bf16 v[32:47], a[212:215], v[188:191], v[32:47]
  ds_read_b64 v[212:213], v253 offset:16384
  ds_read_b64 v[214:215], v253 offset:18432
  ds_read_b128 v[216:219], v231 offset:24576
  ds_read_b64 v[220:221], v253 offset:24576
  ds_read_b64 v[222:223], v253 offset:26624
  v_exp_f32 v20, v20
  v_exp_f32 v21, v21
  v_exp_f32 v22, v22
  v_exp_f32 v23, v23
  v_cvt_pk_bf16_f32 v50, v20, v21
  v_cvt_pk_bf16_f32 v51, v22, v23
  v_mfma_f32_32x32x16_bf16 v[112:127], a[200:203], v[56:59], v[112:127]
  ds_read_b64 v[136:137], v227 offset:0
  ds_read_b64 v[138:139], v227 offset:512
  ds_read_b64 v[140:141], v227 offset:1024
  ds_read_b64 v[142:143], v227 offset:1536
  v_exp_f32 v24, v24
  v_exp_f32 v25, v25
  v_exp_f32 v26, v26
  v_exp_f32 v27, v27
  v_cvt_pk_bf16_f32 v52, v24, v25
  v_cvt_pk_bf16_f32 v53, v26, v27
  v_mfma_f32_32x32x16_bf16 v[112:127], a[204:207], v[60:63], v[112:127]
  s_add_u32 s64, s64, 32768
  v_exp_f32 v28, v28
  v_exp_f32 v29, v29
  v_exp_f32 v30, v30
  v_exp_f32 v31, v31
  v_cvt_pk_bf16_f32 v54, v28, v29
  v_cvt_pk_bf16_f32 v55, v30, v31
  s_waitcnt vmcnt(3)
  v_and_b32 v10, 0xFFFF0000, v10
  v_mfma_f32_32x32x16_bf16 v[16:31], a[224:227], v[176:179], 0
  s_lshl_b32 s62, s37, 4
  v_exp_f32 v32, v32
  v_exp_f32 v33, v33
  v_exp_f32 v34, v34
  v_exp_f32 v35, v35
  v_cvt_pk_bf16_f32 v56, v32, v33
  v_cvt_pk_bf16_f32 v57, v34, v35
  s_waitcnt lgkmcnt(15)
  v_pk_add_f32 v[144:145], v[144:145], v[146:147]
  v_pk_add_f32 v[148:149], v[148:149], v[150:151]
  v_add_f32 v144, v144, v145
  v_add_f32 v148, v148, v149
  v_mfma_f32_32x32x16_bf16 v[16:31], a[228:231], v[180:183], v[16:31]
  s_add_u32 s62, s62, s36
  v_exp_f32 v36, v36
  v_exp_f32 v37, v37
  v_exp_f32 v38, v38
  v_exp_f32 v39, v39
  v_cvt_pk_bf16_f32 v58, v36, v37
  v_cvt_pk_bf16_f32 v59, v38, v39
  s_waitcnt lgkmcnt(2)
  v_mfma_f32_32x32x16_bf16 v[64:79], v[136:139], v[128:131], 0
  v_rcp_f32 v146, v144
  v_mul_f32 v149, v148, v144
  v_add_f32 v148, v148, v144
  v_cmp_nle_f32 s[56:57], s50, v149
  v_mfma_f32_32x32x16_bf16 v[96:111], a[216:219], v[48:51], v[96:111]
  s_lshl_b32 s62, s62, 2
  v_exp_f32 v40, v40
  v_exp_f32 v41, v41
  v_exp_f32 v42, v42
  v_exp_f32 v43, v43
  v_cvt_pk_bf16_f32 v60, v40, v41
  v_cvt_pk_bf16_f32 v61, v42, v43
  s_waitcnt lgkmcnt(0)
  v_mfma_f32_32x32x16_bf16 v[64:79], v[140:143], v[132:135], v[64:79]
  v_cmp_nle_f32 vcc, v148, v229
  v_pk_add_f32 v[192:193], v[192:193], v[200:201]
  v_pk_add_f32 v[194:195], v[194:195], v[202:203]
  v_pk_add_f32 v[196:197], v[196:197], v[204:205]
  v_mfma_f32_32x32x16_bf16 v[96:111], a[220:223], v[52:55], v[96:111]
  s_add_u32 s62, s62, s38
  v_exp_f32 v44, v44
  v_exp_f32 v45, v45
  v_exp_f32 v46, v46
  v_exp_f32 v47, v47
  v_cvt_pk_bf16_f32 v62, v44, v45
  v_cvt_pk_bf16_f32 v63, v46, v47
  v_pk_add_f32 v[198:199], v[198:199], v[206:207]
  v_mul_f32 v146, v146, v10
  s_or_b64 vcc, vcc, s[56:57]
  s_cbranch_scc1 L_slow0
  v_pk_add_f32 v[208:209], v[208:209], v[216:217]
  v_mfma_f32_32x32x16_bf16 v[32:47], a[224:227], v[184:187], 0
  s_lshl_b32 s62, s62, 7
  v_exp_f32 v16, v16
  v_exp_f32 v17, v17
  v_exp_f32 v18, v18
  v_exp_f32 v19, v19
  v_cvt_pk_bf16_f32 v48, v16, v17
  v_cvt_pk_bf16_f32 v49, v18, v19
  v_pk_add_f32 v[210:211], v[210:211], v[218:219]
  v_pk_add_f32 v[212:213], v[212:213], v[220:221]
  v_pk_add_f32 v[214:215], v[214:215], v[222:223]
  v_pk_add_f32 v[192:193], v[192:193], v[208:209]
  v_mfma_f32_32x32x16_bf16 v[32:47], a[228:231], v[188:191], v[32:47]
  s_add_u32 s62, s62, 393216
  v_exp_f32 v20, v20
  v_exp_f32 v21, v21
  v_exp_f32 v22, v22
  v_exp_f32 v23, v23
  v_cvt_pk_bf16_f32 v50, v20, v21
  v_cvt_pk_bf16_f32 v51, v22, v23
  v_pk_add_f32 v[194:195], v[194:195], v[210:211]
  v_pk_add_f32 v[196:197], v[196:197], v[212:213]
  v_pk_add_f32 v[198:199], v[198:199], v[214:215]
  v_pk_mul_f32 v[192:193], v[192:193], v[146:147] op_sel_hi:[1,0]
  v_mfma_f32_32x32x16_bf16 v[112:127], a[216:219], v[56:59], v[112:127]
  s_add_u32 m0, s67, 0
  v_exp_f32 v24, v24
  v_exp_f32 v25, v25
  v_exp_f32 v26, v26
  v_exp_f32 v27, v27
  v_cvt_pk_bf16_f32 v52, v24, v25
  v_cvt_pk_bf16_f32 v53, v26, v27
  v_pk_mul_f32 v[194:195], v[194:195], v[146:147] op_sel_hi:[1,0]
  v_pk_mul_f32 v[196:197], v[196:197], v[146:147] op_sel_hi:[1,0]
  v_pk_mul_f32 v[198:199], v[198:199], v[146:147] op_sel_hi:[1,0]
  v_cvt_pk_bf16_f32 v152, v192, v193
  v_mfma_f32_32x32x16_bf16 v[112:127], a[220:223], v[60:63], v[112:127]
  global_load_lds_dwordx4 v234, s[6:7]
  v_exp_f32 v28, v28
  v_exp_f32 v29, v29
  v_exp_f32 v30, v30
  v_exp_f32 v31, v31
  v_cvt_pk_bf16_f32 v54, v28, v29
  v_cvt_pk_bf16_f32 v55, v30, v31
  v_cvt_pk_bf16_f32 v153, v194, v195
  v_cvt_pk_bf16_f32 v154, v196, v197
  v_cvt_pk_bf16_f32 v155, v198, v199
  v_cndmask_b32 v155, v155, 0, s[46:47]
  v_mfma_f32_32x32x16_bf16 v[16:31], a[240:243], v[176:179], 0
  buffer_store_dwordx4 v[152:155], v242, s[16:19], s64 offen sc1
  v_exp_f32 v32, v32
  v_exp_f32 v33, v33
  v_exp_f32 v34, v34
  v_exp_f32 v35, v35
  v_cvt_pk_bf16_f32 v56, v32, v33
  v_cvt_pk_bf16_f32 v57, v34, v35
  v_mov_b32 v2, v76
  v_mov_b32 v4, v76
  v_lshlrev_b32 v9, 16, v9
  v_mfma_f32_32x32x16_bf16 v[16:31], a[244:247], v[180:183], v[16:31]
  s_add_u32 s64, s64, 131072
  v_exp_f32 v36, v36
  v_exp_f32 v37, v37
  v_exp_f32 v38, v38
  v_exp_f32 v39, v39
  v_cvt_pk_bf16_f32 v58, v36, v37
  v_cvt_pk_bf16_f32 v59, v38, v39
  s_waitcnt vmcnt(4)
  v_and_b32 v11, 0xFFFF0000, v11
  v_permlane32_swap_b32 v2, v4
  v_add_f32 v4, s52, v4
  v_mfma_f32_32x32x16_bf16 v[96:111], a[232:235], v[48:51], v[96:111]
  s_add_u32 m0, s67, 1024
  v_exp_f32 v40, v40
  v_exp_f32 v41, v41
  v_exp_f32 v42, v42
  v_exp_f32 v43, v43
  v_cvt_pk_bf16_f32 v60, v40, v41
  v_cvt_pk_bf16_f32 v61, v42, v43
  v_rcp_f32 v4, v4
  s_nop 0
  v_mul_f32 v4, v4, v9
  v_pk_mul_f32 v[64:65], v[64:65], v[4:5] op_sel_hi:[1,0]
  v_mfma_f32_32x32x16_bf16 v[96:111], a[236:239], v[52:55], v[96:111]
  global_load_lds_dwordx4 v246, s[6:7]
  v_exp_f32 v44, v44
  v_exp_f32 v45, v45
  v_exp_f32 v46, v46
  v_exp_f32 v47, v47
  v_cvt_pk_bf16_f32 v62, v44, v45
  v_cvt_pk_bf16_f32 v63, v46, v47
  v_pk_mul_f32 v[66:67], v[66:67], v[4:5] op_sel_hi:[1,0]
  v_pk_mul_f32 v[68:69], v[68:69], v[4:5] op_sel_hi:[1,0]
  v_pk_mul_f32 v[70:71], v[70:71], v[4:5] op_sel_hi:[1,0]
  v_mfma_f32_32x32x16_bf16 v[32:47], a[240:243], v[184:187], 0
  s_lshl_b32 s54, s38, 16
  v_exp_f32 v16, v16
  v_exp_f32 v17, v17
  v_exp_f32 v18, v18
  v_exp_f32 v19, v19
  v_cvt_pk_bf16_f32 v48, v16, v17
  v_cvt_pk_bf16_f32 v49, v18, v19
  v_pk_mul_f32 v[72:73], v[72:73], v[4:5] op_sel_hi:[1,0]
  v_pk_mul_f32 v[74:75], v[74:75], v[4:5] op_sel_hi:[1,0]
  v_pk_mul_f32 v[76:77], v[76:77], v[4:5] op_sel_hi:[1,0]
  v_mfma_f32_32x32x16_bf16 v[32:47], a[244:247], v[188:191], v[32:47]
  s_add_u32 s54, s54, s65
  v_exp_f32 v20, v20
  v_exp_f32 v21, v21
  v_exp_f32 v22, v22
  v_exp_f32 v23, v23
  v_cvt_pk_bf16_f32 v50, v20, v21
  v_cvt_pk_bf16_f32 v51, v22, v23
  v_pk_mul_f32 v[78:79], v[78:79], v[4:5] op_sel_hi:[1,0]
  v_cvt_pk_bf16_f32 v80, v64, v65
  v_cvt_pk_bf16_f32 v81, v66, v67
  v_cvt_pk_bf16_f32 v82, v68, v69
  v_mfma_f32_32x32x16_bf16 v[112:127], a[232:235], v[56:59], v[112:127]
  s_add_u32 m0, s67, 2048
  v_exp_f32 v24, v24
  v_exp_f32 v25, v25
  v_exp_f32 v26, v26
  v_exp_f32 v27, v27
  v_cvt_pk_bf16_f32 v52, v24, v25
  v_cvt_pk_bf16_f32 v53, v26, v27
  v_cvt_pk_bf16_f32 v83, v70, v71
  v_cvt_pk_bf16_f32 v84, v72, v73
  v_cvt_pk_bf16_f32 v85, v74, v75
  v_mfma_f32_32x32x16_bf16 v[112:127], a[236:239], v[60:63], v[112:127]
  global_load_lds_dwordx4 v247, s[6:7]
  v_exp_f32 v28, v28
  v_exp_f32 v29, v29
  v_exp_f32 v30, v30
  v_exp_f32 v31, v31
  v_cvt_pk_bf16_f32 v54, v28, v29
  v_cvt_pk_bf16_f32 v55, v30, v31
  v_cvt_pk_bf16_f32 v86, v76, v77
  v_cvt_pk_bf16_f32 v87, v78, v79
  v_cndmask_b32 v86, v86, 0, s[46:47]
  v_cndmask_b32 v87, v87, 0, s[46:47]
  v_mfma_f32_32x32x16_bf16 v[16:31], a[0:3], v[176:179], 0
  buffer_store_dwordx4 v[80:83], v1, s[16:19], s54 offen sc1
  v_exp_f32 v32, v32
  v_exp_f32 v33, v33
  v_exp_f32 v34, v34
  v_exp_f32 v35, v35
  v_cvt_pk_bf16_f32 v56, v32, v33
  v_cvt_pk_bf16_f32 v57, v34, v35
  v_mfma_f32_32x32x16_bf16 v[16:31], a[4:7], v[180:183], v[16:31]
  buffer_store_dwordx4 v[84:87], v1, s[16:19], s54 offen offset:1024 sc1
  v_exp_f32 v36, v36
  v_exp_f32 v37, v37
  v_exp_f32 v38, v38
  v_exp_f32 v39, v39
  v_cvt_pk_bf16_f32 v58, v36, v37
  v_cvt_pk_bf16_f32 v59, v38, v39
  v_mfma_f32_32x32x16_bf16 v[96:111], a[248:251], v[48:51], v[96:111]
  s_add_u32 m0, s67, 3072
  v_exp_f32 v40, v40
  v_exp_f32 v41, v41
  v_exp_f32 v42, v42
  v_exp_f32 v43, v43
  v_cvt_pk_bf16_f32 v60, v40, v41
  v_cvt_pk_bf16_f32 v61, v42, v43
  v_mfma_f32_32x32x16_bf16 v[96:111], a[252:255], v[52:55], v[96:111]
  global_load_lds_dwordx4 v248, s[6:7]
  v_exp_f32 v44, v44
  v_exp_f32 v45, v45
  v_exp_f32 v46, v46
  v_exp_f32 v47, v47
  v_cvt_pk_bf16_f32 v62, v44, v45
  v_cvt_pk_bf16_f32 v63, v46, v47
  v_mfma_f32_32x32x16_bf16 v[32:47], a[0:3], v[184:187], 0
  s_add_u32 m0, s67, 4096
  v_exp_f32 v16, v16
  v_exp_f32 v17, v17
  v_exp_f32 v18, v18
  v_exp_f32 v19, v19
  v_cvt_pk_bf16_f32 v48, v16, v17
  v_cvt_pk_bf16_f32 v49, v18, v19
  v_mfma_f32_32x32x16_bf16 v[32:47], a[4:7], v[188:191], v[32:47]
  global_load_lds_dwordx4 v250, s[6:7]
  v_exp_f32 v20, v20
  v_exp_f32 v21, v21
  v_exp_f32 v22, v22
  v_exp_f32 v23, v23
  v_cvt_pk_bf16_f32 v50, v20, v21
  v_cvt_pk_bf16_f32 v51, v22, v23
  v_mfma_f32_32x32x16_bf16 v[112:127], a[248:251], v[56:59], v[112:127]
  s_add_u32 m0, s67, 5120
  v_exp_f32 v24, v24
  v_exp_f32 v25, v25
  v_exp_f32 v26, v26
  v_exp_f32 v27, v27
  v_cvt_pk_bf16_f32 v52, v24, v25
  v_cvt_pk_bf16_f32 v53, v26, v27
  v_mfma_f32_32x32x16_bf16 v[112:127], a[252:255], v[60:63], v[112:127]
  global_load_lds_dwordx4 v251, s[6:7]
  v_exp_f32 v28, v28
  v_exp_f32 v29, v29
  v_exp_f32 v30, v30
  v_exp_f32 v31, v31
  v_cvt_pk_bf16_f32 v54, v28, v29
  v_cvt_pk_bf16_f32 v55, v30, v31
  v_mfma_f32_32x32x16_bf16 v[16:31], a[16:19], v[176:179], 0
  s_add_u32 m0, s67, 6144
  v_exp_f32 v32, v32
  v_exp_f32 v33, v33
  v_exp_f32 v34, v34
  v_exp_f32 v35, v35
  v_cvt_pk_bf16_f32 v56, v32, v33
  v_cvt_pk_bf16_f32 v57, v34, v35
  v_mfma_f32_32x32x16_bf16 v[16:31], a[20:23], v[180:183], v[16:31]
  global_load_lds_dwordx4 v252, s[6:7]
  v_exp_f32 v36, v36
  v_exp_f32 v37, v37
  v_exp_f32 v38, v38
  v_exp_f32 v39, v39
  v_cvt_pk_bf16_f32 v58, v36, v37
  v_cvt_pk_bf16_f32 v59, v38, v39
  v_mfma_f32_32x32x16_bf16 v[96:111], a[8:11], v[48:51], v[96:111]
  s_add_u32 m0, s67, 7168
  v_exp_f32 v40, v40
  v_exp_f32 v41, v41
  v_exp_f32 v42, v42
  v_exp_f32 v43, v43
  v_cvt_pk_bf16_f32 v60, v40, v41
  v_cvt_pk_bf16_f32 v61, v42, v43
  v_mfma_f32_32x32x16_bf16 v[96:111], a[12:15], v[52:55], v[96:111]
  global_load_lds_dwordx4 v234, s[14:15]
  v_exp_f32 v44, v44
  v_exp_f32 v45, v45
  v_exp_f32 v46, v46
  v_exp_f32 v47, v47
  v_cvt_pk_bf16_f32 v62, v44, v45
  v_cvt_pk_bf16_f32 v63, v46, v47
  v_mfma_f32_32x32x16_bf16 v[32:47], a[16:19], v[184:187], 0
  s_add_u32 m0, s67, 8192
  v_exp_f32 v16, v16
  v_exp_f32 v17, v17
  v_exp_f32 v18, v18
  v_exp_f32 v19, v19
  v_cvt_pk_bf16_f32 v48, v16, v17
  v_cvt_pk_bf16_f32 v49, v18, v19
  v_mfma_f32_32x32x16_bf16 v[32:47], a[20:23], v[188:191], v[32:47]
  global_load_lds_dwordx4 v246, s[14:15]
  v_exp_f32 v20, v20
  v_exp_f32 v21, v21
  v_exp_f32 v22, v22
  v_exp_f32 v23, v23
  v_cvt_pk_bf16_f32 v50, v20, v21
  v_cvt_pk_bf16_f32 v51, v22, v23
  v_mfma_f32_32x32x16_bf16 v[112:127], a[8:11], v[56:59], v[112:127]
  s_add_u32 m0, s67, 9216
  v_exp_f32 v24, v24
  v_exp_f32 v25, v25
  v_exp_f32 v26, v26
  v_exp_f32 v27, v27
  v_cvt_pk_bf16_f32 v52, v24, v25
  v_cvt_pk_bf16_f32 v53, v26, v27
  v_mfma_f32_32x32x16_bf16 v[112:127], a[12:15], v[60:63], v[112:127]
  global_load_lds_dwordx4 v247, s[14:15]
  v_exp_f32 v28, v28
  v_exp_f32 v29, v29
  v_exp_f32 v30, v30
  v_exp_f32 v31, v31
  v_cvt_pk_bf16_f32 v54, v28, v29
  v_cvt_pk_bf16_f32 v55, v30, v31
  v_mfma_f32_32x32x16_bf16 v[16:31], a[32:35], v[176:179], 0
  s_add_u32 m0, s67, 10240
  v_exp_f32 v32, v32
  v_exp_f32 v33, v33
  v_exp_f32 v34, v34
  v_exp_f32 v35, v35
  v_cvt_pk_bf16_f32 v56, v32, v33
  v_cvt_pk_bf16_f32 v57, v34, v35
  v_mfma_f32_32x32x16_bf16 v[16:31], a[36:39], v[180:183], v[16:31]
  global_load_lds_dwordx4 v248, s[14:15]
  v_exp_f32 v36, v36
  v_exp_f32 v37, v37
  v_exp_f32 v38, v38
  v_exp_f32 v39, v39
  v_cvt_pk_bf16_f32 v58, v36, v37
  v_cvt_pk_bf16_f32 v59, v38, v39
  v_mfma_f32_32x32x16_bf16 v[96:111], a[24:27], v[48:51], v[96:111]
  s_add_u32 m0, s67, 11264
  v_exp_f32 v40, v40
  v_exp_f32 v41, v41
  v_exp_f32 v42, v42
  v_exp_f32 v43, v43
  v_cvt_pk_bf16_f32 v60, v40, v41
  v_cvt_pk_bf16_f32 v61, v42, v43
  v_mfma_f32_32x32x16_bf16 v[96:111], a[28:31], v[52:55], v[96:111]
  global_load_lds_dwordx4 v250, s[14:15]
  v_exp_f32 v44, v44
  v_exp_f32 v45, v45
  v_exp_f32 v46, v46
  v_exp_f32 v47, v47
  v_cvt_pk_bf16_f32 v62, v44, v45
  v_cvt_pk_bf16_f32 v63, v46, v47
  v_mfma_f32_32x32x16_bf16 v[32:47], a[32:35], v[184:187], 0
  s_waitcnt vmcnt(9)
  v_exp_f32 v16, v16
  v_exp_f32 v17, v17
  v_exp_f32 v18, v18
  v_exp_f32 v19, v19
  v_cvt_pk_bf16_f32 v48, v16, v17
  v_cvt_pk_bf16_f32 v49, v18, v19
  v_mfma_f32_32x32x16_bf16 v[32:47], a[36:39], v[188:191], v[32:47]
  buffer_store_dword v15, v14, s[16:19], s62 offen sc1
  v_exp_f32 v20, v20
  v_exp_f32 v21, v21
  v_exp_f32 v22, v22
  v_exp_f32 v23, v23
  v_cvt_pk_bf16_f32 v50, v20, v21
  v_cvt_pk_bf16_f32 v51, v22, v23
  v_mfma_f32_32x32x16_bf16 v[112:127], a[24:27], v[56:59], v[112:127]
  s_add_u32 m0, s67, 12288
  v_exp_f32 v24, v24
  v_exp_f32 v25, v25
  v_exp_f32 v26, v26
  v_exp_f32 v27, v27
  v_cvt_pk_bf16_f32 v52, v24, v25
  v_cvt_pk_bf16_f32 v53, v26, v27
  v_mfma_f32_32x32x16_bf16 v[112:127], a[28:31], v[60:63], v[112:127]
  global_load_lds_dwordx4 v251, s[14:15]
  v_exp_f32 v28, v28
  v_exp_f32 v29, v29
  v_exp_f32 v30, v30
  v_exp_f32 v31, v31
  v_cvt_pk_bf16_f32 v54, v28, v29
  v_cvt_pk_bf16_f32 v55, v30, v31
  v_mfma_f32_32x32x16_bf16 v[16:31], a[48:51], v[176:179], 0
  s_add_u32 m0, s67, 13312
  v_exp_f32 v32, v32
  v_exp_f32 v33, v33
  v_exp_f32 v34, v34
  v_exp_f32 v35, v35
  v_cvt_pk_bf16_f32 v56, v32, v33
  v_cvt_pk_bf16_f32 v57, v34, v35
  v_mfma_f32_32x32x16_bf16 v[16:31], a[52:55], v[180:183], v[16:31]
  global_load_lds_dwordx4 v252, s[14:15]
  v_exp_f32 v36, v36
  v_exp_f32 v37, v37
  v_exp_f32 v38, v38
  v_exp_f32 v39, v39
  v_cvt_pk_bf16_f32 v58, v36, v37
  v_cvt_pk_bf16_f32 v59, v38, v39
  v_mfma_f32_32x32x16_bf16 v[96:111], a[40:43], v[48:51], v[96:111]
  s_add_u32 m0, s67, 14336
  v_exp_f32 v40, v40
  v_exp_f32 v41, v41
  v_exp_f32 v42, v42
  v_exp_f32 v43, v43
  v_cvt_pk_bf16_f32 v60, v40, v41
  v_cvt_pk_bf16_f32 v61, v42, v43
  v_mfma_f32_32x32x16_bf16 v[96:111], a[44:47], v[52:55], v[96:111]
  global_load_lds_dwordx4 v252, s[14:15]
  v_exp_f32 v44, v44
  v_exp_f32 v45, v45
  v_exp_f32 v46, v46
  v_exp_f32 v47, v47
  v_cvt_pk_bf16_f32 v62, v44, v45
  v_cvt_pk_bf16_f32 v63, v46, v47
  v_mfma_f32_32x32x16_bf16 v[32:47], a[48:51], v[184:187], 0
  s_add_u32 m0, s67, 15360
  v_exp_f32 v16, v16
  v_exp_f32 v17, v17
  v_exp_f32 v18, v18
  v_exp_f32 v19, v19
  v_cvt_pk_bf16_f32 v48, v16, v17
  v_cvt_pk_bf16_f32 v49, v18, v19
  v_mfma_f32_32x32x16_bf16 v[32:47], a[52:55], v[188:191], v[32:47]
  global_load_lds_dwordx4 v234, s[10:11]
  v_exp_f32 v20, v20
  v_exp_f32 v21, v21
  v_exp_f32 v22, v22
  v_exp_f32 v23, v23
  v_cvt_pk_bf16_f32 v50, v20, v21
  v_cvt_pk_bf16_f32 v51, v22, v23
  v_mfma_f32_32x32x16_bf16 v[112:127], a[40:43], v[56:59], v[112:127]
  s_add_u32 m0, s67, 16384
  v_exp_f32 v24, v24
  v_exp_f32 v25, v25
  v_exp_f32 v26, v26
  v_exp_f32 v27, v27
  v_cvt_pk_bf16_f32 v52, v24, v25
  v_cvt_pk_bf16_f32 v53, v26, v27
  v_mfma_f32_32x32x16_bf16 v[112:127], a[44:47], v[60:63], v[112:127]
  global_load_lds_dwordx4 v246, s[10:11]
  v_exp_f32 v28, v28
  v_exp_f32 v29, v29
  v_exp_f32 v30, v30
  v_exp_f32 v31, v31
  v_cvt_pk_bf16_f32 v54, v28, v29
  v_cvt_pk_bf16_f32 v55, v30, v31
  v_mfma_f32_32x32x16_bf16 v[16:31], a[64:67], v[176:179], 0
  s_add_u32 m0, s67, 17408
  v_exp_f32 v32, v32
  v_exp_f32 v33, v33
  v_exp_f32 v34, v34
  v_exp_f32 v35, v35
  v_cvt_pk_bf16_f32 v56, v32, v33
  v_cvt_pk_bf16_f32 v57, v34, v35
  v_mfma_f32_32x32x16_bf16 v[16:31], a[68:71], v[180:183], v[16:31]
  global_load_lds_dwordx4 v247, s[10:11]
  v_exp_f32 v36, v36
  v_exp_f32 v37, v37
  v_exp_f32 v38, v38
  v_exp_f32 v39, v39
  v_cvt_pk_bf16_f32 v58, v36, v37
  v_cvt_pk_bf16_f32 v59, v38, v39
  v_mfma_f32_32x32x16_bf16 v[96:111], a[56:59], v[48:51], v[96:111]
  s_add_u32 m0, s67, 18432
  v_exp_f32 v40, v40
  v_exp_f32 v41, v41
  v_exp_f32 v42, v42
  v_exp_f32 v43, v43
  v_cvt_pk_bf16_f32 v60, v40, v41
  v_cvt_pk_bf16_f32 v61, v42, v43
  v_mfma_f32_32x32x16_bf16 v[96:111], a[60:63], v[52:55], v[96:111]
  global_load_lds_dwordx4 v248, s[10:11]
  v_exp_f32 v44, v44
  v_exp_f32 v45, v45
  v_exp_f32 v46, v46
  v_exp_f32 v47, v47
  v_cvt_pk_bf16_f32 v62, v44, v45
  v_cvt_pk_bf16_f32 v63, v46, v47
  v_mfma_f32_32x32x16_bf16 v[32:47], a[64:67], v[184:187], 0
  s_barrier
  v_exp_f32 v16, v16
  v_exp_f32 v17, v17
  v_exp_f32 v18, v18
  v_exp_f32 v19, v19
  v_cvt_pk_bf16_f32 v48, v16, v17
  v_cvt_pk_bf16_f32 v49, v18, v19
  v_mfma_f32_32x32x16_bf16 v[32:47], a[68:71], v[188:191], v[32:47]
  s_add_u32 m0, s67, 19456
  v_exp_f32 v20, v20
  v_exp_f32 v21, v21
  v_exp_f32 v22, v22
  v_exp_f32 v23, v23
  v_cvt_pk_bf16_f32 v50, v20, v21
  v_cvt_pk_bf16_f32 v51, v22, v23
  v_mfma_f32_32x32x16_bf16 v[112:127], a[56:59], v[56:59], v[112:127]
  global_load_lds_dwordx4 v250, s[10:11]
  v_exp_f32 v24, v24
  v_exp_f32 v25, v25
  v_exp_f32 v26, v26
  v_exp_f32 v27, v27
  v_cvt_pk_bf16_f32 v52, v24, v25
  v_cvt_pk_bf16_f32 v53, v26, v27
  v_mfma_f32_32x32x16_bf16 v[112:127], a[60:63], v[60:63], v[112:127]
  s_add_u32 m0, s67, 20480
  v_exp_f32 v28, v28
  v_exp_f32 v29, v29
  v_exp_f32 v30, v30
  v_exp_f32 v31, v31
  v_cvt_pk_bf16_f32 v54, v28, v29
  v_cvt_pk_bf16_f32 v55, v30, v31
  v_mfma_f32_32x32x16_bf16 v[16:31], a[80:83], v[176:179], 0
  global_load_lds_dwordx4 v251, s[10:11]
  v_exp_f32 v32, v32
  v_exp_f32 v33, v33
  v_exp_f32 v34, v34
  v_exp_f32 v35, v35
  v_cvt_pk_bf16_f32 v56, v32, v33
  v_cvt_pk_bf16_f32 v57, v34, v35
  v_mfma_f32_32x32x16_bf16 v[16:31], a[84:87], v[180:183], v[16:31]
  s_add_u32 m0, s67, 21504
  v_exp_f32 v36, v36
  v_exp_f32 v37, v37
  v_exp_f32 v38, v38
  v_exp_f32 v39, v39
  v_cvt_pk_bf16_f32 v58, v36, v37
  v_cvt_pk_bf16_f32 v59, v38, v39
  v_mfma_f32_32x32x16_bf16 v[96:111], a[72:75], v[48:51], v[96:111]
  global_load_lds_dwordx4 v252, s[10:11]
  v_exp_f32 v40, v40
  v_exp_f32 v41, v41
  v_exp_f32 v42, v42
  v_exp_f32 v43, v43
  v_cvt_pk_bf16_f32 v60, v40, v41
  v_cvt_pk_bf16_f32 v61, v42, v43
  v_mfma_f32_32x32x16_bf16 v[96:111], a[76:79], v[52:55], v[96:111]
  s_add_u32 m0, s67, 22528
  v_exp_f32 v44, v44
  v_exp_f32 v45, v45
  v_exp_f32 v46, v46
  v_exp_f32 v47, v47
  v_cvt_pk_bf16_f32 v62, v44, v45
  v_cvt_pk_bf16_f32 v63, v46, v47
  v_mfma_f32_32x32x16_bf16 v[32:47], a[80:83], v[184:187], 0
  global_load_lds_dwordx4 v234, s[32:33]
  v_exp_f32 v16, v16
  v_exp_f32 v17, v17
  v_exp_f32 v18, v18
  v_exp_f32 v19, v19
  v_cvt_pk_bf16_f32 v48, v16, v17
  v_cvt_pk_bf16_f32 v49, v18, v19
  v_mfma_f32_32x32x16_bf16 v[32:47], a[84:87], v[188:191], v[32:47]
  s_add_u32 m0, s67, 23552
  v_exp_f32 v20, v20
  v_exp_f32 v21, v21
  v_exp_f32 v22, v22
  v_exp_f32 v23, v23
  v_cvt_pk_bf16_f32 v50, v20, v21
  v_cvt_pk_bf16_f32 v51, v22, v23
  v_mfma_f32_32x32x16_bf16 v[112:127], a[72:75], v[56:59], v[112:127]
  global_load_lds_dwordx4 v246, s[32:33]
  v_exp_f32 v24, v24
  v_exp_f32 v25, v25
  v_exp_f32 v26, v26
  v_exp_f32 v27, v27
  v_cvt_pk_bf16_f32 v52, v24, v25
  v_cvt_pk_bf16_f32 v53, v26, v27
  v_mfma_f32_32x32x16_bf16 v[112:127], a[76:79], v[60:63], v[112:127]
  s_add_u32 m0, s67, 24576
  v_exp_f32 v28, v28
  v_exp_f32 v29, v29
  v_exp_f32 v30, v30
  v_exp_f32 v31, v31
  v_cvt_pk_bf16_f32 v54, v28, v29
  v_cvt_pk_bf16_f32 v55, v30, v31
  v_mfma_f32_32x32x16_bf16 v[16:31], a[96:99], v[176:179], 0
  global_load_lds_dwordx4 v247, s[32:33]
  v_exp_f32 v32, v32
  v_exp_f32 v33, v33
  v_exp_f32 v34, v34
  v_exp_f32 v35, v35
  v_cvt_pk_bf16_f32 v56, v32, v33
  v_cvt_pk_bf16_f32 v57, v34, v35
  v_mfma_f32_32x32x16_bf16 v[16:31], a[100:103], v[180:183], v[16:31]
  s_add_u32 m0, s67, 25600
  v_exp_f32 v36, v36
  v_exp_f32 v37, v37
  v_exp_f32 v38, v38
  v_exp_f32 v39, v39
  v_cvt_pk_bf16_f32 v58, v36, v37
  v_cvt_pk_bf16_f32 v59, v38, v39
  v_mfma_f32_32x32x16_bf16 v[96:111], a[88:91], v[48:51], v[96:111]
  global_load_lds_dwordx4 v248, s[32:33]
  v_exp_f32 v40, v40
  v_exp_f32 v41, v41
  v_exp_f32 v42, v42
  v_exp_f32 v43, v43
  v_cvt_pk_bf16_f32 v60, v40, v41
  v_cvt_pk_bf16_f32 v61, v42, v43
  v_mfma_f32_32x32x16_bf16 v[96:111], a[92:95], v[52:55], v[96:111]
  s_add_u32 m0, s67, 26624
  v_exp_f32 v44, v44
  v_exp_f32 v45, v45
  v_exp_f32 v46, v46
  v_exp_f32 v47, v47
  v_cvt_pk_bf16_f32 v62, v44, v45
  v_cvt_pk_bf16_f32 v63, v46, v47
  v_mfma_f32_32x32x16_bf16 v[32:47], a[96:99], v[184:187], 0
  buffer_load_dword v2, v237, s[16:19], s88 offen sc1
  v_exp_f32 v16, v16
  v_exp_f32 v17, v17
  v_exp_f32 v18, v18
  v_exp_f32 v19, v19
  v_cvt_pk_bf16_f32 v48, v16, v17
  v_cvt_pk_bf16_f32 v49, v18, v19
  v_mfma_f32_32x32x16_bf16 v[32:47], a[100:103], v[188:191], v[32:47]
  global_load_lds_dwordx4 v250, s[32:33]
  v_exp_f32 v20, v20
  v_exp_f32 v21, v21
  v_exp_f32 v22, v22
  v_exp_f32 v23, v23
  v_cvt_pk_bf16_f32 v50, v20, v21
  v_cvt_pk_bf16_f32 v51, v22, v23
  v_mfma_f32_32x32x16_bf16 v[112:127], a[88:91], v[56:59], v[112:127]
  s_add_u32 m0, s67, 27648
  v_exp_f32 v24, v24
  v_exp_f32 v25, v25
  v_exp_f32 v26, v26
  v_exp_f32 v27, v27
  v_cvt_pk_bf16_f32 v52, v24, v25
  v_cvt_pk_bf16_f32 v53, v26, v27
  v_mfma_f32_32x32x16_bf16 v[112:127], a[92:95], v[60:63], v[112:127]
  global_load_lds_dwordx4 v251, s[32:33]
  v_exp_f32 v28, v28
  v_exp_f32 v29, v29
  v_exp_f32 v30, v30
  v_exp_f32 v31, v31
  v_cvt_pk_bf16_f32 v54, v28, v29
  v_cvt_pk_bf16_f32 v55, v30, v31
  v_mfma_f32_32x32x16_bf16 v[16:31], a[112:115], v[176:179], 0
  s_add_u32 m0, s67, 28672
  v_exp_f32 v32, v32
  v_exp_f32 v33, v33
  v_exp_f32 v34, v34
  v_exp_f32 v35, v35
  v_cvt_pk_bf16_f32 v56, v32, v33
  v_cvt_pk_bf16_f32 v57, v34, v35
  v_mfma_f32_32x32x16_bf16 v[16:31], a[116:119], v[180:183], v[16:31]
  global_load_lds_dwordx4 v252, s[32:33]
  v_exp_f32 v36, v36
  v_exp_f32 v37, v37
  v_exp_f32 v38, v38
  v_exp_f32 v39, v39
  v_cvt_pk_bf16_f32 v58, v36, v37
  v_cvt_pk_bf16_f32 v59, v38, v39
  v_mfma_f32_32x32x16_bf16 v[96:111], a[104:107], v[48:51], v[96:111]
  s_add_u32 m0, s67, 29696
  v_exp_f32 v40, v40
  v_exp_f32 v41, v41
  v_exp_f32 v42, v42
  v_exp_f32 v43, v43
  v_cvt_pk_bf16_f32 v60, v40, v41
  v_cvt_pk_bf16_f32 v61, v42, v43
  v_mfma_f32_32x32x16_bf16 v[96:111], a[108:111], v[52:55], v[96:111]
  global_load_lds_dwordx4 v252, s[32:33]
  v_exp_f32 v44, v44
  v_exp_f32 v45, v45
  v_exp_f32 v46, v46
  v_exp_f32 v47, v47
  v_cvt_pk_bf16_f32 v62, v44, v45
  v_cvt_pk_bf16_f32 v63, v46, v47
  v_mfma_f32_32x32x16_bf16 v[32:47], a[112:115], v[184:187], 0
  s_add_u32 s12, s87, 4096
  v_exp_f32 v16, v16
  v_exp_f32 v17, v17
  v_exp_f32 v18, v18
  v_exp_f32 v19, v19
  v_cvt_pk_bf16_f32 v48, v16, v17
  v_cvt_pk_bf16_f32 v49, v18, v19
  v_mfma_f32_32x32x16_bf16 v[32:47], a[116:119], v[188:191], v[32:47]
  s_add_u32 s12, s12, s16
  s_addc_u32 s13, s17, 0
  v_exp_f32 v20, v20
  v_exp_f32 v21, v21
  v_exp_f32 v22, v22
  v_exp_f32 v23, v23
  v_cvt_pk_bf16_f32 v50, v20, v21
  v_cvt_pk_bf16_f32 v51, v22, v23
  v_mfma_f32_32x32x16_bf16 v[112:127], a[104:107], v[56:59], v[112:127]
  v_exp_f32 v24, v24
  v_exp_f32 v25, v25
  v_exp_f32 v26, v26
  v_exp_f32 v27, v27
  v_cvt_pk_bf16_f32 v52, v24, v25
  v_cvt_pk_bf16_f32 v53, v26, v27
  v_mfma_f32_32x32x16_bf16 v[112:127], a[108:111], v[60:63], v[112:127]
  v_exp_f32 v28, v28
  v_exp_f32 v29, v29
  v_exp_f32 v30, v30
  v_exp_f32 v31, v31
  v_cvt_pk_bf16_f32 v54, v28, v29
  v_cvt_pk_bf16_f32 v55, v30, v31
  v_mfma_f32_32x32x16_bf16 v[16:31], a[128:131], v[176:179], 0
  v_exp_f32 v32, v32
  v_exp_f32 v33, v33
  v_exp_f32 v34, v34
  v_exp_f32 v35, v35
  v_cvt_pk_bf16_f32 v56, v32, v33
  v_cvt_pk_bf16_f32 v57, v34, v35
  s_waitcnt vmcnt(4)
  v_cmp_ne_u32 vcc, v15, v2
  s_cbranch_vccnz L_oolE
L_retE:
  v_mfma_f32_32x32x16_bf16 v[16:31], a[132:135], v[180:183], v[16:31]
  global_load_dwordx4 a[176:179], v1, s[12:13] offset:-4096 sc1
  v_exp_f32 v36, v36
  v_exp_f32 v37, v37
  v_exp_f32 v38, v38
  v_exp_f32 v39, v39
  v_cvt_pk_bf16_f32 v58, v36, v37
  v_cvt_pk_bf16_f32 v59, v38, v39
  v_mfma_f32_32x32x16_bf16 v[96:111], a[120:123], v[48:51], v[96:111]
  global_load_dwordx4 a[180:183], v1, s[12:13] offset:-3072 sc1
  v_exp_f32 v40, v40
  v_exp_f32 v41, v41
  v_exp_f32 v42, v42
  v_exp_f32 v43, v43
  v_cvt_pk_bf16_f32 v60, v40, v41
  v_cvt_pk_bf16_f32 v61, v42, v43
  v_mfma_f32_32x32x16_bf16 v[96:111], a[124:127], v[52:55], v[96:111]
  global_load_dwordx4 a[184:187], v1, s[12:13] offset:-2048 sc1
  v_exp_f32 v44, v44
  v_exp_f32 v45, v45
  v_exp_f32 v46, v46
  v_exp_f32 v47, v47
  v_cvt_pk_bf16_f32 v62, v44, v45
  v_cvt_pk_bf16_f32 v63, v46, v47
  v_mfma_f32_32x32x16_bf16 v[32:47], a[128:131], v[184:187], 0
  global_load_dwordx4 a[188:191], v1, s[12:13] offset:-1024 sc1
  v_exp_f32 v16, v16
  v_exp_f32 v17, v17
  v_exp_f32 v18, v18
  v_exp_f32 v19, v19
  v_cvt_pk_bf16_f32 v48, v16, v17
  v_cvt_pk_bf16_f32 v49, v18, v19
  v_mfma_f32_32x32x16_bf16 v[32:47], a[132:135], v[188:191], v[32:47]
  global_load_dwordx4 a[192:195], v1, s[12:13] offset:0 sc1
  v_exp_f32 v20, v20
  v_exp_f32 v21, v21
  v_exp_f32 v22, v22
  v_exp_f32 v23, v23
  v_cvt_pk_bf16_f32 v50, v20, v21
  v_cvt_pk_bf16_f32 v51, v22, v23
  v_mfma_f32_32x32x16_bf16 v[112:127], a[120:123], v[56:59], v[112:127]
  global_load_dwordx4 a[196:199], v1, s[12:13] offset:1024 sc1
  v_exp_f32 v24, v24
  v_exp_f32 v25, v25
  v_exp_f32 v26, v26
  v_exp_f32 v27, v27
  v_cvt_pk_bf16_f32 v52, v24, v25
  v_cvt_pk_bf16_f32 v53, v26, v27
  v_mfma_f32_32x32x16_bf16 v[112:127], a[124:127], v[60:63], v[112:127]
  global_load_dwordx4 a[200:203], v1, s[12:13] offset:2048 sc1
  v_exp_f32 v28, v28
  v_exp_f32 v29, v29
  v_exp_f32 v30, v30
  v_exp_f32 v31, v31
  v_cvt_pk_bf16_f32 v54, v28, v29
  v_cvt_pk_bf16_f32 v55, v30, v31
  v_mfma_f32_32x32x16_bf16 v[16:31], a[144:147], v[176:179], 0
  global_load_dwordx4 a[204:207], v1, s[12:13] offset:3072 sc1
  v_exp_f32 v32, v32
  v_exp_f32 v33, v33
  v_exp_f32 v34, v34
  v_exp_f32 v35, v35
  v_cvt_pk_bf16_f32 v56, v32, v33
  v_cvt_pk_bf16_f32 v57, v34, v35
  v_mfma_f32_32x32x16_bf16 v[16:31], a[148:151], v[180:183], v[16:31]
  s_add_u32 s12, s12, 131072
  s_addc_u32 s13, s13, 0
  v_exp_f32 v36, v36
  v_exp_f32 v37, v37
  v_exp_f32 v38, v38
  v_exp_f32 v39, v39
  v_cvt_pk_bf16_f32 v58, v36, v37
  v_cvt_pk_bf16_f32 v59, v38, v39
  v_mfma_f32_32x32x16_bf16 v[96:111], a[136:139], v[48:51], v[96:111]
  global_load_dwordx4 a[240:243], v1, s[12:13] offset:-4096 sc1
  v_exp_f32 v40, v40
  v_exp_f32 v41, v41
  v_exp_f32 v42, v42
  v_exp_f32 v43, v43
  v_cvt_pk_bf16_f32 v60, v40, v41
  v_cvt_pk_bf16_f32 v61, v42, v43
  v_mfma_f32_32x32x16_bf16 v[96:111], a[140:143], v[52:55], v[96:111]
  global_load_dwordx4 a[244:247], v1, s[12:13] offset:-3072 sc1
  v_exp_f32 v44, v44
  v_exp_f32 v45, v45
  v_exp_f32 v46, v46
  v_exp_f32 v47, v47
  v_cvt_pk_bf16_f32 v62, v44, v45
  v_cvt_pk_bf16_f32 v63, v46, v47
  v_mfma_f32_32x32x16_bf16 v[32:47], a[144:147], v[184:187], 0
  global_load_dwordx4 a[248:251], v1, s[12:13] offset:-2048 sc1
  v_exp_f32 v16, v16
  v_exp_f32 v17, v17
  v_exp_f32 v18, v18
  v_exp_f32 v19, v19
  v_cvt_pk_bf16_f32 v48, v16, v17
  v_cvt_pk_bf16_f32 v49, v18, v19
  v_mfma_f32_32x32x16_bf16 v[32:47], a[148:151], v[188:191], v[32:47]
  global_load_dwordx4 a[252:255], v1, s[12:13] offset:-1024 sc1
  v_exp_f32 v20, v20
  v_exp_f32 v21, v21
  v_exp_f32 v22, v22
  v_exp_f32 v23, v23
  v_cvt_pk_bf16_f32 v50, v20, v21
  v_cvt_pk_bf16_f32 v51, v22, v23
  v_mfma_f32_32x32x16_bf16 v[112:127], a[136:139], v[56:59], v[112:127]
  global_load_dwordx4 a[0:3], v1, s[12:13] offset:0 sc1
  v_exp_f32 v24, v24
  v_exp_f32 v25, v25
  v_exp_f32 v26, v26
  v_exp_f32 v27, v27
  v_cvt_pk_bf16_f32 v52, v24, v25
  v_cvt_pk_bf16_f32 v53, v26, v27
  v_mfma_f32_32x32x16_bf16 v[112:127], a[140:143], v[60:63], v[112:127]
  global_load_dwordx4 a[4:7], v1, s[12:13] offset:1024 sc1
  v_exp_f32 v28, v28
  v_exp_f32 v29, v29
  v_exp_f32 v30, v30
  v_exp_f32 v31, v31
  v_cvt_pk_bf16_f32 v54, v28, v29
  v_cvt_pk_bf16_f32 v55, v30, v31
  v_mfma_f32_32x32x16_bf16 v[16:31], a[160:163], v[176:179], 0
  global_load_dwordx4 a[8:11], v1, s[12:13] offset:2048 sc1
  v_exp_f32 v32, v32
  v_exp_f32 v33, v33
  v_exp_f32 v34, v34
  v_exp_f32 v35, v35
  v_cvt_pk_bf16_f32 v56, v32, v33
  v_cvt_pk_bf16_f32 v57, v34, v35
  v_mfma_f32_32x32x16_bf16 v[16:31], a[164:167], v[180:183], v[16:31]
  global_load_dwordx4 a[12:15], v1, s[12:13] offset:3072 sc1
  v_exp_f32 v36, v36
  v_exp_f32 v37, v37
  v_exp_f32 v38, v38
  v_exp_f32 v39, v39
  v_cvt_pk_bf16_f32 v58, v36, v37
  v_cvt_pk_bf16_f32 v59, v38, v39
  v_mfma_f32_32x32x16_bf16 v[96:111], a[152:155], v[48:51], v[96:111]
  s_sub_u32 s12, s12, 98304
  s_subb_u32 s13, s13, 0
  v_exp_f32 v40, v40
  v_exp_f32 v41, v41
  v_exp_f32 v42, v42
  v_exp_f32 v43, v43
  v_cvt_pk_bf16_f32 v60, v40, v41
  v_cvt_pk_bf16_f32 v61, v42, v43
  v_mfma_f32_32x32x16_bf16 v[96:111], a[156:159], v[52:55], v[96:111]
  global_load_dwordx4 a[208:211], v242, s[12:13] offset:-4096 sc1
  v_exp_f32 v44, v44
  v_exp_f32 v45, v45
  v_exp_f32 v46, v46
  v_exp_f32 v47, v47
  v_cvt_pk_bf16_f32 v62, v44, v45
  v_cvt_pk_bf16_f32 v63, v46, v47
  v_mfma_f32_32x32x16_bf16 v[32:47], a[160:163], v[184:187], 0
  global_load_dwordx4 a[212:215], v242, s[12:13] offset:-3072 sc1
  v_exp_f32 v16, v16
  v_exp_f32 v17, v17
  v_exp_f32 v18, v18
  v_exp_f32 v19, v19
  v_cvt_pk_bf16_f32 v48, v16, v17
  v_cvt_pk_bf16_f32 v49, v18, v19
  v_mfma_f32_32x32x16_bf16 v[32:47], a[164:167], v[188:191], v[32:47]
  global_load_dwordx4 a[216:219], v242, s[12:13] offset:-2048 sc1
  v_exp_f32 v20, v20
  v_exp_f32 v21, v21
  v_exp_f32 v22, v22
  v_exp_f32 v23, v23
  v_cvt_pk_bf16_f32 v50, v20, v21
  v_cvt_pk_bf16_f32 v51, v22, v23
  v_mfma_f32_32x32x16_bf16 v[112:127], a[152:155], v[56:59], v[112:127]
  global_load_dwordx4 a[220:223], v242, s[12:13] offset:-1024 sc1
  v_exp_f32 v24, v24
  v_exp_f32 v25, v25
  v_exp_f32 v26, v26
  v_exp_f32 v27, v27
  v_cvt_pk_bf16_f32 v52, v24, v25
  v_cvt_pk_bf16_f32 v53, v26, v27
  v_mfma_f32_32x32x16_bf16 v[112:127], a[156:159], v[60:63], v[112:127]
  global_load_dwordx4 a[224:227], v242, s[12:13] offset:0 sc1
  v_exp_f32 v28, v28
  v_exp_f32 v29, v29
  v_exp_f32 v30, v30
  v_exp_f32 v31, v31
  v_cvt_pk_bf16_f32 v54, v28, v29
  v_cvt_pk_bf16_f32 v55, v30, v31
  v_mfma_f32_32x32x16_bf16 v[96:111], a[168:171], v[48:51], v[96:111]
  global_load_dwordx4 a[228:231], v242, s[12:13] offset:1024 sc1
  v_exp_f32 v32, v32
  v_exp_f32 v33, v33
  v_exp_f32 v34, v34
  v_exp_f32 v35, v35
  v_cvt_pk_bf16_f32 v56, v32, v33
  v_cvt_pk_bf16_f32 v57, v34, v35
  v_mfma_f32_32x32x16_bf16 v[96:111], a[172:175], v[52:55], v[96:111]
  global_load_dwordx4 a[232:235], v242, s[12:13] offset:2048 sc1
  v_exp_f32 v36, v36
  v_exp_f32 v37, v37
  v_exp_f32 v38, v38
  v_exp_f32 v39, v39
  v_cvt_pk_bf16_f32 v58, v36, v37
  v_cvt_pk_bf16_f32 v59, v38, v39
  s_nop 1
  v_mfma_f32_32x32x16_bf16 v[112:127], a[168:171], v[56:59], v[112:127]
  s_nop 1
  ds_write_b128 v230, v[96:99] offset:0
  ds_write_b128 v230, v[100:103] offset:1024
  global_load_dwordx4 a[236:239], v242, s[12:13] offset:3072 sc1
  v_exp_f32 v40, v40
  v_exp_f32 v41, v41
  v_exp_f32 v42, v42
  v_exp_f32 v43, v43
  v_cvt_pk_bf16_f32 v60, v40, v41
  v_cvt_pk_bf16_f32 v61, v42, v43
  ds_write_b128 v230, v[104:107] offset:2048
  ds_write_b128 v230, v[108:111] offset:3072
  s_add_u32 s12, s12, 131072
  s_addc_u32 s13, s13, 0
  v_exp_f32 v44, v44
  v_exp_f32 v45, v45
  v_exp_f32 v46, v46
  v_exp_f32 v47, v47
  v_cvt_pk_bf16_f32 v62, v44, v45
  v_cvt_pk_bf16_f32 v63, v46, v47
  s_nop 1
  v_mfma_f32_32x32x16_bf16 v[112:127], a[172:175], v[60:63], v[112:127]
  s_nop 11
  ds_write_b128 v230, v[112:115] offset:4096
  ds_write_b128 v230, v[116:119] offset:5120
  ds_write_b128 v230, v[120:123] offset:6144
  ds_write_b128 v230, v[124:127] offset:7168
  s_waitcnt lgkmcnt(0)
  s_barrier
  ds_read2st64_b32 v[144:145], v232 offset0:0 offset1:32
  ds_read2st64_b32 v[146:147], v232 offset0:64 offset1:96
  ds_read2st64_b32 v[148:149], v233 offset0:0 offset1:32
  ds_read2st64_b32 v[150:151], v233 offset0:64 offset1:96
  ds_read_b128 v[192:195], v231 offset:0
  ds_read_b64 v[196:197], v253 offset:0
  ds_read_b64 v[198:199], v253 offset:2048
  ds_read_b128 v[200:203], v231 offset:8192
  ds_read_b64 v[204:205], v253 offset:8192
  ds_read_b64 v[206:207], v253 offset:10240
  ds_read_b128 v[208:211], v231 offset:16384
  ds_read_b64 v[212:213], v253 offset:16384
  ds_read_b64 v[214:215], v253 offset:18432
  ds_read_b128 v[216:219], v231 offset:24576
  ds_read_b64 v[220:221], v253 offset:24576
  ds_read_b64 v[222:223], v253 offset:26624
  s_waitcnt lgkmcnt(14)
  v_pk_add_f32 v[144:145], v[144:145], v[146:147]
  s_waitcnt lgkmcnt(12)
  v_pk_add_f32 v[148:149], v[148:149], v[150:151]
  v_add_f32 v144, v144, v145
  v_add_f32 v148, v148, v149
  v_rcp_f32 v146, v144
  v_mul_f32 v149, v148, v144
  v_add_f32 v148, v148, v144
  v_cmp_nle_f32 s[56:57], s50, v149
  v_cmp_nle_f32 vcc, v148, v229
  s_waitcnt lgkmcnt(8)
  v_pk_add_f32 v[192:193], v[192:193], v[200:201]
  v_pk_add_f32 v[194:195], v[194:195], v[202:203]
  s_waitcnt lgkmcnt(7)
  v_pk_add_f32 v[196:197], v[196:197], v[204:205]
  s_waitcnt lgkmcnt(6)
  v_pk_add_f32 v[198:199], v[198:199], v[206:207]
  v_mul_f32 v146, v146, v11
  s_or_b64 vcc, vcc, s[56:57]
  s_cbranch_scc1 L_slow1
  s_waitcnt lgkmcnt(2)
  v_pk_add_f32 v[208:209], v[208:209], v[216:217]
  v_pk_add_f32 v[210:211], v[210:211], v[218:219]
  s_waitcnt lgkmcnt(1)
  v_pk_add_f32 v[212:213], v[212:213], v[220:221]
  s_waitcnt lgkmcnt(0)
  v_pk_add_f32 v[214:215], v[214:215], v[222:223]
  v_pk_add_f32 v[192:193], v[192:193], v[208:209]
  v_pk_add_f32 v[194:195], v[194:195], v[210:211]
  v_pk_add_f32 v[196:197], v[196:197], v[212:213]
  v_pk_add_f32 v[198:199], v[198:199], v[214:215]
  v_pk_mul_f32 v[192:193], v[192:193], v[146:147] op_sel_hi:[1,0]
  v_pk_mul_f32 v[194:195], v[194:195], v[146:147] op_sel_hi:[1,0]
  v_pk_mul_f32 v[196:197], v[196:197], v[146:147] op_sel_hi:[1,0]
  v_pk_mul_f32 v[198:199], v[198:199], v[146:147] op_sel_hi:[1,0]
  v_cvt_pk_bf16_f32 v152, v192, v193
  v_cvt_pk_bf16_f32 v153, v194, v195
  v_cvt_pk_bf16_f32 v154, v196, v197
  v_cvt_pk_bf16_f32 v155, v198, v199
  v_cndmask_b32 v155, v155, v245, s[46:47]
  buffer_store_dwordx4 v[152:155], v242, s[16:19], s64 offen sc1
L_tail:
  s_cmp_ge_u32 s2, 224
  s_cbranch_scc1 L_oolIdle
  s_waitcnt vmcnt(25)
  ds_read_b64_tr_b16 a[16:17], v240 offset:0
  ds_read_b64_tr_b16 a[18:19], v240 offset:1024
  ds_read_b64_tr_b16 a[20:21], v241 offset:0
  ds_read_b64_tr_b16 a[22:23], v241 offset:1024
  ds_read_b64_tr_b16 a[24:25], v240 offset:2048
  ds_read_b64_tr_b16 a[26:27], v240 offset:3072
  ds_read_b64_tr_b16 a[28:29], v241 offset:2048
  ds_read_b64_tr_b16 a[30:31], v241 offset:3072
  s_waitcnt vmcnt(24) lgkmcnt(6)
  v_mfma_f32_32x32x16_bf16 v[16:31], a[16:19], a[176:179], 0
  ds_read_b64_tr_b16 a[32:33], v240 offset:3584
  ds_read_b64_tr_b16 a[34:35], v240 offset:4608
  s_waitcnt vmcnt(16)
  v_mfma_f32_32x32x16_bf16 v[48:63], a[16:19], a[240:243], 0
  s_waitcnt lgkmcnt(6)
  v_mfma_f32_32x32x16_bf16 v[32:47], a[20:23], a[176:179], 0
  ds_read_b64_tr_b16 a[36:37], v241 offset:3584
  ds_read_b64_tr_b16 a[38:39], v241 offset:4608
  v_mfma_f32_32x32x16_bf16 v[64:79], a[20:23], a[240:243], 0
  s_waitcnt lgkmcnt(6)
  v_mfma_f32_32x32x16_bf16 v[16:31], a[24:27], a[180:183], v[16:31]
  ds_read_b64_tr_b16 a[40:41], v240 offset:5632
  ds_read_b64_tr_b16 a[42:43], v240 offset:6656
  s_waitcnt vmcnt(15)
  v_mfma_f32_32x32x16_bf16 v[48:63], a[24:27], a[244:247], v[48:63]
  s_waitcnt lgkmcnt(6)
  v_mfma_f32_32x32x16_bf16 v[32:47], a[28:31], a[180:183], v[32:47]
  ds_read_b64_tr_b16 a[44:45], v241 offset:5632
  ds_read_b64_tr_b16 a[46:47], v241 offset:6656
  v_mfma_f32_32x32x16_bf16 v[64:79], a[28:31], a[244:247], v[64:79]
  s_waitcnt lgkmcnt(6)
  v_mfma_f32_32x32x16_bf16 v[16:31], a[32:35], a[184:187], v[16:31]
  ds_read_b64_tr_b16 a[48:49], v240 offset:7168
  ds_read_b64_tr_b16 a[50:51], v240 offset:8192
  s_waitcnt vmcnt(14)
  v_mfma_f32_32x32x16_bf16 v[48:63], a[32:35], a[248:251], v[48:63]
  s_waitcnt lgkmcnt(6)
  v_mfma_f32_32x32x16_bf16 v[32:47], a[36:39], a[184:187], v[32:47]
  ds_read_b64_tr_b16 a[52:53], v241 offset:7168
  ds_read_b64_tr_b16 a[54:55], v241 offset:8192
  v_mfma_f32_32x32x16_bf16 v[64:79], a[36:39], a[248:251], v[64:79]
  s_waitcnt lgkmcnt(6)
  v_mfma_f32_32x32x16_bf16 v[16:31], a[40:43], a[188:191], v[16:31]
  ds_read_b64_tr_b16 a[56:57], v240 offset:9216
  ds_read_b64_tr_b16 a[58:59], v240 offset:10240
  s_waitcnt vmcnt(13)
  v_mfma_f32_32x32x16_bf16 v[48:63], a[40:43], a[252:255], v[48:63]
  s_waitcnt lgkmcnt(6)
  v_mfma_f32_32x32x16_bf16 v[32:47], a[44:47], a[188:191], v[32:47]
  ds_read_b64_tr_b16 a[60:61], v241 offset:9216
  ds_read_b64_tr_b16 a[62:63], v241 offset:10240
  v_mfma_f32_32x32x16_bf16 v[64:79], a[44:47], a[252:255], v[64:79]
  s_waitcnt lgkmcnt(6)
  v_mfma_f32_32x32x16_bf16 v[16:31], a[48:51], a[192:195], v[16:31]
  ds_read_b64_tr_b16 a[64:65], v240 offset:10752
  ds_read_b64_tr_b16 a[66:67], v240 offset:11776
  s_waitcnt vmcnt(12)
  v_mfma_f32_32x32x16_bf16 v[48:63], a[48:51], a[0:3], v[48:63]
  s_waitcnt lgkmcnt(6)
  v_mfma_f32_32x32x16_bf16 v[32:47], a[52:55], a[192:195], v[32:47]
  ds_read_b64_tr_b16 a[68:69], v241 offset:10752
  ds_read_b64_tr_b16 a[70:71], v241 offset:11776
  v_mfma_f32_32x32x16_bf16 v[64:79], a[52:55], a[0:3], v[64:79]
  s_waitcnt lgkmcnt(6)
  v_mfma_f32_32x32x16_bf16 v[16:31], a[56:59], a[196:199], v[16:31]
  ds_read_b64_tr_b16 a[72:73], v240 offset:12800
  ds_read_b64_tr_b16 a[74:75], v240 offset:13824
  s_waitcnt vmcnt(11)
  v_mfma_f32_32x32x16_bf16 v[48:63], a[56:59], a[4:7], v[48:63]
  s_waitcnt lgkmcnt(6)
  v_mfma_f32_32x32x16_bf16 v[32:47], a[60:63], a[196:199], v[32:47]
  ds_read_b64_tr_b16 a[76:77], v241 offset:12800
  ds_read_b64_tr_b16 a[78:79], v241 offset:13824
  v_mfma_f32_32x32x16_bf16 v[64:79], a[60:63], a[4:7], v[64:79]
  s_waitcnt lgkmcnt(6)
  v_mfma_f32_32x32x16_bf16 v[16:31], a[64:67], a[200:203], v[16:31]
  ds_read_b64_tr_b16 a[80:81], v240 offset:15360
  ds_read_b64_tr_b16 a[82:83], v238 offset:15360
  s_waitcnt vmcnt(10)
  v_mfma_f32_32x32x16_bf16 v[48:63], a[64:67], a[8:11], v[48:63]
  s_waitcnt lgkmcnt(6)
  v_mfma_f32_32x32x16_bf16 v[32:47], a[68:71], a[200:203], v[32:47]
  ds_read_b64_tr_b16 a[84:85], v241 offset:15360
  ds_read_b64_tr_b16 a[86:87], v225 offset:15360
  v_mfma_f32_32x32x16_bf16 v[64:79], a[68:71], a[8:11], v[64:79]
  s_waitcnt lgkmcnt(6)
  v_mfma_f32_32x32x16_bf16 v[16:31], a[72:75], a[204:207], v[16:31]
  ds_read_b64_tr_b16 a[88:89], v240 offset:17408
  ds_read_b64_tr_b16 a[90:91], v225 offset:15616
  s_waitcnt vmcnt(9)
  v_mfma_f32_32x32x16_bf16 v[48:63], a[72:75], a[12:15], v[48:63]
  s_waitcnt lgkmcnt(6)
  v_mfma_f32_32x32x16_bf16 v[32:47], a[76:79], a[204:207], v[32:47]
  ds_read_b64_tr_b16 a[92:93], v241 offset:17408
  ds_read_b64_tr_b16 a[94:95], v238 offset:15616
  v_mfma_f32_32x32x16_bf16 v[64:79], a[76:79], a[12:15], v[64:79]
  s_waitcnt vmcnt(8) lgkmcnt(6)
  v_mfma_f32_32x32x16_bf16 v[16:31], a[80:83], a[208:211], v[16:31]
  ds_read_b64_tr_b16 a[96:97], v240 offset:18944
  ds_read_b64_tr_b16 a[98:99], v238 offset:18944
  s_waitcnt lgkmcnt(6)
  v_mfma_f32_32x32x16_bf16 v[32:47], a[84:87], a[208:211], v[32:47]
  ds_read_b64_tr_b16 a[100:101], v241 offset:18944
  ds_read_b64_tr_b16 a[102:103], v225 offset:18944
  s_waitcnt vmcnt(7) lgkmcnt(6)
  v_mfma_f32_32x32x16_bf16 v[16:31], a[88:91], a[212:215], v[16:31]
  ds_read_b64_tr_b16 a[104:105], v240 offset:20992
  ds_read_b64_tr_b16 a[106:107], v225 offset:19200
  s_waitcnt lgkmcnt(6)
  v_mfma_f32_32x32x16_bf16 v[32:47], a[92:95], a[212:215], v[32:47]
  ds_read_b64_tr_b16 a[108:109], v241 offset:20992
  ds_read_b64_tr_b16 a[110:111], v238 offset:19200
  s_waitcnt vmcnt(6) lgkmcnt(6)
  v_mfma_f32_32x32x16_bf16 v[16:31], a[96:99], a[216:219], v[16:31]
  ds_read_b64_tr_b16 a[112:113], v240 offset:22528
  ds_read_b64_tr_b16 a[114:115], v238 offset:22528
  s_waitcnt lgkmcnt(6)
  v_mfma_f32_32x32x16_bf16 v[32:47], a[100:103], a[216:219], v[32:47]
  ds_read_b64_tr_b16 a[116:117], v241 offset:22528
  ds_read_b64_tr_b16 a[118:119], v225 offset:22528
  s_waitcnt vmcnt(5) lgkmcnt(6)
  v_mfma_f32_32x32x16_bf16 v[16:31], a[104:107], a[220:223], v[16:31]
  ds_read_b64_tr_b16 a[120:121], v240 offset:24576
  ds_read_b64_tr_b16 a[122:123], v225 offset:22784
  global_load_dwordx4 v[128:131], v242, s[12:13] offset:-4096 sc1
  s_waitcnt lgkmcnt(6)
  v_mfma_f32_32x32x16_bf16 v[32:47], a[108:111], a[220:223], v[32:47]
  ds_read_b64_tr_b16 a[124:125], v241 offset:24576
  ds_read_b64_tr_b16 a[126:127], v238 offset:22784
  global_load_dwordx4 v[132:135], v242, s[12:13] offset:-3072 sc1
  s_waitcnt vmcnt(6) lgkmcnt(6)
  v_mfma_f32_32x32x16_bf16 v[16:31], a[112:115], a[224:227], v[16:31]
  ds_read_b64_tr_b16 a[128:129], v240 offset:26112
  ds_read_b64_tr_b16 a[130:131], v238 offset:26112
  global_load_dwordx4 v[136:139], v242, s[12:13] offset:-2048 sc1
  s_waitcnt lgkmcnt(6)
  v_mfma_f32_32x32x16_bf16 v[32:47], a[116:119], a[224:227], v[32:47]
  ds_read_b64_tr_b16 a[132:133], v241 offset:26112
  ds_read_b64_tr_b16 a[134:135], v225 offset:26112
  global_load_dwordx4 v[140:143], v242, s[12:13] offset:-1024 sc1
  s_waitcnt vmcnt(7) lgkmcnt(6)
  v_mfma_f32_32x32x16_bf16 v[16:31], a[120:123], a[228:231], v[16:31]
  ds_read_b64_tr_b16 a[136:137], v240 offset:28160
  ds_read_b64_tr_b16 a[138:139], v225 offset:26368
  global_load_dwordx4 v[144:147], v242, s[12:13] offset:0 sc1
  s_waitcnt lgkmcnt(6)
  v_mfma_f32_32x32x16_bf16 v[32:47], a[124:127], a[228:231], v[32:47]
  ds_read_b64_tr_b16 a[140:141], v241 offset:28160
  ds_read_b64_tr_b16 a[142:143], v238 offset:26368
  global_load_dwordx4 v[148:151], v242, s[12:13] offset:1024 sc1
  s_waitcnt vmcnt(8) lgkmcnt(6)
  v_mfma_f32_32x32x16_bf16 v[16:31], a[128:131], a[232:235], v[16:31]
  global_load_dwordx4 v[152:155], v242, s[12:13] offset:2048 sc1
  s_waitcnt lgkmcnt(4)
  v_mfma_f32_32x32x16_bf16 v[32:47], a[132:135], a[232:235], v[32:47]
  global_load_dwordx4 v[156:159], v242, s[12:13] offset:3072 sc1
  s_waitcnt vmcnt(9) lgkmcnt(2)
  v_mfma_f32_32x32x16_bf16 v[16:31], a[136:139], a[236:239], v[16:31]
  s_waitcnt lgkmcnt(0)
  v_mfma_f32_32x32x16_bf16 v[32:47], a[140:143], a[236:239], v[32:47]
  v_add_u32 v5, s67, v1
  v_subrev_u32 v6, 131072, v243
  v_add_u32 v7, 61440, v6
  s_nop 6
  ds_write_b128 v5, v[16:19] offset:0
  ds_write_b128 v5, v[20:23] offset:1024
  ds_write_b128 v5, v[24:27] offset:2048
  ds_write_b128 v5, v[28:31] offset:3072
  ds_write_b128 v5, v[32:35] offset:4096
  ds_write_b128 v5, v[36:39] offset:5120
  ds_write_b128 v5, v[40:43] offset:6144
  ds_write_b128 v5, v[44:47] offset:7168
  s_waitcnt lgkmcnt(0)
  s_barrier
  ds_read_b128 v[80:83], v6 offset:0
  ds_read_b128 v[84:87], v6 offset:1024
  ds_read_b128 v[88:91], v6 offset:30720
  ds_read_b128 v[92:95], v6 offset:31744
  ds_read_b128 v[96:99], v7 offset:0
  ds_read_b128 v[100:103], v7 offset:1024
  ds_read_b128 v[104:107], v7 offset:30720
  ds_read_b128 v[108:111], v7 offset:31744
  s_waitcnt vmcnt(0)
  v_xor_b32 v159, v159, v245
  v_xor_b32 v155, v155, v245
  v_xor_b32 v151, v151, v245
  v_xor_b32 v147, v147, v245
  v_xor_b32 v143, v143, v245
  v_xor_b32 v139, v139, v245
  v_xor_b32 v135, v135, v245
  v_xor_b32 v131, v131, v245
  v_or3_b32 v2, v131, v135, v139
  v_or3_b32 v3, v143, v147, v151
  v_or3_b32 v2, v2, v155, v159
  v_or_b32 v2, v2, v3
  v_cmp_ne_u32 vcc, 0, v2
  s_nop 2
  s_and_b64 vcc, vcc, s[46:47]
  s_cbranch_scc1 L_oolL
L_retL:
  v_mfma_f32_32x32x16_bf16 v[48:63], a[80:83], v[128:131], v[48:63]
  s_waitcnt lgkmcnt(5)
  v_pk_add_f32 v[80:81], v[80:81], v[88:89]
  v_pk_add_f32 v[82:83], v[82:83], v[90:91]
  v_mfma_f32_32x32x16_bf16 v[48:63], a[88:91], v[132:135], v[48:63]
  s_waitcnt lgkmcnt(4)
  v_pk_add_f32 v[84:85], v[84:85], v[92:93]
  v_pk_add_f32 v[86:87], v[86:87], v[94:95]
  v_mfma_f32_32x32x16_bf16 v[48:63], a[96:99], v[136:139], v[48:63]
  s_waitcnt lgkmcnt(1)
  v_pk_add_f32 v[96:97], v[96:97], v[104:105]
  v_pk_add_f32 v[98:99], v[98:99], v[106:107]
  v_mfma_f32_32x32x16_bf16 v[48:63], a[104:107], v[140:143], v[48:63]
  s_waitcnt lgkmcnt(0)
  v_pk_add_f32 v[100:101], v[100:101], v[108:109]
  v_pk_add_f32 v[102:103], v[102:103], v[110:111]
  v_mfma_f32_32x32x16_bf16 v[48:63], a[112:115], v[144:147], v[48:63]
  v_pk_add_f32 v[80:81], v[80:81], v[96:97]
  v_pk_add_f32 v[82:83], v[82:83], v[98:99]
  v_mfma_f32_32x32x16_bf16 v[48:63], a[120:123], v[148:151], v[48:63]
  v_pk_add_f32 v[84:85], v[84:85], v[100:101]
  v_pk_add_f32 v[86:87], v[86:87], v[102:103]
  v_mfma_f32_32x32x16_bf16 v[48:63], a[128:131], v[152:155], v[48:63]
  v_cvt_pk_bf16_f32 v112, v80, v81
  v_cvt_pk_bf16_f32 v114, v84, v85
  v_mfma_f32_32x32x16_bf16 v[48:63], a[136:139], v[156:159], v[48:63]
  v_cvt_pk_bf16_f32 v113, v82, v83
  v_cvt_pk_bf16_f32 v115, v86, v87
  v_mfma_f32_32x32x16_bf16 v[64:79], a[84:87], v[128:131], v[64:79]
  s_nop 0
  v_permlane32_swap_b32 v112, v114
  v_mfma_f32_32x32x16_bf16 v[64:79], a[92:95], v[132:135], v[64:79]
  v_permlane32_swap_b32 v113, v115
  buffer_store_dwordx4 v[112:115], v244, s[28:31], s89 offen
  v_mfma_f32_32x32x16_bf16 v[64:79], a[100:103], v[136:139], v[64:79]
  s_or_b32 s53, s2, s38
  s_cmp_eq_u32 s53, 0
  s_cselect_b32 s53, 0, 0x40000000
  buffer_store_dword v15, v14, s[16:19], s53 offen sc1
  s_add_u32 s89, s89, 57344
  v_mfma_f32_32x32x16_bf16 v[64:79], a[108:111], v[140:143], v[64:79]
  v_mfma_f32_32x32x16_bf16 v[64:79], a[116:119], v[144:147], v[64:79]
  ds_write_b128 v230, v[48:51] offset:0
  v_mfma_f32_32x32x16_bf16 v[64:79], a[124:127], v[148:151], v[64:79]
  ds_write_b128 v230, v[52:55] offset:1024
  v_mfma_f32_32x32x16_bf16 v[64:79], a[132:135], v[152:155], v[64:79]
  ds_write_b128 v230, v[56:59] offset:2048
  v_mfma_f32_32x32x16_bf16 v[64:79], a[140:143], v[156:159], v[64:79]
  ds_write_b128 v230, v[60:63] offset:3072
  s_nop 10
  ds_write_b128 v230, v[64:67] offset:4096
  ds_write_b128 v230, v[68:71] offset:5120
  ds_write_b128 v230, v[72:75] offset:6144
  ds_write_b128 v230, v[76:79] offset:7168
  s_waitcnt lgkmcnt(0)
  s_barrier
  ds_read_b128 v[80:83], v243 offset:0
  ds_read_b128 v[84:87], v243 offset:1024
  ds_read_b128 v[88:91], v243 offset:8192
  ds_read_b128 v[92:95], v243 offset:9216
  ds_read_b128 v[96:99], v243 offset:16384
  ds_read_b128 v[100:103], v243 offset:17408
  ds_read_b128 v[104:107], v243 offset:24576
  ds_read_b128 v[108:111], v243 offset:25600
  s_waitcnt lgkmcnt(5)
  v_pk_add_f32 v[80:81], v[80:81], v[88:89]
  v_pk_add_f32 v[82:83], v[82:83], v[90:91]
  s_waitcnt lgkmcnt(4)
  v_pk_add_f32 v[84:85], v[84:85], v[92:93]
  v_pk_add_f32 v[86:87], v[86:87], v[94:95]
  s_waitcnt lgkmcnt(1)
  v_pk_add_f32 v[96:97], v[96:97], v[104:105]
  v_pk_add_f32 v[98:99], v[98:99], v[106:107]
  s_waitcnt lgkmcnt(0)
  v_pk_add_f32 v[100:101], v[100:101], v[108:109]
  v_pk_add_f32 v[102:103], v[102:103], v[110:111]
  v_pk_add_f32 v[80:81], v[80:81], v[96:97]
  v_pk_add_f32 v[82:83], v[82:83], v[98:99]
  v_pk_add_f32 v[84:85], v[84:85], v[100:101]
  v_pk_add_f32 v[86:87], v[86:87], v[102:103]
  v_cvt_pk_bf16_f32 v112, v80, v81
  v_cvt_pk_bf16_f32 v114, v84, v85
  v_cvt_pk_bf16_f32 v113, v82, v83
  v_cvt_pk_bf16_f32 v115, v86, v87
  s_nop 0
  v_permlane32_swap_b32 v112, v114
  v_permlane32_swap_b32 v113, v115
  buffer_store_dwordx4 v[112:115], v244, s[28:31], s89 offen
L_fin:
L_end:
  s_endpgm
L_oolK0:
  s_mov_b32 s58, 0
L_oolK0_l:
  buffer_load_dword v2, v236, s[16:19], 0 offen sc1
  s_add_u32 s58, s58, 1
  s_cmp_gt_u32 s58, 0x40000
  s_cbranch_scc1 L_oolK0_x
  s_waitcnt vmcnt(0)
  v_cmp_ne_u32 vcc, v15, v2
  s_cbranch_vccnz L_oolK0_l
L_oolK0_x:
  s_waitcnt vmcnt(0)
  s_branch L_retK0
L_oolK1:
  s_mov_b32 s58, 0
L_oolK1_l:
  buffer_load_dword v2, v236, s[16:19], 0 offen sc1
  s_add_u32 s58, s58, 1
  s_cmp_gt_u32 s58, 0x40000
  s_cbranch_scc1 L_oolK1_x
  s_waitcnt vmcnt(0)
  v_cmp_ne_u32 vcc, v15, v2
  s_cbranch_vccnz L_oolK1_l
L_oolK1_x:
  s_waitcnt vmcnt(0)
  s_branch L_retK1
L_oolQ:
  s_mov_b32 s58, 0
L_oolQ_l:
  global_load_dwordx4 v[160:163], v242, s[56:57] offset:-4096 sc1
  global_load_dwordx4 v[164:167], v242, s[56:57] offset:-3072 sc1
  global_load_dwordx4 v[168:171], v242, s[56:57] offset:-2048 sc1
  global_load_dwordx4 v[172:175], v242, s[56:57] offset:-1024 sc1
  global_load_dwordx4 v[176:179], v242, s[56:57] offset:0 sc1
  global_load_dwordx4 v[180:183], v242, s[56:57] offset:1024 sc1
  global_load_dwordx4 v[184:187], v242, s[56:57] offset:2048 sc1
  global_load_dwordx4 v[188:191], v242, s[56:57] offset:3072 sc1
  s_add_u32 s58, s58, 1
  s_cmp_gt_u32 s58, 0x40000
  s_cbranch_scc1 L_oolQ_x
  s_waitcnt vmcnt(0)
  v_xor_b32 v191, v191, v207
  v_xor_b32 v187, v187, v207
  v_xor_b32 v183, v183, v207
  v_xor_b32 v179, v179, v207
  v_xor_b32 v175, v175, v207
  v_xor_b32 v171, v171, v207
  v_xor_b32 v167, v167, v207
  v_xor_b32 v163, v163, v207
  v_or3_b32 v2, v163, v167, v171
  v_or3_b32 v3, v175, v179, v183
  v_or3_b32 v2, v2, v187, v191
  v_or_b32 v2, v2, v3
  v_cmp_lt_u32 vcc, 0xFFFF, v2
  s_nop 2
  s_and_b64 vcc, vcc, s[46:47]
  s_cbranch_scc1 L_oolQ_l
L_oolQ_x:
  s_waitcnt vmcnt(0)
  s_nop 1
  s_branch L_retQ
L_oolL:
  s_mov_b32 s58, 0
L_oolL_l:
  global_load_dwordx4 v[128:131], v242, s[12:13] offset:-4096 sc1
  global_load_dwordx4 v[132:135], v242, s[12:13] offset:-3072 sc1
  global_load_dwordx4 v[136:139], v242, s[12:13] offset:-2048 sc1
  global_load_dwordx4 v[140:143], v242, s[12:13] offset:-1024 sc1
  global_load_dwordx4 v[144:147], v242, s[12:13] offset:0 sc1
  global_load_dwordx4 v[148:151], v242, s[12:13] offset:1024 sc1
  global_load_dwordx4 v[152:155], v242, s[12:13] offset:2048 sc1
  global_load_dwordx4 v[156:159], v242, s[12:13] offset:3072 sc1
  s_add_u32 s58, s58, 1
  s_cmp_gt_u32 s58, 0x40000
  s_cbranch_scc1 L_oolL_x
  s_waitcnt vmcnt(0)
  v_xor_b32 v159, v159, v245
  v_xor_b32 v155, v155, v245
  v_xor_b32 v151, v151, v245
  v_xor_b32 v147, v147, v245
  v_xor_b32 v143, v143, v245
  v_xor_b32 v139, v139, v245
  v_xor_b32 v135, v135, v245
  v_xor_b32 v131, v131, v245
  v_or3_b32 v2, v131, v135, v139
  v_or3_b32 v3, v143, v147, v151
  v_or3_b32 v2, v2, v155, v159
  v_or_b32 v2, v2, v3
  v_cmp_ne_u32 vcc, 0, v2
  s_nop 2
  s_and_b64 vcc, vcc, s[46:47]
  s_cbranch_scc1 L_oolL_l
L_oolL_x:
  s_waitcnt vmcnt(0)
  s_nop 1
  s_branch L_retL
L_oolZ:
  s_mov_b32 s58, 0
L_oolZ_l:
  buffer_load_dword v2, v235, s[16:19], 0 offen sc1
  s_add_u32 s58, s58, 1
  s_cmp_gt_u32 s58, 0x40000
  s_cbranch_scc1 L_oolZ_x
  s_waitcnt vmcnt(0)
  v_cmp_ne_u32 vcc, v15, v2
  s_cbranch_vccnz L_oolZ_l
L_oolZ_x:
  s_waitcnt vmcnt(0)
  s_branch L_retZ
L_oolE:
  s_mov_b32 s58, 0
L_oolE_l:
  buffer_load_dword v2, v237, s[16:19], s88 offen sc1
  s_add_u32 s58, s58, 1
  s_cmp_gt_u32 s58, 0x40000
  s_cbranch_scc1 L_oolE_x
  s_waitcnt vmcnt(0)
  v_cmp_ne_u32 vcc, v15, v2
  s_cbranch_vccnz L_oolE_l
L_oolE_x:
  s_waitcnt vmcnt(0)
  s_branch L_retE
L_oolIdle:
  s_branch L_fin
L_hotend:
L_slow0:
  s_waitcnt vmcnt(0) lgkmcnt(0)
  s_nop 15
  v_mfma_f32_32x32x16_bf16 v[64:79], v[136:139], v[128:131], 0
  v_mfma_f32_32x32x16_bf16 v[64:79], v[140:143], v[132:135], v[64:79]
  s_nop 11
  v_mov_b32 v2, v76
  v_mov_b32 v4, v76
  v_lshlrev_b32 v9, 16, v9
  v_and_b32 v11, 0xFFFF0000, v11
  v_permlane32_swap_b32 v2, v4
  v_add_f32 v4, s52, v4
  v_rcp_f32 v4, v4
  s_nop 0
  v_mul_f32 v4, v4, v9
  v_pk_mul_f32 v[64:65], v[64:65], v[4:5] op_sel_hi:[1,0]
  v_pk_mul_f32 v[66:67], v[66:67], v[4:5] op_sel_hi:[1,0]
  v_pk_mul_f32 v[68:69], v[68:69], v[4:5] op_sel_hi:[1,0]
  v_pk_mul_f32 v[70:71], v[70:71], v[4:5] op_sel_hi:[1,0]
  v_pk_mul_f32 v[72:73], v[72:73], v[4:5] op_sel_hi:[1,0]
  v_pk_mul_f32 v[74:75], v[74:75], v[4:5] op_sel_hi:[1,0]
  v_pk_mul_f32 v[76:77], v[76:77], v[4:5] op_sel_hi:[1,0]
  v_pk_mul_f32 v[78:79], v[78:79], v[4:5] op_sel_hi:[1,0]
  v_cvt_pk_bf16_f32 v80, v64, v65
  v_cvt_pk_bf16_f32 v81, v66, v67
  v_cvt_pk_bf16_f32 v82, v68, v69
  v_cvt_pk_bf16_f32 v83, v70, v71
  v_cvt_pk_bf16_f32 v84, v72, v73
  v_cvt_pk_bf16_f32 v85, v74, v75
  v_cvt_pk_bf16_f32 v86, v76, v77
  v_cvt_pk_bf16_f32 v87, v78, v79
  v_cndmask_b32 v86, v86, 0, s[46:47]
  v_cndmask_b32 v87, v87, 0, s[46:47]
  s_lshl_b32 s54, s38, 16
  s_add_u32 s54, s54, s65
  buffer_store_dwordx4 v[80:83], v1, s[16:19], s54 offen sc1
  buffer_store_dwordx4 v[84:87], v1, s[16:19], s54 offen offset:1024 sc1
  s_mov_b32 s91, 0
  s_branch L_slow
L_slow1:
  s_mov_b32 s91, 2
L_slow:
  s_waitcnt vmcnt(0) lgkmcnt(0)
  s_nop 15
  s_barrier
  s_add_u32 s4, s63, 4096
  s_add_u32 s4, s4, s16
  s_addc_u32 s5, s17, 0
  global_load_dwordx4 a[176:179], v1, s[4:5] offset:-4096 sc1
  global_load_dwordx4 a[180:183], v1, s[4:5] offset:-3072 sc1
  global_load_dwordx4 a[184:187], v1, s[4:5] offset:-2048 sc1
  global_load_dwordx4 a[188:191], v1, s[4:5] offset:-1024 sc1
  global_load_dwordx4 a[192:195], v1, s[4:5] offset:0 sc1
  global_load_dwordx4 a[196:199], v1, s[4:5] offset:1024 sc1
  global_load_dwordx4 a[200:203], v1, s[4:5] offset:2048 sc1
  global_load_dwordx4 a[204:207], v1, s[4:5] offset:3072 sc1
  s_add_u32 s4, s4, 8192
  s_addc_u32 s5, s5, 0
  s_waitcnt vmcnt(0)
  global_load_dwordx4 a[208:211], v1, s[4:5] offset:-4096 sc1
  global_load_dwordx4 a[212:215], v1, s[4:5] offset:-3072 sc1
  global_load_dwordx4 a[216:219], v1, s[4:5] offset:-2048 sc1
  global_load_dwordx4 a[220:223], v1, s[4:5] offset:-1024 sc1
  global_load_dwordx4 a[224:227], v1, s[4:5] offset:0 sc1
  global_load_dwordx4 a[228:231], v1, s[4:5] offset:1024 sc1
  global_load_dwordx4 a[232:235], v1, s[4:5] offset:2048 sc1
  global_load_dwordx4 a[236:239], v1, s[4:5] offset:3072 sc1
  s_add_u32 s4, s4, 8192
  s_addc_u32 s5, s5, 0
  s_waitcnt vmcnt(0)
  global_load_dwordx4 a[240:243], v1, s[4:5] offset:-4096 sc1
  global_load_dwordx4 a[244:247], v1, s[4:5] offset:-3072 sc1
  global_load_dwordx4 a[248:251], v1, s[4:5] offset:-2048 sc1
  global_load_dwordx4 a[252:255], v1, s[4:5] offset:-1024 sc1
  global_load_dwordx4 a[0:3], v1, s[4:5] offset:0 sc1
  global_load_dwordx4 a[4:7], v1, s[4:5] offset:1024 sc1
  global_load_dwordx4 a[8:11], v1, s[4:5] offset:2048 sc1
  global_load_dwordx4 a[12:15], v1, s[4:5] offset:3072 sc1
  s_add_u32 s4, s4, 8192
  s_addc_u32 s5, s5, 0
  s_waitcnt vmcnt(0)
  global_load_dwordx4 a[16:19], v1, s[4:5] offset:-4096 sc1
  global_load_dwordx4 a[20:23], v1, s[4:5] offset:-3072 sc1
  global_load_dwordx4 a[24:27], v1, s[4:5] offset:-2048 sc1
  global_load_dwordx4 a[28:31], v1, s[4:5] offset:-1024 sc1
  global_load_dwordx4 a[32:35], v1, s[4:5] offset:0 sc1
  global_load_dwordx4 a[36:39], v1, s[4:5] offset:1024 sc1
  global_load_dwordx4 a[40:43], v1, s[4:5] offset:2048 sc1
  global_load_dwordx4 a[44:47], v1, s[4:5] offset:3072 sc1
  s_add_u32 s4, s4, 8192
  s_addc_u32 s5, s5, 0
  s_waitcnt vmcnt(0)
  global_load_dwordx4 a[48:51], v1, s[4:5] offset:-4096 sc1
  global_load_dwordx4 a[52:55], v1, s[4:5] offset:-3072 sc1
  global_load_dwordx4 a[56:59], v1, s[4:5] offset:-2048 sc1
  global_load_dwordx4 a[60:63], v1, s[4:5] offset:-1024 sc1
  global_load_dwordx4 a[64:67], v1, s[4:5] offset:0 sc1
  global_load_dwordx4 a[68:71], v1, s[4:5] offset:1024 sc1
  global_load_dwordx4 a[72:75], v1, s[4:5] offset:2048 sc1
  global_load_dwordx4 a[76:79], v1, s[4:5] offset:3072 sc1
  s_add_u32 s4, s4, 8192
  s_addc_u32 s5, s5, 0
  s_waitcnt vmcnt(0)
  global_load_dwordx4 a[80:83], v1, s[4:5] offset:-4096 sc1
  global_load_dwordx4 a[84:87], v1, s[4:5] offset:-3072 sc1
  global_load_dwordx4 a[88:91], v1, s[4:5] offset:-2048 sc1
  global_load_dwordx4 a[92:95], v1, s[4:5] offset:-1024 sc1
  global_load_dwordx4 a[96:99], v1, s[4:5] offset:0 sc1
  global_load_dwordx4 a[100:103], v1, s[4:5] offset:1024 sc1
  global_load_dwordx4 a[104:107], v1, s[4:5] offset:2048 sc1
  global_load_dwordx4 a[108:111], v1, s[4:5] offset:3072 sc1
  s_add_u32 s4, s4, 8192
  s_addc_u32 s5, s5, 0
  s_waitcnt vmcnt(0)
  global_load_dwordx4 a[112:115], v1, s[4:5] offset:-4096 sc1
  global_load_dwordx4 a[116:119], v1, s[4:5] offset:-3072 sc1
  global_load_dwordx4 a[120:123], v1, s[4:5] offset:-2048 sc1
  global_load_dwordx4 a[124:127], v1, s[4:5] offset:-1024 sc1
  global_load_dwordx4 a[128:131], v1, s[4:5] offset:0 sc1
  global_load_dwordx4 a[132:135], v1, s[4:5] offset:1024 sc1
  global_load_dwordx4 a[136:139], v1, s[4:5] offset:2048 sc1
  global_load_dwordx4 a[140:143], v1, s[4:5] offset:3072 sc1
  s_add_u32 s4, s4, 8192
  s_addc_u32 s5, s5, 0
  s_waitcnt vmcnt(0)
  global_load_dwordx4 a[144:147], v1, s[4:5] offset:-4096 sc1
  global_load_dwordx4 a[148:151], v1, s[4:5] offset:-3072 sc1
  global_load_dwordx4 a[152:155], v1, s[4:5] offset:-2048 sc1
  global_load_dwordx4 a[156:159], v1, s[4:5] offset:-1024 sc1
  global_load_dwordx4 a[160:163], v1, s[4:5] offset:0 sc1
  global_load_dwordx4 a[164:167], v1, s[4:5] offset:1024 sc1
  global_load_dwordx4 a[168:171], v1, s[4:5] offset:2048 sc1
  global_load_dwordx4 a[172:175], v1, s[4:5] offset:3072 sc1
  ds_write_b128 v1, v[160:163] offset:0
  ds_write_b128 v1, v[164:167] offset:1024
  ds_write_b128 v1, v[168:171] offset:2048
  ds_write_b128 v1, v[172:175] offset:3072
  ds_write_b128 v1, v[176:179] offset:4096
  ds_write_b128 v1, v[180:183] offset:5120
  ds_write_b128 v1, v[184:187] offset:6144
  ds_write_b128 v1, v[188:191] offset:7168
  s_lshr_b32 s64, s38, 1
  s_lshl_b32 s64, s64, 16
  s_and_b32 s55, s38, 1
  s_lshl_b32 s55, s55, 10
  s_add_u32 s64, s64, s55
  s_add_u32 s64, s64, s65
  s_add_u32 s64, s64, 32768
  s_lshl_b32 s62, s37, 4
  s_add_u32 s62, s62, s36
  s_lshl_b32 s62, s62, 2
  s_add_u32 s62, s62, s38
  s_lshl_b32 s62, s62, 7
  s_add_u32 s62, s62, 393216
  s_waitcnt vmcnt(0) lgkmcnt(0)
  s_barrier
L_slowT:
  s_lshl_b32 s53, s91, 11
  v_add_u32 v3, s53, v1
  ds_read_b128 v[176:179], v3 offset:0
  ds_read_b128 v[180:183], v3 offset:1024
  v_mov_b32 v2, 0xff800000
  s_waitcnt lgkmcnt(1)
  v_cndmask_b32 v179, v179, 0, s[46:47]
  s_waitcnt lgkmcnt(0)
  v_cndmask_b32 v183, v183, 0, s[46:47]
  v_mfma_f32_32x32x16_bf16 v[16:31], a[176:179], v[176:179], 0
  s_nop 0
  v_mfma_f32_32x32x16_bf16 v[16:31], a[180:183], v[180:183], v[16:31]
  s_nop 11
  v_max3_f32 v2, v2, v16, v17
  v_max3_f32 v2, v2, v18, v19
  v_max3_f32 v2, v2, v20, v21
  v_max3_f32 v2, v2, v22, v23
  v_max3_f32 v2, v2, v24, v25
  v_max3_f32 v2, v2, v26, v27
  v_max3_f32 v2, v2, v28, v29
  v_max3_f32 v2, v2, v30, v31
  v_mfma_f32_32x32x16_bf16 v[32:47], a[192:195], v[176:179], 0
  v_mfma_f32_32x32x16_bf16 v[32:47], a[196:199], v[180:183], v[32:47]
  s_nop 11
  v_max3_f32 v2, v2, v32, v33
  v_max3_f32 v2, v2, v34, v35
  v_max3_f32 v2, v2, v36, v37
  v_max3_f32 v2, v2, v38, v39
  v_max3_f32 v2, v2, v40, v41
  v_max3_f32 v2, v2, v42, v43
  v_max3_f32 v2, v2, v44, v45
  v_max3_f32 v2, v2, v46, v47
  v_mfma_f32_32x32x16_bf16 v[16:31], a[208:211], v[176:179], 0
  v_mfma_f32_32x32x16_bf16 v[16:31], a[212:215], v[180:183], v[16:31]
  s_nop 11
  v_max3_f32 v2, v2, v16, v17
  v_max3_f32 v2, v2, v18, v19
  v_max3_f32 v2, v2, v20, v21
  v_max3_f32 v2, v2, v22, v23
  v_max3_f32 v2, v2, v24, v25
  v_max3_f32 v2, v2, v26, v27
  v_max3_f32 v2, v2, v28, v29
  v_max3_f32 v2, v2, v30, v31
  v_mfma_f32_32x32x16_bf16 v[32:47], a[224:227], v[176:179], 0
  v_mfma_f32_32x32x16_bf16 v[32:47], a[228:231], v[180:183], v[32:47]
  s_nop 11
  v_max3_f32 v2, v2, v32, v33
  v_max3_f32 v2, v2, v34, v35
  v_max3_f32 v2, v2, v36, v37
  v_max3_f32 v2, v2, v38, v39
  v_max3_f32 v2, v2, v40, v41
  v_max3_f32 v2, v2, v42, v43
  v_max3_f32 v2, v2, v44, v45
  v_max3_f32 v2, v2, v46, v47
  v_mfma_f32_32x32x16_bf16 v[16:31], a[240:243], v[176:179], 0
  v_mfma_f32_32x32x16_bf16 v[16:31], a[244:247], v[180:183], v[16:31]
  s_nop 11
  v_max3_f32 v2, v2, v16, v17
  v_max3_f32 v2, v2, v18, v19
  v_max3_f32 v2, v2, v20, v21
  v_max3_f32 v2, v2, v22, v23
  v_max3_f32 v2, v2, v24, v25
  v_max3_f32 v2, v2, v26, v27
  v_max3_f32 v2, v2, v28, v29
  v_max3_f32 v2, v2, v30, v31
  v_mfma_f32_32x32x16_bf16 v[32:47], a[0:3], v[176:179], 0
  v_mfma_f32_32x32x16_bf16 v[32:47], a[4:7], v[180:183], v[32:47]
  s_nop 11
  v_max3_f32 v2, v2, v32, v33
  v_max3_f32 v2, v2, v34, v35
  v_max3_f32 v2, v2, v36, v37
  v_max3_f32 v2, v2, v38, v39
  v_max3_f32 v2, v2, v40, v41
  v_max3_f32 v2, v2, v42, v43
  v_max3_f32 v2, v2, v44, v45
  v_max3_f32 v2, v2, v46, v47
  v_mfma_f32_32x32x16_bf16 v[16:31], a[16:19], v[176:179], 0
  v_mfma_f32_32x32x16_bf16 v[16:31], a[20:23], v[180:183], v[16:31]
  s_nop 11
  v_max3_f32 v2, v2, v16, v17
  v_max3_f32 v2, v2, v18, v19
  v_max3_f32 v2, v2, v20, v21
  v_max3_f32 v2, v2, v22, v23
  v_max3_f32 v2, v2, v24, v25
  v_max3_f32 v2, v2, v26, v27
  v_max3_f32 v2, v2, v28, v29
  v_max3_f32 v2, v2, v30, v31
  v_mfma_f32_32x32x16_bf16 v[32:47], a[32:35], v[176:179], 0
  v_mfma_f32_32x32x16_bf16 v[32:47], a[36:39], v[180:183], v[32:47]
  s_nop 11
  v_max3_f32 v2, v2, v32, v33
  v_max3_f32 v2, v2, v34, v35
  v_max3_f32 v2, v2, v36, v37
  v_max3_f32 v2, v2, v38, v39
  v_max3_f32 v2, v2, v40, v41
  v_max3_f32 v2, v2, v42, v43
  v_max3_f32 v2, v2, v44, v45
  v_max3_f32 v2, v2, v46, v47
  v_mfma_f32_32x32x16_bf16 v[16:31], a[48:51], v[176:179], 0
  v_mfma_f32_32x32x16_bf16 v[16:31], a[52:55], v[180:183], v[16:31]
  s_nop 11
  v_max3_f32 v2, v2, v16, v17
  v_max3_f32 v2, v2, v18, v19
  v_max3_f32 v2, v2, v20, v21
  v_max3_f32 v2, v2, v22, v23
  v_max3_f32 v2, v2, v24, v25
  v_max3_f32 v2, v2, v26, v27
  v_max3_f32 v2, v2, v28, v29
  v_max3_f32 v2, v2, v30, v31
  v_mfma_f32_32x32x16_bf16 v[32:47], a[64:67], v[176:179], 0
  v_mfma_f32_32x32x16_bf16 v[32:47], a[68:71], v[180:183], v[32:47]
  s_nop 11
  v_max3_f32 v2, v2, v32, v33
  v_max3_f32 v2, v2, v34, v35
  v_max3_f32 v2, v2, v36, v37
  v_max3_f32 v2, v2, v38, v39
  v_max3_f32 v2, v2, v40, v41
  v_max3_f32 v2, v2, v42, v43
  v_max3_f32 v2, v2, v44, v45
  v_max3_f32 v2, v2, v46, v47
  v_mfma_f32_32x32x16_bf16 v[16:31], a[80:83], v[176:179], 0
  v_mfma_f32_32x32x16_bf16 v[16:31], a[84:87], v[180:183], v[16:31]
  s_nop 11
  v_max3_f32 v2, v2, v16, v17
  v_max3_f32 v2, v2, v18, v19
  v_max3_f32 v2, v2, v20, v21
  v_max3_f32 v2, v2, v22, v23
  v_max3_f32 v2, v2, v24, v25
  v_max3_f32 v2, v2, v26, v27
  v_max3_f32 v2, v2, v28, v29
  v_max3_f32 v2, v2, v30, v31
  v_mfma_f32_32x32x16_bf16 v[32:47], a[96:99], v[176:179], 0
  v_mfma_f32_32x32x16_bf16 v[32:47], a[100:103], v[180:183], v[32:47]
  s_nop 11
  v_max3_f32 v2, v2, v32, v33
  v_max3_f32 v2, v2, v34, v35
  v_max3_f32 v2, v2, v36, v37
  v_max3_f32 v2, v2, v38, v39
  v_max3_f32 v2, v2, v40, v41
  v_max3_f32 v2, v2, v42, v43
  v_max3_f32 v2, v2, v44, v45
  v_max3_f32 v2, v2, v46, v47
  v_mfma_f32_32x32x16_bf16 v[16:31], a[112:115], v[176:179], 0
  v_mfma_f32_32x32x16_bf16 v[16:31], a[116:119], v[180:183], v[16:31]
  s_nop 11
  v_max3_f32 v2, v2, v16, v17
  v_max3_f32 v2, v2, v18, v19
  v_max3_f32 v2, v2, v20, v21
  v_max3_f32 v2, v2, v22, v23
  v_max3_f32 v2, v2, v24, v25
  v_max3_f32 v2, v2, v26, v27
  v_max3_f32 v2, v2, v28, v29
  v_max3_f32 v2, v2, v30, v31
  v_mfma_f32_32x32x16_bf16 v[32:47], a[128:131], v[176:179], 0
  v_mfma_f32_32x32x16_bf16 v[32:47], a[132:135], v[180:183], v[32:47]
  s_nop 11
  v_max3_f32 v2, v2, v32, v33
  v_max3_f32 v2, v2, v34, v35
  v_max3_f32 v2, v2, v36, v37
  v_max3_f32 v2, v2, v38, v39
  v_max3_f32 v2, v2, v40, v41
  v_max3_f32 v2, v2, v42, v43
  v_max3_f32 v2, v2, v44, v45
  v_max3_f32 v2, v2, v46, v47
  v_mfma_f32_32x32x16_bf16 v[16:31], a[144:147], v[176:179], 0
  v_mfma_f32_32x32x16_bf16 v[16:31], a[148:151], v[180:183], v[16:31]
  s_nop 11
  v_max3_f32 v2, v2, v16, v17
  v_max3_f32 v2, v2, v18, v19
  v_max3_f32 v2, v2, v20, v21
  v_max3_f32 v2, v2, v22, v23
  v_max3_f32 v2, v2, v24, v25
  v_max3_f32 v2, v2, v26, v27
  v_max3_f32 v2, v2, v28, v29
  v_max3_f32 v2, v2, v30, v31
  v_mfma_f32_32x32x16_bf16 v[32:47], a[160:163], v[176:179], 0
  v_mfma_f32_32x32x16_bf16 v[32:47], a[164:167], v[180:183], v[32:47]
  s_nop 11
  v_max3_f32 v2, v2, v32, v33
  v_max3_f32 v2, v2, v34, v35
  v_max3_f32 v2, v2, v36, v37
  v_max3_f32 v2, v2, v38, v39
  v_max3_f32 v2, v2, v40, v41
  v_max3_f32 v2, v2, v42, v43
  v_max3_f32 v2, v2, v44, v45
  v_max3_f32 v2, v2, v46, v47
  v_mov_b32 v3, v2
  s_nop 1
  v_permlane32_swap_b32 v3, v2
  v_max_f32 v2, v2, v3
  s_lshl_b32 s53, s38, 8
  v_lshlrev_b32 v4, 2, v0
  v_add_u32 v3, s53, v4
  ds_write_b32 v3, v2 offset:8192
  s_waitcnt lgkmcnt(0)
  s_barrier
  ds_read_b32 v5, v4 offset:8192
  ds_read_b32 v6, v4 offset:8448
  ds_read_b32 v7, v4 offset:8704
  ds_read_b32 v8, v4 offset:8960
  s_waitcnt lgkmcnt(2)
  v_max_f32 v5, v5, v6
  s_waitcnt lgkmcnt(0)
  v_max3_f32 v2, v5, v7, v8
  v_mfma_f32_32x32x16_bf16 v[16:31], a[176:179], v[176:179], 0
  v_mfma_f32_32x32x16_bf16 v[16:31], a[180:183], v[180:183], v[16:31]
  s_nop 11
  v_sub_f32 v16, v16, v2
  v_sub_f32 v17, v17, v2
  v_sub_f32 v18, v18, v2
  v_sub_f32 v19, v19, v2
  v_sub_f32 v20, v20, v2
  v_sub_f32 v21, v21, v2
  v_sub_f32 v22, v22, v2
  v_sub_f32 v23, v23, v2
  v_sub_f32 v24, v24, v2
  v_sub_f32 v25, v25, v2
  v_sub_f32 v26, v26, v2
  v_sub_f32 v27, v27, v2
  v_sub_f32 v28, v28, v2
  v_sub_f32 v29, v29, v2
  v_sub_f32 v30, v30, v2
  v_sub_f32 v31, v31, v2
  v_exp_f32 v16, v16
  v_exp_f32 v17, v17
  v_exp_f32 v18, v18
  v_exp_f32 v19, v19
  v_exp_f32 v20, v20
  v_exp_f32 v21, v21
  v_exp_f32 v22, v22
  v_exp_f32 v23, v23
  v_exp_f32 v24, v24
  v_exp_f32 v25, v25
  v_exp_f32 v26, v26
  v_exp_f32 v27, v27
  v_exp_f32 v28, v28
  v_exp_f32 v29, v29
  v_exp_f32 v30, v30
  v_exp_f32 v31, v31
  v_cvt_pk_bf16_f32 v48, v16, v17
  v_cvt_pk_bf16_f32 v49, v18, v19
  v_cvt_pk_bf16_f32 v50, v20, v21
  v_cvt_pk_bf16_f32 v51, v22, v23
  v_cvt_pk_bf16_f32 v52, v24, v25
  v_cvt_pk_bf16_f32 v53, v26, v27
  v_cvt_pk_bf16_f32 v54, v28, v29
  v_cvt_pk_bf16_f32 v55, v30, v31
  v_mfma_f32_32x32x16_bf16 v[64:79], a[184:187], v[48:51], 0
  s_nop 0
  v_mfma_f32_32x32x16_bf16 v[64:79], a[188:191], v[52:55], v[64:79]
  v_mfma_f32_32x32x16_bf16 v[32:47], a[192:195], v[176:179], 0
  v_mfma_f32_32x32x16_bf16 v[32:47], a[196:199], v[180:183], v[32:47]
  s_nop 11
  v_sub_f32 v32, v32, v2
  v_sub_f32 v33, v33, v2
  v_sub_f32 v34, v34, v2
  v_sub_f32 v35, v35, v2
  v_sub_f32 v36, v36, v2
  v_sub_f32 v37, v37, v2
  v_sub_f32 v38, v38, v2
  v_sub_f32 v39, v39, v2
  v_sub_f32 v40, v40, v2
  v_sub_f32 v41, v41, v2
  v_sub_f32 v42, v42, v2
  v_sub_f32 v43, v43, v2
  v_sub_f32 v44, v44, v2
  v_sub_f32 v45, v45, v2
  v_sub_f32 v46, v46, v2
  v_sub_f32 v47, v47, v2
  v_exp_f32 v32, v32
  v_exp_f32 v33, v33
  v_exp_f32 v34, v34
  v_exp_f32 v35, v35
  v_exp_f32 v36, v36
  v_exp_f32 v37, v37
  v_exp_f32 v38, v38
  v_exp_f32 v39, v39
  v_exp_f32 v40, v40
  v_exp_f32 v41, v41
  v_exp_f32 v42, v42
  v_exp_f32 v43, v43
  v_exp_f32 v44, v44
  v_exp_f32 v45, v45
  v_exp_f32 v46, v46
  v_exp_f32 v47, v47
  v_cvt_pk_bf16_f32 v56, v32, v33
  v_cvt_pk_bf16_f32 v57, v34, v35
  v_cvt_pk_bf16_f32 v58, v36, v37
  v_cvt_pk_bf16_f32 v59, v38, v39
  v_cvt_pk_bf16_f32 v60, v40, v41
  v_cvt_pk_bf16_f32 v61, v42, v43
  v_cvt_pk_bf16_f32 v62, v44, v45
  v_cvt_pk_bf16_f32 v63, v46, v47
  v_mfma_f32_32x32x16_bf16 v[64:79], a[200:203], v[56:59], v[64:79]
  s_nop 0
  v_mfma_f32_32x32x16_bf16 v[64:79], a[204:207], v[60:63], v[64:79]
  v_mfma_f32_32x32x16_bf16 v[16:31], a[208:211], v[176:179], 0
  v_mfma_f32_32x32x16_bf16 v[16:31], a[212:215], v[180:183], v[16:31]
  s_nop 11
  v_sub_f32 v16, v16, v2
  v_sub_f32 v17, v17, v2
  v_sub_f32 v18, v18, v2
  v_sub_f32 v19, v19, v2
  v_sub_f32 v20, v20, v2
  v_sub_f32 v21, v21, v2
  v_sub_f32 v22, v22, v2
  v_sub_f32 v23, v23, v2
  v_sub_f32 v24, v24, v2
  v_sub_f32 v25, v25, v2
  v_sub_f32 v26, v26, v2
  v_sub_f32 v27, v27, v2
  v_sub_f32 v28, v28, v2
  v_sub_f32 v29, v29, v2
  v_sub_f32 v30, v30, v2
  v_sub_f32 v31, v31, v2
  v_exp_f32 v16, v16
  v_exp_f32 v17, v17
  v_exp_f32 v18, v18
  v_exp_f32 v19, v19
  v_exp_f32 v20, v20
  v_exp_f32 v21, v21
  v_exp_f32 v22, v22
  v_exp_f32 v23, v23
  v_exp_f32 v24, v24
  v_exp_f32 v25, v25
  v_exp_f32 v26, v26
  v_exp_f32 v27, v27
  v_exp_f32 v28, v28
  v_exp_f32 v29, v29
  v_exp_f32 v30, v30
  v_exp_f32 v31, v31
  v_cvt_pk_bf16_f32 v48, v16, v17
  v_cvt_pk_bf16_f32 v49, v18, v19
  v_cvt_pk_bf16_f32 v50, v20, v21
  v_cvt_pk_bf16_f32 v51, v22, v23
  v_cvt_pk_bf16_f32 v52, v24, v25
  v_cvt_pk_bf16_f32 v53, v26, v27
  v_cvt_pk_bf16_f32 v54, v28, v29
  v_cvt_pk_bf16_f32 v55, v30, v31
  v_mfma_f32_32x32x16_bf16 v[64:79], a[216:219], v[48:51], v[64:79]
  s_nop 0
  v_mfma_f32_32x32x16_bf16 v[64:79], a[220:223], v[52:55], v[64:79]
  v_mfma_f32_32x32x16_bf16 v[32:47], a[224:227], v[176:179], 0
  v_mfma_f32_32x32x16_bf16 v[32:47], a[228:231], v[180:183], v[32:47]
  s_nop 11
  v_sub_f32 v32, v32, v2
  v_sub_f32 v33, v33, v2
  v_sub_f32 v34, v34, v2
  v_sub_f32 v35, v35, v2
  v_sub_f32 v36, v36, v2
  v_sub_f32 v37, v37, v2
  v_sub_f32 v38, v38, v2
  v_sub_f32 v39, v39, v2
  v_sub_f32 v40, v40, v2
  v_sub_f32 v41, v41, v2
  v_sub_f32 v42, v42, v2
  v_sub_f32 v43, v43, v2
  v_sub_f32 v44, v44, v2
  v_sub_f32 v45, v45, v2
  v_sub_f32 v46, v46, v2
  v_sub_f32 v47, v47, v2
  v_exp_f32 v32, v32
  v_exp_f32 v33, v33
  v_exp_f32 v34, v34
  v_exp_f32 v35, v35
  v_exp_f32 v36, v36
  v_exp_f32 v37, v37
  v_exp_f32 v38, v38
  v_exp_f32 v39, v39
  v_exp_f32 v40, v40
  v_exp_f32 v41, v41
  v_exp_f32 v42, v42
  v_exp_f32 v43, v43
  v_exp_f32 v44, v44
  v_exp_f32 v45, v45
  v_exp_f32 v46, v46
  v_exp_f32 v47, v47
  v_cvt_pk_bf16_f32 v56, v32, v33
  v_cvt_pk_bf16_f32 v57, v34, v35
  v_cvt_pk_bf16_f32 v58, v36, v37
  v_cvt_pk_bf16_f32 v59, v38, v39
  v_cvt_pk_bf16_f32 v60, v40, v41
  v_cvt_pk_bf16_f32 v61, v42, v43
  v_cvt_pk_bf16_f32 v62, v44, v45
  v_cvt_pk_bf16_f32 v63, v46, v47
  v_mfma_f32_32x32x16_bf16 v[64:79], a[232:235], v[56:59], v[64:79]
  s_nop 0
  v_mfma_f32_32x32x16_bf16 v[64:79], a[236:239], v[60:63], v[64:79]
  v_mfma_f32_32x32x16_bf16 v[16:31], a[240:243], v[176:179], 0
  v_mfma_f32_32x32x16_bf16 v[16:31], a[244:247], v[180:183], v[16:31]
  s_nop 11
  v_sub_f32 v16, v16, v2
  v_sub_f32 v17, v17, v2
  v_sub_f32 v18, v18, v2
  v_sub_f32 v19, v19, v2
  v_sub_f32 v20, v20, v2
  v_sub_f32 v21, v21, v2
  v_sub_f32 v22, v22, v2
  v_sub_f32 v23, v23, v2
  v_sub_f32 v24, v24, v2
  v_sub_f32 v25, v25, v2
  v_sub_f32 v26, v26, v2
  v_sub_f32 v27, v27, v2
  v_sub_f32 v28, v28, v2
  v_sub_f32 v29, v29, v2
  v_sub_f32 v30, v30, v2
  v_sub_f32 v31, v31, v2
  v_exp_f32 v16, v16
  v_exp_f32 v17, v17
  v_exp_f32 v18, v18
  v_exp_f32 v19, v19
  v_exp_f32 v20, v20
  v_exp_f32 v21, v21
  v_exp_f32 v22, v22
  v_exp_f32 v23, v23
  v_exp_f32 v24, v24
  v_exp_f32 v25, v25
  v_exp_f32 v26, v26
  v_exp_f32 v27, v27
  v_exp_f32 v28, v28
  v_exp_f32 v29, v29
  v_exp_f32 v30, v30
  v_exp_f32 v31, v31
  v_cvt_pk_bf16_f32 v48, v16, v17
  v_cvt_pk_bf16_f32 v49, v18, v19
  v_cvt_pk_bf16_f32 v50, v20, v21
  v_cvt_pk_bf16_f32 v51, v22, v23
  v_cvt_pk_bf16_f32 v52, v24, v25
  v_cvt_pk_bf16_f32 v53, v26, v27
  v_cvt_pk_bf16_f32 v54, v28, v29
  v_cvt_pk_bf16_f32 v55, v30, v31
  v_mfma_f32_32x32x16_bf16 v[64:79], a[248:251], v[48:51], v[64:79]
  s_nop 0
  v_mfma_f32_32x32x16_bf16 v[64:79], a[252:255], v[52:55], v[64:79]
  v_mfma_f32_32x32x16_bf16 v[32:47], a[0:3], v[176:179], 0
  v_mfma_f32_32x32x16_bf16 v[32:47], a[4:7], v[180:183], v[32:47]
  s_nop 11
  v_sub_f32 v32, v32, v2
  v_sub_f32 v33, v33, v2
  v_sub_f32 v34, v34, v2
  v_sub_f32 v35, v35, v2
  v_sub_f32 v36, v36, v2
  v_sub_f32 v37, v37, v2
  v_sub_f32 v38, v38, v2
  v_sub_f32 v39, v39, v2
  v_sub_f32 v40, v40, v2
  v_sub_f32 v41, v41, v2
  v_sub_f32 v42, v42, v2
  v_sub_f32 v43, v43, v2
  v_sub_f32 v44, v44, v2
  v_sub_f32 v45, v45, v2
  v_sub_f32 v46, v46, v2
  v_sub_f32 v47, v47, v2
  v_exp_f32 v32, v32
  v_exp_f32 v33, v33
  v_exp_f32 v34, v34
  v_exp_f32 v35, v35
  v_exp_f32 v36, v36
  v_exp_f32 v37, v37
  v_exp_f32 v38, v38
  v_exp_f32 v39, v39
  v_exp_f32 v40, v40
  v_exp_f32 v41, v41
  v_exp_f32 v42, v42
  v_exp_f32 v43, v43
  v_exp_f32 v44, v44
  v_exp_f32 v45, v45
  v_exp_f32 v46, v46
  v_exp_f32 v47, v47
  v_cvt_pk_bf16_f32 v56, v32, v33
  v_cvt_pk_bf16_f32 v57, v34, v35
  v_cvt_pk_bf16_f32 v58, v36, v37
  v_cvt_pk_bf16_f32 v59, v38, v39
  v_cvt_pk_bf16_f32 v60, v40, v41
  v_cvt_pk_bf16_f32 v61, v42, v43
  v_cvt_pk_bf16_f32 v62, v44, v45
  v_cvt_pk_bf16_f32 v63, v46, v47
  v_mfma_f32_32x32x16_bf16 v[64:79], a[8:11], v[56:59], v[64:79]
  s_nop 0
  v_mfma_f32_32x32x16_bf16 v[64:79], a[12:15], v[60:63], v[64:79]
  v_mfma_f32_32x32x16_bf16 v[16:31], a[16:19], v[176:179], 0
  v_mfma_f32_32x32x16_bf16 v[16:31], a[20:23], v[180:183], v[16:31]
  s_nop 11
  v_sub_f32 v16, v16, v2
  v_sub_f32 v17, v17, v2
  v_sub_f32 v18, v18, v2
  v_sub_f32 v19, v19, v2
  v_sub_f32 v20, v20, v2
  v_sub_f32 v21, v21, v2
  v_sub_f32 v22, v22, v2
  v_sub_f32 v23, v23, v2
  v_sub_f32 v24, v24, v2
  v_sub_f32 v25, v25, v2
  v_sub_f32 v26, v26, v2
  v_sub_f32 v27, v27, v2
  v_sub_f32 v28, v28, v2
  v_sub_f32 v29, v29, v2
  v_sub_f32 v30, v30, v2
  v_sub_f32 v31, v31, v2
  v_exp_f32 v16, v16
  v_exp_f32 v17, v17
  v_exp_f32 v18, v18
  v_exp_f32 v19, v19
  v_exp_f32 v20, v20
  v_exp_f32 v21, v21
  v_exp_f32 v22, v22
  v_exp_f32 v23, v23
  v_exp_f32 v24, v24
  v_exp_f32 v25, v25
  v_exp_f32 v26, v26
  v_exp_f32 v27, v27
  v_exp_f32 v28, v28
  v_exp_f32 v29, v29
  v_exp_f32 v30, v30
  v_exp_f32 v31, v31
  v_cvt_pk_bf16_f32 v48, v16, v17
  v_cvt_pk_bf16_f32 v49, v18, v19
  v_cvt_pk_bf16_f32 v50, v20, v21
  v_cvt_pk_bf16_f32 v51, v22, v23
  v_cvt_pk_bf16_f32 v52, v24, v25
  v_cvt_pk_bf16_f32 v53, v26, v27
  v_cvt_pk_bf16_f32 v54, v28, v29
  v_cvt_pk_bf16_f32 v55, v30, v31
  v_mfma_f32_32x32x16_bf16 v[64:79], a[24:27], v[48:51], v[64:79]
  s_nop 0
  v_mfma_f32_32x32x16_bf16 v[64:79], a[28:31], v[52:55], v[64:79]
  v_mfma_f32_32x32x16_bf16 v[32:47], a[32:35], v[176:179], 0
  v_mfma_f32_32x32x16_bf16 v[32:47], a[36:39], v[180:183], v[32:47]
  s_nop 11
  v_sub_f32 v32, v32, v2
  v_sub_f32 v33, v33, v2
  v_sub_f32 v34, v34, v2
  v_sub_f32 v35, v35, v2
  v_sub_f32 v36, v36, v2
  v_sub_f32 v37, v37, v2
  v_sub_f32 v38, v38, v2
  v_sub_f32 v39, v39, v2
  v_sub_f32 v40, v40, v2
  v_sub_f32 v41, v41, v2
  v_sub_f32 v42, v42, v2
  v_sub_f32 v43, v43, v2
  v_sub_f32 v44, v44, v2
  v_sub_f32 v45, v45, v2
  v_sub_f32 v46, v46, v2
  v_sub_f32 v47, v47, v2
  v_exp_f32 v32, v32
  v_exp_f32 v33, v33
  v_exp_f32 v34, v34
  v_exp_f32 v35, v35
  v_exp_f32 v36, v36
  v_exp_f32 v37, v37
  v_exp_f32 v38, v38
  v_exp_f32 v39, v39
  v_exp_f32 v40, v40
  v_exp_f32 v41, v41
  v_exp_f32 v42, v42
  v_exp_f32 v43, v43
  v_exp_f32 v44, v44
  v_exp_f32 v45, v45
  v_exp_f32 v46, v46
  v_exp_f32 v47, v47
  v_cvt_pk_bf16_f32 v56, v32, v33
  v_cvt_pk_bf16_f32 v57, v34, v35
  v_cvt_pk_bf16_f32 v58, v36, v37
  v_cvt_pk_bf16_f32 v59, v38, v39
  v_cvt_pk_bf16_f32 v60, v40, v41
  v_cvt_pk_bf16_f32 v61, v42, v43
  v_cvt_pk_bf16_f32 v62, v44, v45
  v_cvt_pk_bf16_f32 v63, v46, v47
  v_mfma_f32_32x32x16_bf16 v[64:79], a[40:43], v[56:59], v[64:79]
  s_nop 0
  v_mfma_f32_32x32x16_bf16 v[64:79], a[44:47], v[60:63], v[64:79]
  v_mfma_f32_32x32x16_bf16 v[16:31], a[48:51], v[176:179], 0
  v_mfma_f32_32x32x16_bf16 v[16:31], a[52:55], v[180:183], v[16:31]
  s_nop 11
  v_sub_f32 v16, v16, v2
  v_sub_f32 v17, v17, v2
  v_sub_f32 v18, v18, v2
  v_sub_f32 v19, v19, v2
  v_sub_f32 v20, v20, v2
  v_sub_f32 v21, v21, v2
  v_sub_f32 v22, v22, v2
  v_sub_f32 v23, v23, v2
  v_sub_f32 v24, v24, v2
  v_sub_f32 v25, v25, v2
  v_sub_f32 v26, v26, v2
  v_sub_f32 v27, v27, v2
  v_sub_f32 v28, v28, v2
  v_sub_f32 v29, v29, v2
  v_sub_f32 v30, v30, v2
  v_sub_f32 v31, v31, v2
  v_exp_f32 v16, v16
  v_exp_f32 v17, v17
  v_exp_f32 v18, v18
  v_exp_f32 v19, v19
  v_exp_f32 v20, v20
  v_exp_f32 v21, v21
  v_exp_f32 v22, v22
  v_exp_f32 v23, v23
  v_exp_f32 v24, v24
  v_exp_f32 v25, v25
  v_exp_f32 v26, v26
  v_exp_f32 v27, v27
  v_exp_f32 v28, v28
  v_exp_f32 v29, v29
  v_exp_f32 v30, v30
  v_exp_f32 v31, v31
  v_cvt_pk_bf16_f32 v48, v16, v17
  v_cvt_pk_bf16_f32 v49, v18, v19
  v_cvt_pk_bf16_f32 v50, v20, v21
  v_cvt_pk_bf16_f32 v51, v22, v23
  v_cvt_pk_bf16_f32 v52, v24, v25
  v_cvt_pk_bf16_f32 v53, v26, v27
  v_cvt_pk_bf16_f32 v54, v28, v29
  v_cvt_pk_bf16_f32 v55, v30, v31
  v_mfma_f32_32x32x16_bf16 v[64:79], a[56:59], v[48:51], v[64:79]
  s_nop 0
  v_mfma_f32_32x32x16_bf16 v[64:79], a[60:63], v[52:55], v[64:79]
  v_mfma_f32_32x32x16_bf16 v[32:47], a[64:67], v[176:179], 0
  v_mfma_f32_32x32x16_bf16 v[32:47], a[68:71], v[180:183], v[32:47]
  s_nop 11
  v_sub_f32 v32, v32, v2
  v_sub_f32 v33, v33, v2
  v_sub_f32 v34, v34, v2
  v_sub_f32 v35, v35, v2
  v_sub_f32 v36, v36, v2
  v_sub_f32 v37, v37, v2
  v_sub_f32 v38, v38, v2
  v_sub_f32 v39, v39, v2
  v_sub_f32 v40, v40, v2
  v_sub_f32 v41, v41, v2
  v_sub_f32 v42, v42, v2
  v_sub_f32 v43, v43, v2
  v_sub_f32 v44, v44, v2
  v_sub_f32 v45, v45, v2
  v_sub_f32 v46, v46, v2
  v_sub_f32 v47, v47, v2
  v_exp_f32 v32, v32
  v_exp_f32 v33, v33
  v_exp_f32 v34, v34
  v_exp_f32 v35, v35
  v_exp_f32 v36, v36
  v_exp_f32 v37, v37
  v_exp_f32 v38, v38
  v_exp_f32 v39, v39
  v_exp_f32 v40, v40
  v_exp_f32 v41, v41
  v_exp_f32 v42, v42
  v_exp_f32 v43, v43
  v_exp_f32 v44, v44
  v_exp_f32 v45, v45
  v_exp_f32 v46, v46
  v_exp_f32 v47, v47
  v_cvt_pk_bf16_f32 v56, v32, v33
  v_cvt_pk_bf16_f32 v57, v34, v35
  v_cvt_pk_bf16_f32 v58, v36, v37
  v_cvt_pk_bf16_f32 v59, v38, v39
  v_cvt_pk_bf16_f32 v60, v40, v41
  v_cvt_pk_bf16_f32 v61, v42, v43
  v_cvt_pk_bf16_f32 v62, v44, v45
  v_cvt_pk_bf16_f32 v63, v46, v47
  v_mfma_f32_32x32x16_bf16 v[64:79], a[72:75], v[56:59], v[64:79]
  s_nop 0
  v_mfma_f32_32x32x16_bf16 v[64:79], a[76:79], v[60:63], v[64:79]
  v_mfma_f32_32x32x16_bf16 v[16:31], a[80:83], v[176:179], 0
  v_mfma_f32_32x32x16_bf16 v[16:31], a[84:87], v[180:183], v[16:31]
  s_nop 11
  v_sub_f32 v16, v16, v2
  v_sub_f32 v17, v17, v2
  v_sub_f32 v18, v18, v2
  v_sub_f32 v19, v19, v2
  v_sub_f32 v20, v20, v2
  v_sub_f32 v21, v21, v2
  v_sub_f32 v22, v22, v2
  v_sub_f32 v23, v23, v2
  v_sub_f32 v24, v24, v2
  v_sub_f32 v25, v25, v2
  v_sub_f32 v26, v26, v2
  v_sub_f32 v27, v27, v2
  v_sub_f32 v28, v28, v2
  v_sub_f32 v29, v29, v2
  v_sub_f32 v30, v30, v2
  v_sub_f32 v31, v31, v2
  v_exp_f32 v16, v16
  v_exp_f32 v17, v17
  v_exp_f32 v18, v18
  v_exp_f32 v19, v19
  v_exp_f32 v20, v20
  v_exp_f32 v21, v21
  v_exp_f32 v22, v22
  v_exp_f32 v23, v23
  v_exp_f32 v24, v24
  v_exp_f32 v25, v25
  v_exp_f32 v26, v26
  v_exp_f32 v27, v27
  v_exp_f32 v28, v28
  v_exp_f32 v29, v29
  v_exp_f32 v30, v30
  v_exp_f32 v31, v31
  v_cvt_pk_bf16_f32 v48, v16, v17
  v_cvt_pk_bf16_f32 v49, v18, v19
  v_cvt_pk_bf16_f32 v50, v20, v21
  v_cvt_pk_bf16_f32 v51, v22, v23
  v_cvt_pk_bf16_f32 v52, v24, v25
  v_cvt_pk_bf16_f32 v53, v26, v27
  v_cvt_pk_bf16_f32 v54, v28, v29
  v_cvt_pk_bf16_f32 v55, v30, v31
  v_mfma_f32_32x32x16_bf16 v[64:79], a[88:91], v[48:51], v[64:79]
  s_nop 0
  v_mfma_f32_32x32x16_bf16 v[64:79], a[92:95], v[52:55], v[64:79]
  v_mfma_f32_32x32x16_bf16 v[32:47], a[96:99], v[176:179], 0
  v_mfma_f32_32x32x16_bf16 v[32:47], a[100:103], v[180:183], v[32:47]
  s_nop 11
  v_sub_f32 v32, v32, v2
  v_sub_f32 v33, v33, v2
  v_sub_f32 v34, v34, v2
  v_sub_f32 v35, v35, v2
  v_sub_f32 v36, v36, v2
  v_sub_f32 v37, v37, v2
  v_sub_f32 v38, v38, v2
  v_sub_f32 v39, v39, v2
  v_sub_f32 v40, v40, v2
  v_sub_f32 v41, v41, v2
  v_sub_f32 v42, v42, v2
  v_sub_f32 v43, v43, v2
  v_sub_f32 v44, v44, v2
  v_sub_f32 v45, v45, v2
  v_sub_f32 v46, v46, v2
  v_sub_f32 v47, v47, v2
  v_exp_f32 v32, v32
  v_exp_f32 v33, v33
  v_exp_f32 v34, v34
  v_exp_f32 v35, v35
  v_exp_f32 v36, v36
  v_exp_f32 v37, v37
  v_exp_f32 v38, v38
  v_exp_f32 v39, v39
  v_exp_f32 v40, v40
  v_exp_f32 v41, v41
  v_exp_f32 v42, v42
  v_exp_f32 v43, v43
  v_exp_f32 v44, v44
  v_exp_f32 v45, v45
  v_exp_f32 v46, v46
  v_exp_f32 v47, v47
  v_cvt_pk_bf16_f32 v56, v32, v33
  v_cvt_pk_bf16_f32 v57, v34, v35
  v_cvt_pk_bf16_f32 v58, v36, v37
  v_cvt_pk_bf16_f32 v59, v38, v39
  v_cvt_pk_bf16_f32 v60, v40, v41
  v_cvt_pk_bf16_f32 v61, v42, v43
  v_cvt_pk_bf16_f32 v62, v44, v45
  v_cvt_pk_bf16_f32 v63, v46, v47
  v_mfma_f32_32x32x16_bf16 v[64:79], a[104:107], v[56:59], v[64:79]
  s_nop 0
  v_mfma_f32_32x32x16_bf16 v[64:79], a[108:111], v[60:63], v[64:79]
  v_mfma_f32_32x32x16_bf16 v[16:31], a[112:115], v[176:179], 0
  v_mfma_f32_32x32x16_bf16 v[16:31], a[116:119], v[180:183], v[16:31]
  s_nop 11
  v_sub_f32 v16, v16, v2
  v_sub_f32 v17, v17, v2
  v_sub_f32 v18, v18, v2
  v_sub_f32 v19, v19, v2
  v_sub_f32 v20, v20, v2
  v_sub_f32 v21, v21, v2
  v_sub_f32 v22, v22, v2
  v_sub_f32 v23, v23, v2
  v_sub_f32 v24, v24, v2
  v_sub_f32 v25, v25, v2
  v_sub_f32 v26, v26, v2
  v_sub_f32 v27, v27, v2
  v_sub_f32 v28, v28, v2
  v_sub_f32 v29, v29, v2
  v_sub_f32 v30, v30, v2
  v_sub_f32 v31, v31, v2
  v_exp_f32 v16, v16
  v_exp_f32 v17, v17
  v_exp_f32 v18, v18
  v_exp_f32 v19, v19
  v_exp_f32 v20, v20
  v_exp_f32 v21, v21
  v_exp_f32 v22, v22
  v_exp_f32 v23, v23
  v_exp_f32 v24, v24
  v_exp_f32 v25, v25
  v_exp_f32 v26, v26
  v_exp_f32 v27, v27
  v_exp_f32 v28, v28
  v_exp_f32 v29, v29
  v_exp_f32 v30, v30
  v_exp_f32 v31, v31
  v_cvt_pk_bf16_f32 v48, v16, v17
  v_cvt_pk_bf16_f32 v49, v18, v19
  v_cvt_pk_bf16_f32 v50, v20, v21
  v_cvt_pk_bf16_f32 v51, v22, v23
  v_cvt_pk_bf16_f32 v52, v24, v25
  v_cvt_pk_bf16_f32 v53, v26, v27
  v_cvt_pk_bf16_f32 v54, v28, v29
  v_cvt_pk_bf16_f32 v55, v30, v31
  v_mfma_f32_32x32x16_bf16 v[64:79], a[120:123], v[48:51], v[64:79]
  s_nop 0
  v_mfma_f32_32x32x16_bf16 v[64:79], a[124:127], v[52:55], v[64:79]
  v_mfma_f32_32x32x16_bf16 v[32:47], a[128:131], v[176:179], 0
  v_mfma_f32_32x32x16_bf16 v[32:47], a[132:135], v[180:183], v[32:47]
  s_nop 11
  v_sub_f32 v32, v32, v2
  v_sub_f32 v33, v33, v2
  v_sub_f32 v34, v34, v2
  v_sub_f32 v35, v35, v2
  v_sub_f32 v36, v36, v2
  v_sub_f32 v37, v37, v2
  v_sub_f32 v38, v38, v2
  v_sub_f32 v39, v39, v2
  v_sub_f32 v40, v40, v2
  v_sub_f32 v41, v41, v2
  v_sub_f32 v42, v42, v2
  v_sub_f32 v43, v43, v2
  v_sub_f32 v44, v44, v2
  v_sub_f32 v45, v45, v2
  v_sub_f32 v46, v46, v2
  v_sub_f32 v47, v47, v2
  v_exp_f32 v32, v32
  v_exp_f32 v33, v33
  v_exp_f32 v34, v34
  v_exp_f32 v35, v35
  v_exp_f32 v36, v36
  v_exp_f32 v37, v37
  v_exp_f32 v38, v38
  v_exp_f32 v39, v39
  v_exp_f32 v40, v40
  v_exp_f32 v41, v41
  v_exp_f32 v42, v42
  v_exp_f32 v43, v43
  v_exp_f32 v44, v44
  v_exp_f32 v45, v45
  v_exp_f32 v46, v46
  v_exp_f32 v47, v47
  v_cvt_pk_bf16_f32 v56, v32, v33
  v_cvt_pk_bf16_f32 v57, v34, v35
  v_cvt_pk_bf16_f32 v58, v36, v37
  v_cvt_pk_bf16_f32 v59, v38, v39
  v_cvt_pk_bf16_f32 v60, v40, v41
  v_cvt_pk_bf16_f32 v61, v42, v43
  v_cvt_pk_bf16_f32 v62, v44, v45
  v_cvt_pk_bf16_f32 v63, v46, v47
  v_mfma_f32_32x32x16_bf16 v[64:79], a[136:139], v[56:59], v[64:79]
  s_nop 0
  v_mfma_f32_32x32x16_bf16 v[64:79], a[140:143], v[60:63], v[64:79]
  v_mfma_f32_32x32x16_bf16 v[16:31], a[144:147], v[176:179], 0
  v_mfma_f32_32x32x16_bf16 v[16:31], a[148:151], v[180:183], v[16:31]
  s_nop 11
  v_sub_f32 v16, v16, v2
  v_sub_f32 v17, v17, v2
  v_sub_f32 v18, v18, v2
  v_sub_f32 v19, v19, v2
  v_sub_f32 v20, v20, v2
  v_sub_f32 v21, v21, v2
  v_sub_f32 v22, v22, v2
  v_sub_f32 v23, v23, v2
  v_sub_f32 v24, v24, v2
  v_sub_f32 v25, v25, v2
  v_sub_f32 v26, v26, v2
  v_sub_f32 v27, v27, v2
  v_sub_f32 v28, v28, v2
  v_sub_f32 v29, v29, v2
  v_sub_f32 v30, v30, v2
  v_sub_f32 v31, v31, v2
  v_exp_f32 v16, v16
  v_exp_f32 v17, v17
  v_exp_f32 v18, v18
  v_exp_f32 v19, v19
  v_exp_f32 v20, v20
  v_exp_f32 v21, v21
  v_exp_f32 v22, v22
  v_exp_f32 v23, v23
  v_exp_f32 v24, v24
  v_exp_f32 v25, v25
  v_exp_f32 v26, v26
  v_exp_f32 v27, v27
  v_exp_f32 v28, v28
  v_exp_f32 v29, v29
  v_exp_f32 v30, v30
  v_exp_f32 v31, v31
  v_cvt_pk_bf16_f32 v48, v16, v17
  v_cvt_pk_bf16_f32 v49, v18, v19
  v_cvt_pk_bf16_f32 v50, v20, v21
  v_cvt_pk_bf16_f32 v51, v22, v23
  v_cvt_pk_bf16_f32 v52, v24, v25
  v_cvt_pk_bf16_f32 v53, v26, v27
  v_cvt_pk_bf16_f32 v54, v28, v29
  v_cvt_pk_bf16_f32 v55, v30, v31
  v_mfma_f32_32x32x16_bf16 v[64:79], a[152:155], v[48:51], v[64:79]
  s_nop 0
  v_mfma_f32_32x32x16_bf16 v[64:79], a[156:159], v[52:55], v[64:79]
  v_mfma_f32_32x32x16_bf16 v[32:47], a[160:163], v[176:179], 0
  v_mfma_f32_32x32x16_bf16 v[32:47], a[164:167], v[180:183], v[32:47]
  s_nop 11
  v_sub_f32 v32, v32, v2
  v_sub_f32 v33, v33, v2
  v_sub_f32 v34, v34, v2
  v_sub_f32 v35, v35, v2
  v_sub_f32 v36, v36, v2
  v_sub_f32 v37, v37, v2
  v_sub_f32 v38, v38, v2
  v_sub_f32 v39, v39, v2
  v_sub_f32 v40, v40, v2
  v_sub_f32 v41, v41, v2
  v_sub_f32 v42, v42, v2
  v_sub_f32 v43, v43, v2
  v_sub_f32 v44, v44, v2
  v_sub_f32 v45, v45, v2
  v_sub_f32 v46, v46, v2
  v_sub_f32 v47, v47, v2
  v_exp_f32 v32, v32
  v_exp_f32 v33, v33
  v_exp_f32 v34, v34
  v_exp_f32 v35, v35
  v_exp_f32 v36, v36
  v_exp_f32 v37, v37
  v_exp_f32 v38, v38
  v_exp_f32 v39, v39
  v_exp_f32 v40, v40
  v_exp_f32 v41, v41
  v_exp_f32 v42, v42
  v_exp_f32 v43, v43
  v_exp_f32 v44, v44
  v_exp_f32 v45, v45
  v_exp_f32 v46, v46
  v_exp_f32 v47, v47
  v_cvt_pk_bf16_f32 v56, v32, v33
  v_cvt_pk_bf16_f32 v57, v34, v35
  v_cvt_pk_bf16_f32 v58, v36, v37
  v_cvt_pk_bf16_f32 v59, v38, v39
  v_cvt_pk_bf16_f32 v60, v40, v41
  v_cvt_pk_bf16_f32 v61, v42, v43
  v_cvt_pk_bf16_f32 v62, v44, v45
  v_cvt_pk_bf16_f32 v63, v46, v47
  v_mfma_f32_32x32x16_bf16 v[64:79], a[168:171], v[56:59], v[64:79]
  s_nop 0
  v_mfma_f32_32x32x16_bf16 v[64:79], a[172:175], v[60:63], v[64:79]
  s_and_b32 s53, s91, 1
  s_lshl_b32 s54, s53, 12
  v_add_u32 v3, s54, v230
  s_nop 8
  ds_write_b128 v3, v[64:67] offset:0
  ds_write_b128 v3, v[68:71] offset:1024
  ds_write_b128 v3, v[72:75] offset:2048
  ds_write_b128 v3, v[76:79] offset:3072
  s_waitcnt lgkmcnt(0)
  s_barrier
  s_add_u32 s91, s91, 1
  s_cmp_eq_u32 s53, 0
  s_cbranch_scc1 L_slowT
  s_cmp_eq_u32 s91, 2
  s_cbranch_scc0 L_slowL
  ds_read2st64_b32 v[144:145], v232 offset0:0 offset1:32
  ds_read2st64_b32 v[146:147], v232 offset0:64 offset1:96
  ds_read2st64_b32 v[148:149], v233 offset0:0 offset1:32
  ds_read2st64_b32 v[150:151], v233 offset0:64 offset1:96
  ds_read_b128 v[192:195], v231 offset:0
  ds_read_b64 v[196:197], v253 offset:0
  ds_read_b64 v[198:199], v253 offset:2048
  ds_read_b128 v[200:203], v231 offset:8192
  ds_read_b64 v[204:205], v253 offset:8192
  ds_read_b64 v[206:207], v253 offset:10240
  ds_read_b128 v[208:211], v231 offset:16384
  ds_read_b64 v[212:213], v253 offset:16384
  ds_read_b64 v[214:215], v253 offset:18432
  ds_read_b128 v[216:219], v231 offset:24576
  ds_read_b64 v[220:221], v253 offset:24576
  ds_read_b64 v[222:223], v253 offset:26624
  s_waitcnt lgkmcnt(14)
  v_pk_add_f32 v[144:145], v[144:145], v[146:147]
  s_waitcnt lgkmcnt(12)
  v_pk_add_f32 v[148:149], v[148:149], v[150:151]
  v_add_f32 v144, v144, v145
  v_add_f32 v148, v148, v149
  v_rcp_f32 v146, v144
  s_waitcnt lgkmcnt(8)
  v_pk_add_f32 v[192:193], v[192:193], v[200:201]
  v_pk_add_f32 v[194:195], v[194:195], v[202:203]
  s_waitcnt lgkmcnt(7)
  v_pk_add_f32 v[196:197], v[196:197], v[204:205]
  s_waitcnt lgkmcnt(6)
  v_pk_add_f32 v[198:199], v[198:199], v[206:207]
  v_mul_f32 v146, v146, v10
  s_waitcnt lgkmcnt(2)
  v_pk_add_f32 v[208:209], v[208:209], v[216:217]
  v_pk_add_f32 v[210:211], v[210:211], v[218:219]
  s_waitcnt lgkmcnt(1)
  v_pk_add_f32 v[212:213], v[212:213], v[220:221]
  s_waitcnt lgkmcnt(0)
  v_pk_add_f32 v[214:215], v[214:215], v[222:223]
  v_pk_add_f32 v[192:193], v[192:193], v[208:209]
  v_pk_add_f32 v[194:195], v[194:195], v[210:211]
  v_pk_add_f32 v[196:197], v[196:197], v[212:213]
  v_pk_add_f32 v[198:199], v[198:199], v[214:215]
  v_pk_mul_f32 v[192:193], v[192:193], v[146:147] op_sel_hi:[1,0]
  v_pk_mul_f32 v[194:195], v[194:195], v[146:147] op_sel_hi:[1,0]
  v_pk_mul_f32 v[196:197], v[196:197], v[146:147] op_sel_hi:[1,0]
  v_pk_mul_f32 v[198:199], v[198:199], v[146:147] op_sel_hi:[1,0]
  v_cvt_pk_bf16_f32 v152, v192, v193
  v_cvt_pk_bf16_f32 v153, v194, v195
  v_cvt_pk_bf16_f32 v154, v196, v197
  v_cvt_pk_bf16_f32 v155, v198, v199
  v_cndmask_b32 v155, v155, 0, s[46:47]
  buffer_store_dwordx4 v[152:155], v242, s[16:19], s64 offen sc1
  s_waitcnt vmcnt(0) lgkmcnt(0)
  buffer_store_dword v15, v14, s[16:19], s62 offen sc1
  s_barrier
  s_branch L_slowT
L_slowL:
  ds_read2st64_b32 v[144:145], v232 offset0:0 offset1:32
  ds_read2st64_b32 v[146:147], v232 offset0:64 offset1:96
  ds_read2st64_b32 v[148:149], v233 offset0:0 offset1:32
  ds_read2st64_b32 v[150:151], v233 offset0:64 offset1:96
  ds_read_b128 v[192:195], v231 offset:0
  ds_read_b64 v[196:197], v253 offset:0
  ds_read_b64 v[198:199], v253 offset:2048
  ds_read_b128 v[200:203], v231 offset:8192
  ds_read_b64 v[204:205], v253 offset:8192
  ds_read_b64 v[206:207], v253 offset:10240
  ds_read_b128 v[208:211], v231 offset:16384
  ds_read_b64 v[212:213], v253 offset:16384
  ds_read_b64 v[214:215], v253 offset:18432
  ds_read_b128 v[216:219], v231 offset:24576
  ds_read_b64 v[220:221], v253 offset:24576
  ds_read_b64 v[222:223], v253 offset:26624
  s_waitcnt lgkmcnt(14)
  v_pk_add_f32 v[144:145], v[144:145], v[146:147]
  s_waitcnt lgkmcnt(12)
  v_pk_add_f32 v[148:149], v[148:149], v[150:151]
  v_add_f32 v144, v144, v145
  v_add_f32 v148, v148, v149
  v_rcp_f32 v146, v144
  s_waitcnt lgkmcnt(8)
  v_pk_add_f32 v[192:193], v[192:193], v[200:201]
  v_pk_add_f32 v[194:195], v[194:195], v[202:203]
  s_waitcnt lgkmcnt(7)
  v_pk_add_f32 v[196:197], v[196:197], v[204:205]
  s_waitcnt lgkmcnt(6)
  v_pk_add_f32 v[198:199], v[198:199], v[206:207]
  v_mul_f32 v146, v146, v11
  s_waitcnt lgkmcnt(2)
  v_pk_add_f32 v[208:209], v[208:209], v[216:217]
  v_pk_add_f32 v[210:211], v[210:211], v[218:219]
  s_waitcnt lgkmcnt(1)
  v_pk_add_f32 v[212:213], v[212:213], v[220:221]
  s_waitcnt lgkmcnt(0)
  v_pk_add_f32 v[214:215], v[214:215], v[222:223]
  v_pk_add_f32 v[192:193], v[192:193], v[208:209]
  v_pk_add_f32 v[194:195], v[194:195], v[210:211]
  v_pk_add_f32 v[196:197], v[196:197], v[212:213]
  v_pk_add_f32 v[198:199], v[198:199], v[214:215]
  v_pk_mul_f32 v[192:193], v[192:193], v[146:147] op_sel_hi:[1,0]
  v_pk_mul_f32 v[194:195], v[194:195], v[146:147] op_sel_hi:[1,0]
  v_pk_mul_f32 v[196:197], v[196:197], v[146:147] op_sel_hi:[1,0]
  v_pk_mul_f32 v[198:199], v[198:199], v[146:147] op_sel_hi:[1,0]
  v_cvt_pk_bf16_f32 v152, v192, v193
  v_cvt_pk_bf16_f32 v153, v194, v195
  v_cvt_pk_bf16_f32 v154, v196, v197
  v_cvt_pk_bf16_f32 v155, v198, v199
  v_cndmask_b32 v155, v155, v245, s[46:47]
  s_add_u32 s64, s64, 131072
  buffer_store_dwordx4 v[152:155], v242, s[16:19], s64 offen sc1
  s_waitcnt vmcnt(0) lgkmcnt(0)
  s_barrier
  s_add_u32 m0, s67, 0
  s_nop 0
  global_load_lds_dwordx4 v234, s[6:7]
  s_add_u32 m0, s67, 1024
  s_nop 0
  global_load_lds_dwordx4 v246, s[6:7]
  s_add_u32 m0, s67, 2048
  s_nop 0
  global_load_lds_dwordx4 v247, s[6:7]
  s_add_u32 m0, s67, 3072
  s_nop 0
  global_load_lds_dwordx4 v248, s[6:7]
  s_add_u32 m0, s67, 4096
  s_nop 0
  global_load_lds_dwordx4 v250, s[6:7]
  s_add_u32 m0, s67, 5120
  s_nop 0
  global_load_lds_dwordx4 v251, s[6:7]
  s_add_u32 m0, s67, 6144
  s_nop 0
  global_load_lds_dwordx4 v252, s[6:7]
  s_add_u32 m0, s67, 7168
  s_nop 0
  global_load_lds_dwordx4 v234, s[14:15]
  s_add_u32 m0, s67, 8192
  s_nop 0
  global_load_lds_dwordx4 v246, s[14:15]
  s_add_u32 m0, s67, 9216
  s_nop 0
  global_load_lds_dwordx4 v247, s[14:15]
  s_add_u32 m0, s67, 10240
  s_nop 0
  global_load_lds_dwordx4 v248, s[14:15]
  s_add_u32 m0, s67, 11264
  s_nop 0
  global_load_lds_dwordx4 v250, s[14:15]
  s_add_u32 m0, s67, 12288
  s_nop 0
  global_load_lds_dwordx4 v251, s[14:15]
  s_add_u32 m0, s67, 13312
  s_nop 0
  global_load_lds_dwordx4 v252, s[14:15]
  s_add_u32 m0, s67, 14336
  s_nop 0
  global_load_lds_dwordx4 v252, s[14:15]
  s_add_u32 m0, s67, 15360
  s_nop 0
  global_load_lds_dwordx4 v234, s[10:11]
  s_add_u32 m0, s67, 16384
  s_nop 0
  global_load_lds_dwordx4 v246, s[10:11]
  s_add_u32 m0, s67, 17408
  s_nop 0
  global_load_lds_dwordx4 v247, s[10:11]
  s_add_u32 m0, s67, 18432
  s_nop 0
  global_load_lds_dwordx4 v248, s[10:11]
  s_add_u32 m0, s67, 19456
  s_nop 0
  global_load_lds_dwordx4 v250, s[10:11]
  s_add_u32 m0, s67, 20480
  s_nop 0
  global_load_lds_dwordx4 v251, s[10:11]
  s_add_u32 m0, s67, 21504
  s_nop 0
  global_load_lds_dwordx4 v252, s[10:11]
  s_add_u32 m0, s67, 22528
  s_nop 0
  global_load_lds_dwordx4 v234, s[32:33]
  s_add_u32 m0, s67, 23552
  s_nop 0
  global_load_lds_dwordx4 v246, s[32:33]
  s_add_u32 m0, s67, 24576
  s_nop 0
  global_load_lds_dwordx4 v247, s[32:33]
  s_add_u32 m0, s67, 25600
  s_nop 0
  global_load_lds_dwordx4 v248, s[32:33]
  s_add_u32 m0, s67, 26624
  s_nop 0
  global_load_lds_dwordx4 v250, s[32:33]
  s_add_u32 m0, s67, 27648
  s_nop 0
  global_load_lds_dwordx4 v251, s[32:33]
  s_add_u32 m0, s67, 28672
  s_nop 0
  global_load_lds_dwordx4 v252, s[32:33]
  s_add_u32 m0, s67, 29696
  s_nop 0
  global_load_lds_dwordx4 v252, s[32:33]
  s_mov_b32 s58, 0
L_poll1:
  buffer_load_dword v2, v237, s[16:19], s88 offen sc1
  s_add_u32 s58, s58, 1
  s_cmp_gt_u32 s58, 0x40000
  s_cbranch_scc1 L_poll1_done
  s_waitcnt vmcnt(0)
  v_cmp_ne_u32 vcc, v15, v2
  s_cbranch_vccnz L_poll1
L_poll1_done:
  s_waitcnt vmcnt(0)
  s_add_u32 s12, s87, 4096
  s_add_u32 s12, s12, s16
  s_addc_u32 s13, s17, 0
  global_load_dwordx4 a[176:179], v1, s[12:13] offset:-4096 sc1
  global_load_dwordx4 a[180:183], v1, s[12:13] offset:-3072 sc1
  global_load_dwordx4 a[184:187], v1, s[12:13] offset:-2048 sc1
  global_load_dwordx4 a[188:191], v1, s[12:13] offset:-1024 sc1
  global_load_dwordx4 a[192:195], v1, s[12:13] offset:0 sc1
  global_load_dwordx4 a[196:199], v1, s[12:13] offset:1024 sc1
  global_load_dwordx4 a[200:203], v1, s[12:13] offset:2048 sc1
  global_load_dwordx4 a[204:207], v1, s[12:13] offset:3072 sc1
  s_add_u32 s12, s12, 131072
  s_addc_u32 s13, s13, 0
  global_load_dwordx4 a[240:243], v1, s[12:13] offset:-4096 sc1
  global_load_dwordx4 a[244:247], v1, s[12:13] offset:-3072 sc1
  global_load_dwordx4 a[248:251], v1, s[12:13] offset:-2048 sc1
  global_load_dwordx4 a[252:255], v1, s[12:13] offset:-1024 sc1
  global_load_dwordx4 a[0:3], v1, s[12:13] offset:0 sc1
  global_load_dwordx4 a[4:7], v1, s[12:13] offset:1024 sc1
  global_load_dwordx4 a[8:11], v1, s[12:13] offset:2048 sc1
  global_load_dwordx4 a[12:15], v1, s[12:13] offset:3072 sc1
  s_sub_u32 s12, s12, 98304
  s_subb_u32 s13, s13, 0
  global_load_dwordx4 a[208:211], v242, s[12:13] offset:-4096 sc1
  global_load_dwordx4 a[212:215], v242, s[12:13] offset:-3072 sc1
  global_load_dwordx4 a[216:219], v242, s[12:13] offset:-2048 sc1
  global_load_dwordx4 a[220:223], v242, s[12:13] offset:-1024 sc1
  global_load_dwordx4 a[224:227], v242, s[12:13] offset:0 sc1
  global_load_dwordx4 a[228:231], v242, s[12:13] offset:1024 sc1
  global_load_dwordx4 a[232:235], v242, s[12:13] offset:2048 sc1
  global_load_dwordx4 a[236:239], v242, s[12:13] offset:3072 sc1
  s_add_u32 s12, s12, 131072
  s_addc_u32 s13, s13, 0
  s_waitcnt vmcnt(0) lgkmcnt(0)
  s_branch L_tail
L_codeend:
.section .rodata,"a"
.p2align 6
.amdhsa_kernel gated_mix__linear_attn_block__mha_block__prompt_kernel
  .amdhsa_next_free_vgpr 512
  .amdhsa_next_free_sgpr 102
  .amdhsa_accum_offset 256
  .amdhsa_group_segment_fixed_size 0
  .amdhsa_kernarg_size 80
  .amdhsa_user_sgpr_count 2
  .amdhsa_user_sgpr_kernarg_segment_ptr 1
  .amdhsa_system_sgpr_workgroup_id_x 1
.end_amdhsa_kernel
```
